```python
import torch

def _softmax(x, axis=-1):
    return torch.softmax(x, dim=axis)
def _gelu(x):
    return torch.nn.functional.gelu(x, approximate="tanh")
def _silu(x):
    return torch.nn.functional.silu(x)
def _sigmoid(x):
    return torch.sigmoid(x)
def _layernorm(x, axis=-1, eps=1e-5):
    m = x.mean(dim=axis, keepdim=True)
    v = x.var(dim=axis, keepdim=True, unbiased=False)
    return (x - m) / torch.sqrt(v + eps)
def _scatter_add(tgt, idx, src, axis=0):
    return tgt.clone().index_add_(axis, idx, src)
def _segment_sum(src, seg, n):
    out = torch.zeros((n,) + src.shape[1:], dtype=src.dtype)
    return out.index_add_(0, seg, src)
def _pad(x, pw):
    flat = tuple(v for pair in reversed(pw) for v in pair)
    return torch.nn.functional.pad(x, flat)

kernel_name = 'recurrent_scan__gqa_block_cached__mixer_token_mlp__prompt'

def setup_inputs():

    _w = (lambda a: (lambda t: t.to(torch.bfloat16) if t.is_floating_point() else t)(torch.as_tensor(a)))
    def _A_setup():
        B, Sq, D = 1, 2048, 512
        Hq, Hkv, Sk, Dh = 32, 8, 2048, 128
        assert Hq % Hkv == 0, (Hq, Hkv)
        return {
            "x": _w((lambda *s: torch.randn(*s, dtype=torch.bfloat16) * 0.05)(B, Sq, D)),
            "k_cache": _w((lambda *s: torch.randn(*s, dtype=torch.bfloat16) * 3.2)(B, Hkv, Sk, Dh)),
            "v_cache": _w((lambda *s: torch.randn(*s, dtype=torch.bfloat16) * 3.2)(B, Hkv, Sk, Dh)),
            "wq": _w((lambda *s: torch.randn(*s, dtype=torch.bfloat16) * 3.2)(D, Hq * Dh) * (D ** -0.5)),
            "wo": _w((lambda *s: torch.randn(*s, dtype=torch.bfloat16) * 3.2)(Hq * Dh, D) * ((Hq * Dh) ** -0.5)),
        }
    _A_in = _A_setup()

    def _B_setup():
        B, S, D, F = 1, 2048, 512, 1792
        return {
            "x": _w((lambda *s: torch.randn(*s, dtype=torch.bfloat16) * 0.05)(B, S, D)),
            "w1": _w((lambda *s: torch.randn(*s, dtype=torch.bfloat16) * 3.2)(S, F) * (S ** -0.5)),
            "b1": _w((lambda *s: torch.randn(*s, dtype=torch.bfloat16) * 3.2)(F) * 0.02),
            "w2": _w((lambda *s: torch.randn(*s, dtype=torch.bfloat16) * 0.4)(F, S) * (F ** -0.5)),
            "b2": _w((lambda *s: torch.randn(*s, dtype=torch.bfloat16) * 0.4)(S) * 0.02),
        }
    _B_in = _B_setup()

    return {
        "A_x": _A_in["x"],
        "A_k_cache": _A_in["k_cache"],
        "A_v_cache": _A_in["v_cache"],
        "A_wq": _A_in["wq"],
        "A_wo": _A_in["wo"],
        "B_x": _B_in["x"],
        "B_w1": _B_in["w1"],
        "B_b1": _B_in["b1"],
        "B_w2": _B_in["w2"],
        "B_b2": _B_in["b2"],
    }

def reference(A_x, A_k_cache, A_v_cache, A_wq, A_wo, B_x, B_w1, B_b1, B_w2, B_b2):
    def _A_ref(x, k_cache, v_cache, wq, wo):
        B, Sq, D = x.shape
        Hq, Dh = 32, 128
        Hkv = k_cache.shape[1]
        rep = Hq // Hkv
        q = (lambda x, *d: x.permute(*d))((x @ wq).reshape(B, Sq, Hq, Dh), 0, 2, 1, 3)
        k = (lambda x, n, axis: torch.repeat_interleave(x, n, dim=axis))(k_cache, rep, axis=1)
        v = (lambda x, n, axis: torch.repeat_interleave(x, n, dim=axis))(v_cache, rep, axis=1)
        scores = torch.einsum("bhqd,bhkd->bhqk", q, k) * (Dh ** -0.5)
        p = _softmax(scores, axis=-1)
        o = torch.einsum("bhqk,bhkd->bhqd", p, v)
        return (lambda x, *d: x.permute(*d))(o, 0, 2, 1, 3).reshape(B, Sq, Hq * Dh) @ wo

    def _B_ref(x, w1, b1, w2, b2):
        B, S, D = x.shape
        h = _layernorm(x, axis=-1)
        u = torch.einsum("bsd,sf->bdf", h, w1) + b1
        u = _gelu(u)
        y = torch.einsum("bdf,fs->bds", u, w2) + b2
        return (lambda x, *d: x.permute(*d))(y, 0, 2, 1)

    x = A_x
    xn = _layernorm(x, axis=-1)
    s = _A_ref(xn, A_k_cache, A_v_cache, A_wq, A_wo)
    g = _silu(_B_ref(xn, B_w1, B_b1, B_w2, B_b2))
    return x + s * g
```

```asm
; @launch grid=(256,1,1) block=(256,1,1) lds=163840
.amdgcn_target "amdgcn-amd-amdhsa--gfx950"
.text
.globl recurrent_scan__gqa_block_cached__mixer_token_mlp__prompt_kernel
.p2align 8
.type recurrent_scan__gqa_block_cached__mixer_token_mlp__prompt_kernel,@function
recurrent_scan__gqa_block_cached__mixer_token_mlp__prompt_kernel:

    s_cmp_ge_u32 s2, 256
    s_cbranch_scc1 L_at_done
    s_load_dwordx2 s[4:5], s[0:1], 0
    s_load_dwordx2 s[12:13], s[0:1], 96
    s_load_dwordx2 s[14:15], s[0:1], 88
    v_lshrrev_b32 v1, 6, v0
    v_and_b32 v0, 63, v0
    s_and_b32 s33, s2, 7
    v_readfirstlane_b32 s42, v1
    s_lshr_b32 s32, s2, 3
    s_and_b32 s40, s33, 3
    s_lshl_b32 s40, s40, 1
    s_and_b32 s3, s32, 1
    s_add_u32 s40, s40, s3
    s_lshr_b32 s41, s33, 2
    s_lshl_b32 s41, s41, 4
    s_lshr_b32 s3, s32, 1
    s_add_u32 s41, s41, s3
    v_and_b32 v2, 15, v0
    v_lshrrev_b32 v3, 4, v0
    v_lshlrev_b32 v2, 10, v2
    v_lshl_add_u32 v2, v3, 4, v2
    s_lshl_b32 s3, s41, 16
    s_lshl_b32 s8, s42, 14
    s_add_u32 s3, s3, s8
    s_waitcnt lgkmcnt(0)
    s_mov_b32 s16, s4
    s_mov_b32 s17, s5
    s_mov_b32 s18, 2097152
    s_mov_b32 s19, 0x00020000
    buffer_load_dwordx4 v[64:67], v2, s[16:19], s3 offen offset:0
    buffer_load_dwordx4 v[68:71], v2, s[16:19], s3 offen offset:64
    buffer_load_dwordx4 v[72:75], v2, s[16:19], s3 offen offset:128
    buffer_load_dwordx4 v[76:79], v2, s[16:19], s3 offen offset:192
    buffer_load_dwordx4 v[80:83], v2, s[16:19], s3 offen offset:256
    buffer_load_dwordx4 v[84:87], v2, s[16:19], s3 offen offset:320
    buffer_load_dwordx4 v[88:91], v2, s[16:19], s3 offen offset:384
    buffer_load_dwordx4 v[92:95], v2, s[16:19], s3 offen offset:448
    buffer_load_dwordx4 v[96:99], v2, s[16:19], s3 offen offset:512
    buffer_load_dwordx4 v[100:103], v2, s[16:19], s3 offen offset:576
    buffer_load_dwordx4 v[104:107], v2, s[16:19], s3 offen offset:640
    buffer_load_dwordx4 v[108:111], v2, s[16:19], s3 offen offset:704
    buffer_load_dwordx4 v[112:115], v2, s[16:19], s3 offen offset:768
    buffer_load_dwordx4 v[116:119], v2, s[16:19], s3 offen offset:832
    buffer_load_dwordx4 v[120:123], v2, s[16:19], s3 offen offset:896
    buffer_load_dwordx4 v[124:127], v2, s[16:19], s3 offen offset:960
    s_load_dwordx2 s[16:17], s[0:1], 8
    s_load_dwordx2 s[20:21], s[0:1], 16
    s_load_dwordx2 s[8:9], s[0:1], 24
    s_load_dwordx2 s[10:11], s[0:1], 32
    s_load_dwordx2 s[56:57], s[0:1], 48
    s_load_dwordx2 s[34:35], s[0:1], 56
    s_mov_b32 s60, s12
    s_mov_b32 s61, s13
    s_mov_b32 s62, 8388608
    s_mov_b32 s63, 0x00020000
    s_mov_b32 s4, s14
    s_mov_b32 s5, s15
    s_mov_b32 s6, 256
    s_mov_b32 s7, 0x00020000
    s_cmp_ge_u32 s2, 56
    s_cbranch_scc1 L_nozero
    s_cmp_lg_u32 s42, 0
    s_cbranch_scc1 L_nozero
    s_lshl_b32 s3, s2, 8
    s_cmp_ge_u32 s2, 40
    s_cselect_b32 s14, 6144, 0
    s_add_u32 s3, s3, s14
    s_add_u32 s3, s3, 6291456
    v_mov_b32 v1, 0
    v_lshlrev_b32 v3, 2, v0
    buffer_store_dword v1, v3, s[60:63], s3 offen sc1
    s_waitcnt vmcnt(0)
    v_mov_b32 v3, 1
    v_cmp_eq_u32 vcc, 0, v0
    s_and_saveexec_b64 s[14:15], vcc
    buffer_atomic_add v3, v1, s[4:7], 0 offen
    s_mov_b64 exec, s[14:15]
L_nozero:
    s_lshl_b32 s14, s40, 19
    s_lshl_b32 s3, s40, 21
    s_add_u32 s3, s3, 8388608
    s_waitcnt lgkmcnt(0)
    s_add_u32 s16, s16, s14
    s_addc_u32 s17, s17, 0
    s_mov_b32 s18, 524288
    s_mov_b32 s19, 0x00020000
    s_add_u32 s20, s20, s14
    s_addc_u32 s21, s21, 0
    s_mov_b32 s22, 524288
    s_mov_b32 s23, 0x00020000
    s_mov_b32 s58, 7340032
    s_mov_b32 s59, 0x00020000
    s_mov_b32 s24, s8
    s_mov_b32 s25, s9
    s_mov_b32 s26, 4194304
    s_mov_b32 s27, 0x00020000
    s_mov_b32 s28, s10
    s_mov_b32 s29, s11
    s_mov_b32 s30, 4194304
    s_mov_b32 s31, 0x00020000
    s_add_u32 s36, s12, s3
    s_addc_u32 s37, s13, 0
    s_mov_b32 s38, 2097152
    s_mov_b32 s39, 0x00020000
    s_and_b32 s55, s33, 1
    s_lshl_b32 s55, s55, 2
    s_and_b32 s3, s32, 3
    s_add_u32 s55, s55, s3
    s_mov_b32 s11, s55
    s_lshr_b32 s54, s33, 1
    s_lshl_b32 s10, s54, 3
    s_mul_i32 s54, s54, 7
    s_lshr_b32 s3, s32, 2
    s_add_u32 s54, s54, s3
    s_add_u32 s10, s10, s3
    s_mov_b32 s96, s54
    s_mov_b32 s97, s55
    s_mov_b32 s98, 0
    s_lshl_b32 s14, s42, 6
    v_add_u32 v1, s14, v0
    v_lshrrev_b32 v2, 4, v1
    v_and_b32 v3, 15, v1
    v_lshlrev_b32 v2, 13, v2
    v_lshl_add_u32 v250, v3, 6, v2
    v_lshlrev_b32 v251, 6, v1
    v_lshrrev_b32 v1, 4, v0
    v_and_b32 v2, 15, v0
    v_lshlrev_b32 v3, 2, v1
    v_xor_b32 v3, v2, v3
    v_lshlrev_b32 v3, 4, v3
    v_lshl_add_u32 v238, v1, 8, v3
    v_lshl_add_u32 v245, v1, 13, v3
    v_add_u32 v4, 0, v1
    v_xor_b32 v4, v2, v4
    v_lshlrev_b32 v4, 4, v4
    v_lshl_add_u32 v234, v1, 8, v4
    v_add_u32 v4, 4, v1
    v_xor_b32 v4, v2, v4
    v_lshlrev_b32 v4, 4, v4
    v_lshl_add_u32 v235, v1, 8, v4
    v_add_u32 v4, 8, v1
    v_xor_b32 v4, v2, v4
    v_lshlrev_b32 v4, 4, v4
    v_lshl_add_u32 v236, v1, 8, v4
    v_add_u32 v4, 12, v1
    v_xor_b32 v4, v2, v4
    v_lshlrev_b32 v4, 4, v4
    v_lshl_add_u32 v237, v1, 8, v4
    v_and_b32 v4, 31, v0
    v_lshrrev_b32 v5, 5, v0
    v_xor_b32 v6, v5, v2
    v_lshlrev_b32 v7, 8, v4
    v_xor_b32 v8, 0, v6
    v_lshl_add_u32 v222, v8, 4, v7
    v_xor_b32 v8, 2, v6
    v_lshl_add_u32 v223, v8, 4, v7
    v_xor_b32 v8, 4, v6
    v_lshl_add_u32 v224, v8, 4, v7
    v_xor_b32 v8, 6, v6
    v_lshl_add_u32 v225, v8, 4, v7
    v_xor_b32 v8, 8, v6
    v_lshl_add_u32 v226, v8, 4, v7
    v_xor_b32 v8, 10, v6
    v_lshl_add_u32 v227, v8, 4, v7
    v_xor_b32 v8, 12, v6
    v_lshl_add_u32 v228, v8, 4, v7
    v_xor_b32 v8, 14, v6
    v_lshl_add_u32 v229, v8, 4, v7
    v_bfe_u32 v8, v0, 2, 2
    v_bfe_u32 v9, v0, 4, 1
    v_and_b32 v10, 3, v0
    v_lshl_add_u32 v11, v5, 2, v8
    v_lshlrev_b32 v11, 8, v11
    v_lshl_add_u32 v11, v9, 5, v11
    v_lshl_add_u32 v12, v10, 3, v11
    v_xor_b32 v13, 0, v8
    v_lshl_add_u32 v13, v13, 6, v12
    v_add_u32 v230, 65536, v13
    v_xor_b32 v13, 1, v8
    v_lshl_add_u32 v13, v13, 6, v12
    v_add_u32 v231, 65536, v13
    v_xor_b32 v13, 2, v8
    v_lshl_add_u32 v13, v13, 6, v12
    v_add_u32 v232, 65536, v13
    v_xor_b32 v13, 3, v8
    v_lshl_add_u32 v13, v13, 6, v12
    v_add_u32 v233, 65536, v13
    s_and_b32 s14, s42, 1
    s_lshl_b32 s14, s14, 14
    s_lshr_b32 s15, s42, 1
    s_mul_i32 s15, s15, 98304
    s_add_u32 s48, s14, s15
    s_add_u32 s48, s48, 32768
    v_lshl_add_u32 v11, v5, 3, v8
    v_lshlrev_b32 v11, 8, v11
    v_lshl_add_u32 v11, v9, 5, v11
    v_and_b32 v13, 1, v10
    v_lshrrev_b32 v14, 1, v10
    v_lshl_or_b32 v13, v13, 1, v14
    v_lshl_add_u32 v11, v13, 3, v11
    v_add_u32 v11, s48, v11
    v_xor_b32 v13, 0, v8
    v_lshl_add_u32 v240, v13, 6, v11
    v_xor_b32 v13, 1, v8
    v_lshl_add_u32 v241, v13, 6, v11
    v_xor_b32 v13, 2, v8
    v_lshl_add_u32 v242, v13, 6, v11
    v_xor_b32 v13, 3, v8
    v_lshl_add_u32 v243, v13, 6, v11
    v_lshlrev_b32 v15, 4, v0
    v_add_u32 v244, 65536, v15
    s_lshr_b32 s14, s32, 1
    s_lshl_b32 s14, s14, 18
    s_lshl_b32 s15, s40, 10
    s_add_u32 s14, s14, s15
    s_and_b32 s14, s42, 1
    s_lshl_b32 s14, s14, 14
    s_lshr_b32 s15, s42, 1
    s_mul_i32 s15, s15, 98304
    s_add_u32 s48, s14, s15
    s_add_u32 s48, s48, 32768
    s_lshl_b32 s14, s40, 2
    s_add_u32 s14, s14, s42
    s_lshl_b32 s47, s14, 8
    s_lshl_b32 s43, s42, 12
    s_mov_b32 s45, s43
    s_add_u32 s46, s43, 65536
    s_mov_b32 s44, s43
    s_waitcnt vmcnt(15)
    s_lshr_b32 s12, s32, 1
    s_lshl_b32 s12, s12, 18
    s_lshl_b32 s13, s40, 10
    s_add_u32 s12, s12, s13
    buffer_load_dword v246, v250, s[24:27], s12 offen
    s_add_u32 s12, s12, 131072
    buffer_load_dword v247, v250, s[24:27], s12 offen
    v_lshlrev_b32 v132, 16, v64
    v_and_b32 v133, 0xffff0000, v64
    v_lshlrev_b32 v134, 16, v65
    v_and_b32 v135, 0xffff0000, v65
    v_lshlrev_b32 v136, 16, v66
    v_and_b32 v137, 0xffff0000, v66
    v_lshlrev_b32 v138, 16, v67
    v_and_b32 v139, 0xffff0000, v67
    v_pk_mul_f32 v[130:131], v[132:133], v[132:133]
    v_mov_b32 v128, v132
    v_mov_b32 v129, v133
    v_pk_add_f32 v[128:129], v[128:129], v[134:135]
    v_pk_fma_f32 v[130:131], v[134:135], v[134:135], v[130:131]
    v_pk_add_f32 v[128:129], v[128:129], v[136:137]
    v_pk_fma_f32 v[130:131], v[136:137], v[136:137], v[130:131]
    v_pk_add_f32 v[128:129], v[128:129], v[138:139]
    v_pk_fma_f32 v[130:131], v[138:139], v[138:139], v[130:131]
    s_waitcnt vmcnt(16)
    v_lshlrev_b32 v132, 16, v68
    v_and_b32 v133, 0xffff0000, v68
    v_lshlrev_b32 v134, 16, v69
    v_and_b32 v135, 0xffff0000, v69
    v_lshlrev_b32 v136, 16, v70
    v_and_b32 v137, 0xffff0000, v70
    v_lshlrev_b32 v138, 16, v71
    v_and_b32 v139, 0xffff0000, v71
    v_pk_add_f32 v[128:129], v[128:129], v[132:133]
    v_pk_fma_f32 v[130:131], v[132:133], v[132:133], v[130:131]
    v_pk_add_f32 v[128:129], v[128:129], v[134:135]
    v_pk_fma_f32 v[130:131], v[134:135], v[134:135], v[130:131]
    v_pk_add_f32 v[128:129], v[128:129], v[136:137]
    v_pk_fma_f32 v[130:131], v[136:137], v[136:137], v[130:131]
    v_pk_add_f32 v[128:129], v[128:129], v[138:139]
    v_pk_fma_f32 v[130:131], v[138:139], v[138:139], v[130:131]
    s_waitcnt vmcnt(15)
    v_lshlrev_b32 v132, 16, v72
    v_and_b32 v133, 0xffff0000, v72
    v_lshlrev_b32 v134, 16, v73
    v_and_b32 v135, 0xffff0000, v73
    v_lshlrev_b32 v136, 16, v74
    v_and_b32 v137, 0xffff0000, v74
    v_lshlrev_b32 v138, 16, v75
    v_and_b32 v139, 0xffff0000, v75
    v_pk_add_f32 v[128:129], v[128:129], v[132:133]
    v_pk_fma_f32 v[130:131], v[132:133], v[132:133], v[130:131]
    v_pk_add_f32 v[128:129], v[128:129], v[134:135]
    v_pk_fma_f32 v[130:131], v[134:135], v[134:135], v[130:131]
    v_pk_add_f32 v[128:129], v[128:129], v[136:137]
    v_pk_fma_f32 v[130:131], v[136:137], v[136:137], v[130:131]
    v_pk_add_f32 v[128:129], v[128:129], v[138:139]
    v_pk_fma_f32 v[130:131], v[138:139], v[138:139], v[130:131]
    s_waitcnt vmcnt(14)
    v_lshlrev_b32 v132, 16, v76
    v_and_b32 v133, 0xffff0000, v76
    v_lshlrev_b32 v134, 16, v77
    v_and_b32 v135, 0xffff0000, v77
    v_lshlrev_b32 v136, 16, v78
    v_and_b32 v137, 0xffff0000, v78
    v_lshlrev_b32 v138, 16, v79
    v_and_b32 v139, 0xffff0000, v79
    v_pk_add_f32 v[128:129], v[128:129], v[132:133]
    v_pk_fma_f32 v[130:131], v[132:133], v[132:133], v[130:131]
    v_pk_add_f32 v[128:129], v[128:129], v[134:135]
    v_pk_fma_f32 v[130:131], v[134:135], v[134:135], v[130:131]
    v_pk_add_f32 v[128:129], v[128:129], v[136:137]
    v_pk_fma_f32 v[130:131], v[136:137], v[136:137], v[130:131]
    v_pk_add_f32 v[128:129], v[128:129], v[138:139]
    v_pk_fma_f32 v[130:131], v[138:139], v[138:139], v[130:131]
    s_waitcnt vmcnt(13)
    v_lshlrev_b32 v132, 16, v80
    v_and_b32 v133, 0xffff0000, v80
    v_lshlrev_b32 v134, 16, v81
    v_and_b32 v135, 0xffff0000, v81
    v_lshlrev_b32 v136, 16, v82
    v_and_b32 v137, 0xffff0000, v82
    v_lshlrev_b32 v138, 16, v83
    v_and_b32 v139, 0xffff0000, v83
    v_pk_add_f32 v[128:129], v[128:129], v[132:133]
    v_pk_fma_f32 v[130:131], v[132:133], v[132:133], v[130:131]
    v_pk_add_f32 v[128:129], v[128:129], v[134:135]
    v_pk_fma_f32 v[130:131], v[134:135], v[134:135], v[130:131]
    v_pk_add_f32 v[128:129], v[128:129], v[136:137]
    v_pk_fma_f32 v[130:131], v[136:137], v[136:137], v[130:131]
    v_pk_add_f32 v[128:129], v[128:129], v[138:139]
    v_pk_fma_f32 v[130:131], v[138:139], v[138:139], v[130:131]
    s_waitcnt vmcnt(12)
    v_lshlrev_b32 v132, 16, v84
    v_and_b32 v133, 0xffff0000, v84
    v_lshlrev_b32 v134, 16, v85
    v_and_b32 v135, 0xffff0000, v85
    v_lshlrev_b32 v136, 16, v86
    v_and_b32 v137, 0xffff0000, v86
    v_lshlrev_b32 v138, 16, v87
    v_and_b32 v139, 0xffff0000, v87
    v_pk_add_f32 v[128:129], v[128:129], v[132:133]
    v_pk_fma_f32 v[130:131], v[132:133], v[132:133], v[130:131]
    v_pk_add_f32 v[128:129], v[128:129], v[134:135]
    v_pk_fma_f32 v[130:131], v[134:135], v[134:135], v[130:131]
    v_pk_add_f32 v[128:129], v[128:129], v[136:137]
    v_pk_fma_f32 v[130:131], v[136:137], v[136:137], v[130:131]
    v_pk_add_f32 v[128:129], v[128:129], v[138:139]
    v_pk_fma_f32 v[130:131], v[138:139], v[138:139], v[130:131]
    s_waitcnt vmcnt(11)
    v_lshlrev_b32 v132, 16, v88
    v_and_b32 v133, 0xffff0000, v88
    v_lshlrev_b32 v134, 16, v89
    v_and_b32 v135, 0xffff0000, v89
    v_lshlrev_b32 v136, 16, v90
    v_and_b32 v137, 0xffff0000, v90
    v_lshlrev_b32 v138, 16, v91
    v_and_b32 v139, 0xffff0000, v91
    v_pk_add_f32 v[128:129], v[128:129], v[132:133]
    v_pk_fma_f32 v[130:131], v[132:133], v[132:133], v[130:131]
    v_pk_add_f32 v[128:129], v[128:129], v[134:135]
    v_pk_fma_f32 v[130:131], v[134:135], v[134:135], v[130:131]
    v_pk_add_f32 v[128:129], v[128:129], v[136:137]
    v_pk_fma_f32 v[130:131], v[136:137], v[136:137], v[130:131]
    v_pk_add_f32 v[128:129], v[128:129], v[138:139]
    v_pk_fma_f32 v[130:131], v[138:139], v[138:139], v[130:131]
    s_waitcnt vmcnt(10)
    v_lshlrev_b32 v132, 16, v92
    v_and_b32 v133, 0xffff0000, v92
    v_lshlrev_b32 v134, 16, v93
    v_and_b32 v135, 0xffff0000, v93
    v_lshlrev_b32 v136, 16, v94
    v_and_b32 v137, 0xffff0000, v94
    v_lshlrev_b32 v138, 16, v95
    v_and_b32 v139, 0xffff0000, v95
    v_pk_add_f32 v[128:129], v[128:129], v[132:133]
    v_pk_fma_f32 v[130:131], v[132:133], v[132:133], v[130:131]
    v_pk_add_f32 v[128:129], v[128:129], v[134:135]
    v_pk_fma_f32 v[130:131], v[134:135], v[134:135], v[130:131]
    v_pk_add_f32 v[128:129], v[128:129], v[136:137]
    v_pk_fma_f32 v[130:131], v[136:137], v[136:137], v[130:131]
    v_pk_add_f32 v[128:129], v[128:129], v[138:139]
    v_pk_fma_f32 v[130:131], v[138:139], v[138:139], v[130:131]
    s_waitcnt vmcnt(9)
    v_lshlrev_b32 v132, 16, v96
    v_and_b32 v133, 0xffff0000, v96
    v_lshlrev_b32 v134, 16, v97
    v_and_b32 v135, 0xffff0000, v97
    v_lshlrev_b32 v136, 16, v98
    v_and_b32 v137, 0xffff0000, v98
    v_lshlrev_b32 v138, 16, v99
    v_and_b32 v139, 0xffff0000, v99
    v_pk_add_f32 v[128:129], v[128:129], v[132:133]
    v_pk_fma_f32 v[130:131], v[132:133], v[132:133], v[130:131]
    v_pk_add_f32 v[128:129], v[128:129], v[134:135]
    v_pk_fma_f32 v[130:131], v[134:135], v[134:135], v[130:131]
    v_pk_add_f32 v[128:129], v[128:129], v[136:137]
    v_pk_fma_f32 v[130:131], v[136:137], v[136:137], v[130:131]
    v_pk_add_f32 v[128:129], v[128:129], v[138:139]
    v_pk_fma_f32 v[130:131], v[138:139], v[138:139], v[130:131]
    s_waitcnt vmcnt(8)
    v_lshlrev_b32 v132, 16, v100
    v_and_b32 v133, 0xffff0000, v100
    v_lshlrev_b32 v134, 16, v101
    v_and_b32 v135, 0xffff0000, v101
    v_lshlrev_b32 v136, 16, v102
    v_and_b32 v137, 0xffff0000, v102
    v_lshlrev_b32 v138, 16, v103
    v_and_b32 v139, 0xffff0000, v103
    v_pk_add_f32 v[128:129], v[128:129], v[132:133]
    v_pk_fma_f32 v[130:131], v[132:133], v[132:133], v[130:131]
    v_pk_add_f32 v[128:129], v[128:129], v[134:135]
    v_pk_fma_f32 v[130:131], v[134:135], v[134:135], v[130:131]
    v_pk_add_f32 v[128:129], v[128:129], v[136:137]
    v_pk_fma_f32 v[130:131], v[136:137], v[136:137], v[130:131]
    v_pk_add_f32 v[128:129], v[128:129], v[138:139]
    v_pk_fma_f32 v[130:131], v[138:139], v[138:139], v[130:131]
    s_waitcnt vmcnt(7)
    v_lshlrev_b32 v132, 16, v104
    v_and_b32 v133, 0xffff0000, v104
    v_lshlrev_b32 v134, 16, v105
    v_and_b32 v135, 0xffff0000, v105
    v_lshlrev_b32 v136, 16, v106
    v_and_b32 v137, 0xffff0000, v106
    v_lshlrev_b32 v138, 16, v107
    v_and_b32 v139, 0xffff0000, v107
    v_pk_add_f32 v[128:129], v[128:129], v[132:133]
    v_pk_fma_f32 v[130:131], v[132:133], v[132:133], v[130:131]
    v_pk_add_f32 v[128:129], v[128:129], v[134:135]
    v_pk_fma_f32 v[130:131], v[134:135], v[134:135], v[130:131]
    v_pk_add_f32 v[128:129], v[128:129], v[136:137]
    v_pk_fma_f32 v[130:131], v[136:137], v[136:137], v[130:131]
    v_pk_add_f32 v[128:129], v[128:129], v[138:139]
    v_pk_fma_f32 v[130:131], v[138:139], v[138:139], v[130:131]
    s_waitcnt vmcnt(6)
    v_lshlrev_b32 v132, 16, v108
    v_and_b32 v133, 0xffff0000, v108
    v_lshlrev_b32 v134, 16, v109
    v_and_b32 v135, 0xffff0000, v109
    v_lshlrev_b32 v136, 16, v110
    v_and_b32 v137, 0xffff0000, v110
    v_lshlrev_b32 v138, 16, v111
    v_and_b32 v139, 0xffff0000, v111
    v_pk_add_f32 v[128:129], v[128:129], v[132:133]
    v_pk_fma_f32 v[130:131], v[132:133], v[132:133], v[130:131]
    v_pk_add_f32 v[128:129], v[128:129], v[134:135]
    v_pk_fma_f32 v[130:131], v[134:135], v[134:135], v[130:131]
    v_pk_add_f32 v[128:129], v[128:129], v[136:137]
    v_pk_fma_f32 v[130:131], v[136:137], v[136:137], v[130:131]
    v_pk_add_f32 v[128:129], v[128:129], v[138:139]
    v_pk_fma_f32 v[130:131], v[138:139], v[138:139], v[130:131]
    s_waitcnt vmcnt(5)
    v_lshlrev_b32 v132, 16, v112
    v_and_b32 v133, 0xffff0000, v112
    v_lshlrev_b32 v134, 16, v113
    v_and_b32 v135, 0xffff0000, v113
    v_lshlrev_b32 v136, 16, v114
    v_and_b32 v137, 0xffff0000, v114
    v_lshlrev_b32 v138, 16, v115
    v_and_b32 v139, 0xffff0000, v115
    v_pk_add_f32 v[128:129], v[128:129], v[132:133]
    v_pk_fma_f32 v[130:131], v[132:133], v[132:133], v[130:131]
    v_pk_add_f32 v[128:129], v[128:129], v[134:135]
    v_pk_fma_f32 v[130:131], v[134:135], v[134:135], v[130:131]
    v_pk_add_f32 v[128:129], v[128:129], v[136:137]
    v_pk_fma_f32 v[130:131], v[136:137], v[136:137], v[130:131]
    v_pk_add_f32 v[128:129], v[128:129], v[138:139]
    v_pk_fma_f32 v[130:131], v[138:139], v[138:139], v[130:131]
    s_waitcnt vmcnt(4)
    v_lshlrev_b32 v132, 16, v116
    v_and_b32 v133, 0xffff0000, v116
    v_lshlrev_b32 v134, 16, v117
    v_and_b32 v135, 0xffff0000, v117
    v_lshlrev_b32 v136, 16, v118
    v_and_b32 v137, 0xffff0000, v118
    v_lshlrev_b32 v138, 16, v119
    v_and_b32 v139, 0xffff0000, v119
    v_pk_add_f32 v[128:129], v[128:129], v[132:133]
    v_pk_fma_f32 v[130:131], v[132:133], v[132:133], v[130:131]
    v_pk_add_f32 v[128:129], v[128:129], v[134:135]
    v_pk_fma_f32 v[130:131], v[134:135], v[134:135], v[130:131]
    v_pk_add_f32 v[128:129], v[128:129], v[136:137]
    v_pk_fma_f32 v[130:131], v[136:137], v[136:137], v[130:131]
    v_pk_add_f32 v[128:129], v[128:129], v[138:139]
    v_pk_fma_f32 v[130:131], v[138:139], v[138:139], v[130:131]
    s_waitcnt vmcnt(3)
    v_lshlrev_b32 v132, 16, v120
    v_and_b32 v133, 0xffff0000, v120
    v_lshlrev_b32 v134, 16, v121
    v_and_b32 v135, 0xffff0000, v121
    v_lshlrev_b32 v136, 16, v122
    v_and_b32 v137, 0xffff0000, v122
    v_lshlrev_b32 v138, 16, v123
    v_and_b32 v139, 0xffff0000, v123
    v_pk_add_f32 v[128:129], v[128:129], v[132:133]
    v_pk_fma_f32 v[130:131], v[132:133], v[132:133], v[130:131]
    v_pk_add_f32 v[128:129], v[128:129], v[134:135]
    v_pk_fma_f32 v[130:131], v[134:135], v[134:135], v[130:131]
    v_pk_add_f32 v[128:129], v[128:129], v[136:137]
    v_pk_fma_f32 v[130:131], v[136:137], v[136:137], v[130:131]
    v_pk_add_f32 v[128:129], v[128:129], v[138:139]
    v_pk_fma_f32 v[130:131], v[138:139], v[138:139], v[130:131]
    s_waitcnt vmcnt(2)
    v_lshlrev_b32 v132, 16, v124
    v_and_b32 v133, 0xffff0000, v124
    v_lshlrev_b32 v134, 16, v125
    v_and_b32 v135, 0xffff0000, v125
    v_lshlrev_b32 v136, 16, v126
    v_and_b32 v137, 0xffff0000, v126
    v_lshlrev_b32 v138, 16, v127
    v_and_b32 v139, 0xffff0000, v127
    v_pk_add_f32 v[128:129], v[128:129], v[132:133]
    v_pk_fma_f32 v[130:131], v[132:133], v[132:133], v[130:131]
    v_pk_add_f32 v[128:129], v[128:129], v[134:135]
    v_pk_fma_f32 v[130:131], v[134:135], v[134:135], v[130:131]
    v_pk_add_f32 v[128:129], v[128:129], v[136:137]
    v_pk_fma_f32 v[130:131], v[136:137], v[136:137], v[130:131]
    v_pk_add_f32 v[128:129], v[128:129], v[138:139]
    v_pk_fma_f32 v[130:131], v[138:139], v[138:139], v[130:131]
    v_add_f32 v140, v128, v129
    v_add_f32 v141, v130, v131
    v_mov_b32 v142, v140
    v_mov_b32 v143, v141
    s_nop 1
    v_permlane16_swap_b32 v142, v140
    v_permlane16_swap_b32 v143, v141
    v_add_f32 v140, v140, v142
    v_add_f32 v141, v141, v143
    v_mov_b32 v142, v140
    v_mov_b32 v143, v141
    s_nop 1
    v_permlane32_swap_b32 v142, v140
    v_permlane32_swap_b32 v143, v141
    v_add_f32 v140, v140, v142
    v_add_f32 v141, v141, v143
    v_mul_f32 v140, 0x3b000000, v140
    v_mul_f32 v141, 0x3b000000, v141
    v_fma_f32 v141, -v140, v140, v141
    v_max_f32 v141, 0, v141
    v_cvt_pk_bf16_f32 v144, v140, v140
    v_lshlrev_b32 v144, 16, v144
    v_mov_b32 v145, v144
    v_cvt_pk_bf16_f32 v141, v141, v141
    v_lshlrev_b32 v141, 16, v141
    v_add_f32 v141, 0x3727c5ac, v141
    v_cvt_pk_bf16_f32 v141, v141, v141
    v_lshlrev_b32 v141, 16, v141
    v_sqrt_f32 v141, v141
    s_nop 0
    v_cvt_pk_bf16_f32 v141, v141, v141
    v_lshlrev_b32 v141, 16, v141
    v_rcp_f32 v146, v141
    s_nop 0
    v_fma_f32 v142, -v141, v146, 1.0
    v_fma_f32 v146, v142, v146, v146
    v_mov_b32 v147, v146
    v_lshrrev_b32 v1, 4, v0
    v_and_b32 v2, 15, v0
    v_lshrrev_b32 v3, 1, v1
    v_lshlrev_b32 v3, 11, v3
    v_and_b32 v4, 1, v1
    v_lshl_add_u32 v3, v4, 9, v3
    v_lshl_add_u32 v3, v2, 4, v3
    s_lshr_b32 s3, s42, 1
    s_lshl_b32 s3, s3, 10
    s_and_b32 s14, s42, 1
    s_lshl_b32 s14, s14, 8
    s_add_u32 s3, s3, s14
    s_add_u32 s3, s3, 65536
    v_add_u32 v3, s3, v3
    v_mul_f32 v144, v144, v146
    v_sub_f32 v144, 0, v144
    v_mov_b32 v145, v144
    v_lshlrev_b32 v132, 16, v64
    v_and_b32 v133, 0xffff0000, v64
    v_lshlrev_b32 v134, 16, v65
    v_and_b32 v135, 0xffff0000, v65
    v_lshlrev_b32 v136, 16, v66
    v_and_b32 v137, 0xffff0000, v66
    v_lshlrev_b32 v138, 16, v67
    v_and_b32 v139, 0xffff0000, v67
    v_pk_fma_f32 v[132:133], v[132:133], v[146:147], v[144:145]
    v_pk_fma_f32 v[134:135], v[134:135], v[146:147], v[144:145]
    v_pk_fma_f32 v[136:137], v[136:137], v[146:147], v[144:145]
    v_pk_fma_f32 v[138:139], v[138:139], v[146:147], v[144:145]
    v_cvt_pk_bf16_f32 v148, v132, v133
    v_cvt_pk_bf16_f32 v149, v134, v135
    v_cvt_pk_bf16_f32 v150, v136, v137
    v_cvt_pk_bf16_f32 v151, v138, v139
    ds_write_b128 v3, v[148:151] offset:0
    s_add_u32 m0, s48, 0
    s_nop 0
    buffer_load_dwordx4 v245, s[24:27], s47 offen lds
    v_lshlrev_b32 v132, 16, v68
    v_and_b32 v133, 0xffff0000, v68
    v_lshlrev_b32 v134, 16, v69
    v_and_b32 v135, 0xffff0000, v69
    v_lshlrev_b32 v136, 16, v70
    v_and_b32 v137, 0xffff0000, v70
    v_lshlrev_b32 v138, 16, v71
    v_and_b32 v139, 0xffff0000, v71
    v_pk_fma_f32 v[132:133], v[132:133], v[146:147], v[144:145]
    v_pk_fma_f32 v[134:135], v[134:135], v[146:147], v[144:145]
    v_pk_fma_f32 v[136:137], v[136:137], v[146:147], v[144:145]
    v_pk_fma_f32 v[138:139], v[138:139], v[146:147], v[144:145]
    v_cvt_pk_bf16_f32 v152, v132, v133
    v_cvt_pk_bf16_f32 v153, v134, v135
    v_cvt_pk_bf16_f32 v154, v136, v137
    v_cvt_pk_bf16_f32 v155, v138, v139
    ds_write_b128 v3, v[152:155] offset:4096
    s_add_u32 s47, s47, 31744
    buffer_load_dwordx4 v245, s[24:27], s47 offen offset:1024 lds
    v_lshlrev_b32 v132, 16, v72
    v_and_b32 v133, 0xffff0000, v72
    v_lshlrev_b32 v134, 16, v73
    v_and_b32 v135, 0xffff0000, v73
    v_lshlrev_b32 v136, 16, v74
    v_and_b32 v137, 0xffff0000, v74
    v_lshlrev_b32 v138, 16, v75
    v_and_b32 v139, 0xffff0000, v75
    v_pk_fma_f32 v[132:133], v[132:133], v[146:147], v[144:145]
    v_pk_fma_f32 v[134:135], v[134:135], v[146:147], v[144:145]
    v_pk_fma_f32 v[136:137], v[136:137], v[146:147], v[144:145]
    v_pk_fma_f32 v[138:139], v[138:139], v[146:147], v[144:145]
    v_cvt_pk_bf16_f32 v148, v132, v133
    v_cvt_pk_bf16_f32 v149, v134, v135
    v_cvt_pk_bf16_f32 v150, v136, v137
    v_cvt_pk_bf16_f32 v151, v138, v139
    ds_write_b128 v3, v[148:151] offset:8192
    s_add_u32 s47, s47, 31744
    buffer_load_dwordx4 v245, s[24:27], s47 offen offset:2048 lds
    v_lshlrev_b32 v132, 16, v76
    v_and_b32 v133, 0xffff0000, v76
    v_lshlrev_b32 v134, 16, v77
    v_and_b32 v135, 0xffff0000, v77
    v_lshlrev_b32 v136, 16, v78
    v_and_b32 v137, 0xffff0000, v78
    v_lshlrev_b32 v138, 16, v79
    v_and_b32 v139, 0xffff0000, v79
    v_pk_fma_f32 v[132:133], v[132:133], v[146:147], v[144:145]
    v_pk_fma_f32 v[134:135], v[134:135], v[146:147], v[144:145]
    v_pk_fma_f32 v[136:137], v[136:137], v[146:147], v[144:145]
    v_pk_fma_f32 v[138:139], v[138:139], v[146:147], v[144:145]
    v_cvt_pk_bf16_f32 v152, v132, v133
    v_cvt_pk_bf16_f32 v153, v134, v135
    v_cvt_pk_bf16_f32 v154, v136, v137
    v_cvt_pk_bf16_f32 v155, v138, v139
    ds_write_b128 v3, v[152:155] offset:12288
    s_add_u32 s47, s47, 31744
    buffer_load_dwordx4 v245, s[24:27], s47 offen offset:3072 lds
    v_lshlrev_b32 v132, 16, v80
    v_and_b32 v133, 0xffff0000, v80
    v_lshlrev_b32 v134, 16, v81
    v_and_b32 v135, 0xffff0000, v81
    v_lshlrev_b32 v136, 16, v82
    v_and_b32 v137, 0xffff0000, v82
    v_lshlrev_b32 v138, 16, v83
    v_and_b32 v139, 0xffff0000, v83
    v_pk_fma_f32 v[132:133], v[132:133], v[146:147], v[144:145]
    v_pk_fma_f32 v[134:135], v[134:135], v[146:147], v[144:145]
    v_pk_fma_f32 v[136:137], v[136:137], v[146:147], v[144:145]
    v_pk_fma_f32 v[138:139], v[138:139], v[146:147], v[144:145]
    v_cvt_pk_bf16_f32 v148, v132, v133
    v_cvt_pk_bf16_f32 v149, v134, v135
    v_cvt_pk_bf16_f32 v150, v136, v137
    v_cvt_pk_bf16_f32 v151, v138, v139
    ds_write_b128 v3, v[148:151] offset:16384
    s_add_u32 s47, s47, 35840
    s_add_u32 m0, s48, 4096
    s_nop 0
    buffer_load_dwordx4 v245, s[24:27], s47 offen lds
    v_lshlrev_b32 v132, 16, v84
    v_and_b32 v133, 0xffff0000, v84
    v_lshlrev_b32 v134, 16, v85
    v_and_b32 v135, 0xffff0000, v85
    v_lshlrev_b32 v136, 16, v86
    v_and_b32 v137, 0xffff0000, v86
    v_lshlrev_b32 v138, 16, v87
    v_and_b32 v139, 0xffff0000, v87
    v_pk_fma_f32 v[132:133], v[132:133], v[146:147], v[144:145]
    v_pk_fma_f32 v[134:135], v[134:135], v[146:147], v[144:145]
    v_pk_fma_f32 v[136:137], v[136:137], v[146:147], v[144:145]
    v_pk_fma_f32 v[138:139], v[138:139], v[146:147], v[144:145]
    v_cvt_pk_bf16_f32 v152, v132, v133
    v_cvt_pk_bf16_f32 v153, v134, v135
    v_cvt_pk_bf16_f32 v154, v136, v137
    v_cvt_pk_bf16_f32 v155, v138, v139
    ds_write_b128 v3, v[152:155] offset:20480
    s_add_u32 s47, s47, 31744
    buffer_load_dwordx4 v245, s[24:27], s47 offen offset:1024 lds
    v_lshlrev_b32 v132, 16, v88
    v_and_b32 v133, 0xffff0000, v88
    v_lshlrev_b32 v134, 16, v89
    v_and_b32 v135, 0xffff0000, v89
    v_lshlrev_b32 v136, 16, v90
    v_and_b32 v137, 0xffff0000, v90
    v_lshlrev_b32 v138, 16, v91
    v_and_b32 v139, 0xffff0000, v91
    v_pk_fma_f32 v[132:133], v[132:133], v[146:147], v[144:145]
    v_pk_fma_f32 v[134:135], v[134:135], v[146:147], v[144:145]
    v_pk_fma_f32 v[136:137], v[136:137], v[146:147], v[144:145]
    v_pk_fma_f32 v[138:139], v[138:139], v[146:147], v[144:145]
    v_cvt_pk_bf16_f32 v148, v132, v133
    v_cvt_pk_bf16_f32 v149, v134, v135
    v_cvt_pk_bf16_f32 v150, v136, v137
    v_cvt_pk_bf16_f32 v151, v138, v139
    ds_write_b128 v3, v[148:151] offset:24576
    s_add_u32 s47, s47, 31744
    buffer_load_dwordx4 v245, s[24:27], s47 offen offset:2048 lds
    v_lshlrev_b32 v132, 16, v92
    v_and_b32 v133, 0xffff0000, v92
    v_lshlrev_b32 v134, 16, v93
    v_and_b32 v135, 0xffff0000, v93
    v_lshlrev_b32 v136, 16, v94
    v_and_b32 v137, 0xffff0000, v94
    v_lshlrev_b32 v138, 16, v95
    v_and_b32 v139, 0xffff0000, v95
    v_pk_fma_f32 v[132:133], v[132:133], v[146:147], v[144:145]
    v_pk_fma_f32 v[134:135], v[134:135], v[146:147], v[144:145]
    v_pk_fma_f32 v[136:137], v[136:137], v[146:147], v[144:145]
    v_pk_fma_f32 v[138:139], v[138:139], v[146:147], v[144:145]
    v_cvt_pk_bf16_f32 v152, v132, v133
    v_cvt_pk_bf16_f32 v153, v134, v135
    v_cvt_pk_bf16_f32 v154, v136, v137
    v_cvt_pk_bf16_f32 v155, v138, v139
    ds_write_b128 v3, v[152:155] offset:28672
    s_add_u32 s47, s47, 31744
    buffer_load_dwordx4 v245, s[24:27], s47 offen offset:3072 lds
    v_lshlrev_b32 v132, 16, v96
    v_and_b32 v133, 0xffff0000, v96
    v_lshlrev_b32 v134, 16, v97
    v_and_b32 v135, 0xffff0000, v97
    v_lshlrev_b32 v136, 16, v98
    v_and_b32 v137, 0xffff0000, v98
    v_lshlrev_b32 v138, 16, v99
    v_and_b32 v139, 0xffff0000, v99
    v_pk_fma_f32 v[132:133], v[132:133], v[146:147], v[144:145]
    v_pk_fma_f32 v[134:135], v[134:135], v[146:147], v[144:145]
    v_pk_fma_f32 v[136:137], v[136:137], v[146:147], v[144:145]
    v_pk_fma_f32 v[138:139], v[138:139], v[146:147], v[144:145]
    v_cvt_pk_bf16_f32 v148, v132, v133
    v_cvt_pk_bf16_f32 v149, v134, v135
    v_cvt_pk_bf16_f32 v150, v136, v137
    v_cvt_pk_bf16_f32 v151, v138, v139
    ds_write_b128 v3, v[148:151] offset:32768
    s_add_u32 s47, s47, 35840
    s_add_u32 m0, s48, 8192
    s_nop 0
    buffer_load_dwordx4 v245, s[24:27], s47 offen lds
    v_lshlrev_b32 v132, 16, v100
    v_and_b32 v133, 0xffff0000, v100
    v_lshlrev_b32 v134, 16, v101
    v_and_b32 v135, 0xffff0000, v101
    v_lshlrev_b32 v136, 16, v102
    v_and_b32 v137, 0xffff0000, v102
    v_lshlrev_b32 v138, 16, v103
    v_and_b32 v139, 0xffff0000, v103
    v_pk_fma_f32 v[132:133], v[132:133], v[146:147], v[144:145]
    v_pk_fma_f32 v[134:135], v[134:135], v[146:147], v[144:145]
    v_pk_fma_f32 v[136:137], v[136:137], v[146:147], v[144:145]
    v_pk_fma_f32 v[138:139], v[138:139], v[146:147], v[144:145]
    v_cvt_pk_bf16_f32 v152, v132, v133
    v_cvt_pk_bf16_f32 v153, v134, v135
    v_cvt_pk_bf16_f32 v154, v136, v137
    v_cvt_pk_bf16_f32 v155, v138, v139
    ds_write_b128 v3, v[152:155] offset:36864
    s_add_u32 s47, s47, 31744
    buffer_load_dwordx4 v245, s[24:27], s47 offen offset:1024 lds
    v_lshlrev_b32 v132, 16, v104
    v_and_b32 v133, 0xffff0000, v104
    v_lshlrev_b32 v134, 16, v105
    v_and_b32 v135, 0xffff0000, v105
    v_lshlrev_b32 v136, 16, v106
    v_and_b32 v137, 0xffff0000, v106
    v_lshlrev_b32 v138, 16, v107
    v_and_b32 v139, 0xffff0000, v107
    v_pk_fma_f32 v[132:133], v[132:133], v[146:147], v[144:145]
    v_pk_fma_f32 v[134:135], v[134:135], v[146:147], v[144:145]
    v_pk_fma_f32 v[136:137], v[136:137], v[146:147], v[144:145]
    v_pk_fma_f32 v[138:139], v[138:139], v[146:147], v[144:145]
    v_cvt_pk_bf16_f32 v148, v132, v133
    v_cvt_pk_bf16_f32 v149, v134, v135
    v_cvt_pk_bf16_f32 v150, v136, v137
    v_cvt_pk_bf16_f32 v151, v138, v139
    ds_write_b128 v3, v[148:151] offset:40960
    s_add_u32 s47, s47, 31744
    buffer_load_dwordx4 v245, s[24:27], s47 offen offset:2048 lds
    v_lshlrev_b32 v132, 16, v108
    v_and_b32 v133, 0xffff0000, v108
    v_lshlrev_b32 v134, 16, v109
    v_and_b32 v135, 0xffff0000, v109
    v_lshlrev_b32 v136, 16, v110
    v_and_b32 v137, 0xffff0000, v110
    v_lshlrev_b32 v138, 16, v111
    v_and_b32 v139, 0xffff0000, v111
    v_pk_fma_f32 v[132:133], v[132:133], v[146:147], v[144:145]
    v_pk_fma_f32 v[134:135], v[134:135], v[146:147], v[144:145]
    v_pk_fma_f32 v[136:137], v[136:137], v[146:147], v[144:145]
    v_pk_fma_f32 v[138:139], v[138:139], v[146:147], v[144:145]
    v_cvt_pk_bf16_f32 v152, v132, v133
    v_cvt_pk_bf16_f32 v153, v134, v135
    v_cvt_pk_bf16_f32 v154, v136, v137
    v_cvt_pk_bf16_f32 v155, v138, v139
    ds_write_b128 v3, v[152:155] offset:45056
    s_add_u32 s47, s47, 31744
    buffer_load_dwordx4 v245, s[24:27], s47 offen offset:3072 lds
    v_lshlrev_b32 v132, 16, v112
    v_and_b32 v133, 0xffff0000, v112
    v_lshlrev_b32 v134, 16, v113
    v_and_b32 v135, 0xffff0000, v113
    v_lshlrev_b32 v136, 16, v114
    v_and_b32 v137, 0xffff0000, v114
    v_lshlrev_b32 v138, 16, v115
    v_and_b32 v139, 0xffff0000, v115
    v_pk_fma_f32 v[132:133], v[132:133], v[146:147], v[144:145]
    v_pk_fma_f32 v[134:135], v[134:135], v[146:147], v[144:145]
    v_pk_fma_f32 v[136:137], v[136:137], v[146:147], v[144:145]
    v_pk_fma_f32 v[138:139], v[138:139], v[146:147], v[144:145]
    v_cvt_pk_bf16_f32 v148, v132, v133
    v_cvt_pk_bf16_f32 v149, v134, v135
    v_cvt_pk_bf16_f32 v150, v136, v137
    v_cvt_pk_bf16_f32 v151, v138, v139
    ds_write_b128 v3, v[148:151] offset:49152
    s_add_u32 s47, s47, 35840
    s_add_u32 m0, s48, 12288
    s_nop 0
    buffer_load_dwordx4 v245, s[24:27], s47 offen lds
    v_lshlrev_b32 v132, 16, v116
    v_and_b32 v133, 0xffff0000, v116
    v_lshlrev_b32 v134, 16, v117
    v_and_b32 v135, 0xffff0000, v117
    v_lshlrev_b32 v136, 16, v118
    v_and_b32 v137, 0xffff0000, v118
    v_lshlrev_b32 v138, 16, v119
    v_and_b32 v139, 0xffff0000, v119
    v_pk_fma_f32 v[132:133], v[132:133], v[146:147], v[144:145]
    v_pk_fma_f32 v[134:135], v[134:135], v[146:147], v[144:145]
    v_pk_fma_f32 v[136:137], v[136:137], v[146:147], v[144:145]
    v_pk_fma_f32 v[138:139], v[138:139], v[146:147], v[144:145]
    v_cvt_pk_bf16_f32 v152, v132, v133
    v_cvt_pk_bf16_f32 v153, v134, v135
    v_cvt_pk_bf16_f32 v154, v136, v137
    v_cvt_pk_bf16_f32 v155, v138, v139
    ds_write_b128 v3, v[152:155] offset:53248
    s_add_u32 s47, s47, 31744
    buffer_load_dwordx4 v245, s[24:27], s47 offen offset:1024 lds
    v_lshlrev_b32 v132, 16, v120
    v_and_b32 v133, 0xffff0000, v120
    v_lshlrev_b32 v134, 16, v121
    v_and_b32 v135, 0xffff0000, v121
    v_lshlrev_b32 v136, 16, v122
    v_and_b32 v137, 0xffff0000, v122
    v_lshlrev_b32 v138, 16, v123
    v_and_b32 v139, 0xffff0000, v123
    v_pk_fma_f32 v[132:133], v[132:133], v[146:147], v[144:145]
    v_pk_fma_f32 v[134:135], v[134:135], v[146:147], v[144:145]
    v_pk_fma_f32 v[136:137], v[136:137], v[146:147], v[144:145]
    v_pk_fma_f32 v[138:139], v[138:139], v[146:147], v[144:145]
    v_cvt_pk_bf16_f32 v148, v132, v133
    v_cvt_pk_bf16_f32 v149, v134, v135
    v_cvt_pk_bf16_f32 v150, v136, v137
    v_cvt_pk_bf16_f32 v151, v138, v139
    ds_write_b128 v3, v[148:151] offset:57344
    s_add_u32 s47, s47, 31744
    buffer_load_dwordx4 v245, s[24:27], s47 offen offset:2048 lds
    v_lshlrev_b32 v132, 16, v124
    v_and_b32 v133, 0xffff0000, v124
    v_lshlrev_b32 v134, 16, v125
    v_and_b32 v135, 0xffff0000, v125
    v_lshlrev_b32 v136, 16, v126
    v_and_b32 v137, 0xffff0000, v126
    v_lshlrev_b32 v138, 16, v127
    v_and_b32 v139, 0xffff0000, v127
    v_pk_fma_f32 v[132:133], v[132:133], v[146:147], v[144:145]
    v_pk_fma_f32 v[134:135], v[134:135], v[146:147], v[144:145]
    v_pk_fma_f32 v[136:137], v[136:137], v[146:147], v[144:145]
    v_pk_fma_f32 v[138:139], v[138:139], v[146:147], v[144:145]
    v_cvt_pk_bf16_f32 v152, v132, v133
    v_cvt_pk_bf16_f32 v153, v134, v135
    v_cvt_pk_bf16_f32 v154, v136, v137
    v_cvt_pk_bf16_f32 v155, v138, v139
    ds_write_b128 v3, v[152:155] offset:61440
    s_add_u32 s47, s47, 31744
    buffer_load_dwordx4 v245, s[24:27], s47 offen offset:3072 lds
    s_add_u32 s47, s47, 35840
    s_waitcnt lgkmcnt(0)
    s_barrier
    s_lshl_b32 s3, s40, 3
    s_lshl_b32 s14, s42, 1
    s_add_u32 s3, s3, s14
    s_lshr_b32 s14, s3, 5
    s_lshl_b32 s14, s14, 10
    s_and_b32 s3, s3, 31
    s_lshl_b32 s3, s3, 4
    s_add_u32 s3, s3, s14
    s_add_u32 s3, s3, 65536
    v_lshrrev_b32 v1, 1, v0
    v_lshlrev_b32 v1, 11, v1
    v_and_b32 v2, 1, v0
    v_lshl_add_u32 v1, v2, 9, v1
    v_add_u32 v1, s3, v1
    ds_read_b128 v[208:211], v1
    ds_read_b128 v[212:215], v1 offset:16
    s_waitcnt vmcnt(12)
    ds_read_b128 a[160:163], v244 offset:0
    ds_read_b128 a[164:167], v244 offset:1024
    ds_read_b64_tr_b16 a[128:129], v240 offset:0
    ds_read_b64_tr_b16 a[130:131], v240 offset:1024
    ds_read_b64_tr_b16 a[132:133], v241 offset:0
    ds_read_b64_tr_b16 a[134:135], v241 offset:1024
    ds_read_b64_tr_b16 a[136:137], v242 offset:0
    ds_read_b64_tr_b16 a[138:139], v242 offset:1024
    ds_read_b64_tr_b16 a[140:141], v243 offset:0
    ds_read_b64_tr_b16 a[142:143], v243 offset:1024
    s_waitcnt vmcnt(8) lgkmcnt(0)
    v_mfma_f32_32x32x16_bf16 v[16:31], a[128:131], a[160:163], 0
    ds_read_b128 a[168:171], v244 offset:2048
    ds_read_b128 a[172:175], v244 offset:3072
    s_waitcnt lgkmcnt(0)
    v_lshlrev_b32 v184, 4, v0
    s_lshl_b32 s3, s42, 11
    v_mfma_f32_32x32x16_bf16 v[32:47], a[128:131], a[164:167], 0
    ds_read_b64_tr_b16 a[144:145], v240 offset:4096
    ds_read_b64_tr_b16 a[146:147], v240 offset:5120
    s_add_u32 s3, s3, 0
    v_add_u32 v184, s3, v184
    v_add_u32 v185, 1024, v184
    v_mfma_f32_32x32x16_bf16 v[48:63], a[132:135], a[160:163], 0
    ds_read_b64_tr_b16 a[148:149], v241 offset:4096
    ds_read_b64_tr_b16 a[150:151], v241 offset:5120
    v_lshlrev_b32 v144, 16, v208
    v_lshlrev_b32 v164, 16, v212
    v_and_b32 v145, 0xffff0000, v208
    v_mfma_f32_32x32x16_bf16 v[64:79], a[132:135], a[164:167], 0
    ds_read_b64_tr_b16 a[152:153], v242 offset:4096
    ds_read_b64_tr_b16 a[154:155], v242 offset:5120
    s_add_u32 m0, s48, 0
    v_and_b32 v165, 0xffff0000, v212
    v_lshlrev_b32 v146, 16, v209
    v_lshlrev_b32 v166, 16, v213
    v_mfma_f32_32x32x16_bf16 v[80:95], a[136:139], a[160:163], 0
    buffer_load_dwordx4 v245, s[24:27], s47 offen lds
    ds_read_b64_tr_b16 a[156:157], v243 offset:4096
    ds_read_b64_tr_b16 a[158:159], v243 offset:5120
    s_add_u32 s47, s47, 31744
    v_and_b32 v147, 0xffff0000, v209
    v_and_b32 v167, 0xffff0000, v213
    v_lshlrev_b32 v148, 16, v210
    v_mfma_f32_32x32x16_bf16 v[96:111], a[136:139], a[164:167], 0
    buffer_load_dwordx4 v245, s[24:27], s47 offen offset:1024 lds
    s_add_u32 s47, s47, 31744
    v_lshlrev_b32 v168, 16, v214
    v_and_b32 v149, 0xffff0000, v210
    v_and_b32 v169, 0xffff0000, v214
    v_mfma_f32_32x32x16_bf16 v[112:127], a[140:143], a[160:163], 0
    buffer_load_dwordx4 v245, s[24:27], s47 offen offset:2048 lds
    s_add_u32 s47, s47, 31744
    v_lshlrev_b32 v150, 16, v211
    v_lshlrev_b32 v170, 16, v215
    v_and_b32 v151, 0xffff0000, v211
    v_mfma_f32_32x32x16_bf16 v[128:143], a[140:143], a[164:167], 0
    buffer_load_dwordx4 v245, s[24:27], s47 offen offset:3072 lds
    s_add_u32 s47, s47, 35840
    v_and_b32 v171, 0xffff0000, v215
    v_add_f32 v156, v144, v145
    v_add_f32 v176, v164, v165
    s_waitcnt vmcnt(8) lgkmcnt(0)
    v_mfma_f32_32x32x16_bf16 v[16:31], a[144:147], a[168:171], v[16:31]
    ds_read_b128 a[160:163], v244 offset:4096
    ds_read_b128 a[164:167], v244 offset:5120
    v_add_f32 v156, v156, v146
    v_add_f32 v176, v176, v166
    v_add_f32 v156, v156, v147
    v_mfma_f32_32x32x16_bf16 v[32:47], a[144:147], a[172:175], v[32:47]
    ds_read_b64_tr_b16 a[128:129], v240 offset:8192
    ds_read_b64_tr_b16 a[130:131], v240 offset:9216
    v_add_f32 v176, v176, v167
    v_add_f32 v156, v156, v148
    v_add_f32 v176, v176, v168
    v_mfma_f32_32x32x16_bf16 v[48:63], a[148:151], a[168:171], v[48:63]
    ds_read_b64_tr_b16 a[132:133], v241 offset:8192
    ds_read_b64_tr_b16 a[134:135], v241 offset:9216
    v_add_f32 v156, v156, v149
    v_add_f32 v176, v176, v169
    v_add_f32 v156, v156, v150
    v_mfma_f32_32x32x16_bf16 v[64:79], a[148:151], a[172:175], v[64:79]
    ds_read_b64_tr_b16 a[136:137], v242 offset:8192
    ds_read_b64_tr_b16 a[138:139], v242 offset:9216
    s_add_u32 m0, s48, 4096
    v_add_f32 v176, v176, v170
    v_add_f32 v156, v156, v151
    v_add_f32 v176, v176, v171
    v_mfma_f32_32x32x16_bf16 v[80:95], a[152:155], a[168:171], v[80:95]
    buffer_load_dwordx4 v245, s[24:27], s47 offen lds
    ds_read_b64_tr_b16 a[140:141], v243 offset:8192
    ds_read_b64_tr_b16 a[142:143], v243 offset:9216
    s_add_u32 s47, s47, 31744
    s_nop 0
    v_add_f32_dpp v156, v156, v156 quad_perm:[1,0,3,2] row_mask:0xf bank_mask:0xf
    v_add_f32_dpp v176, v176, v176 quad_perm:[1,0,3,2] row_mask:0xf bank_mask:0xf
    v_mfma_f32_32x32x16_bf16 v[96:111], a[152:155], a[172:175], v[96:111]
    buffer_load_dwordx4 v245, s[24:27], s47 offen offset:1024 lds
    s_add_u32 s47, s47, 31744
    s_nop 0
    v_add_f32_dpp v156, v156, v156 quad_perm:[2,3,0,1] row_mask:0xf bank_mask:0xf
    v_add_f32_dpp v176, v176, v176 quad_perm:[2,3,0,1] row_mask:0xf bank_mask:0xf
    v_mfma_f32_32x32x16_bf16 v[112:127], a[156:159], a[168:171], v[112:127]
    buffer_load_dwordx4 v245, s[24:27], s47 offen offset:2048 lds
    s_add_u32 s47, s47, 31744
    s_nop 0
    v_add_f32_dpp v156, v156, v156 row_half_mirror row_mask:0xf bank_mask:0xf
    v_add_f32_dpp v176, v176, v176 row_half_mirror row_mask:0xf bank_mask:0xf
    v_mfma_f32_32x32x16_bf16 v[128:143], a[156:159], a[172:175], v[128:143]
    buffer_load_dwordx4 v245, s[24:27], s47 offen offset:3072 lds
    s_add_u32 s47, s47, 35840
    s_nop 0
    v_add_f32_dpp v156, v156, v156 row_mirror row_mask:0xf bank_mask:0xf
    v_add_f32_dpp v176, v176, v176 row_mirror row_mask:0xf bank_mask:0xf
    s_waitcnt vmcnt(8) lgkmcnt(0)
    v_mfma_f32_32x32x16_bf16 v[16:31], a[128:131], a[160:163], v[16:31]
    ds_read_b128 a[168:171], v244 offset:6144
    ds_read_b128 a[172:175], v244 offset:7168
    v_mov_b32 v157, v156
    v_mov_b32 v177, v176
    s_nop 0
    v_mfma_f32_32x32x16_bf16 v[32:47], a[128:131], a[164:167], v[32:47]
    ds_read_b64_tr_b16 a[144:145], v240 offset:12288
    ds_read_b64_tr_b16 a[146:147], v240 offset:13312
    v_permlane16_swap_b32 v157, v156
    v_permlane16_swap_b32 v177, v176
    v_add_f32 v156, v156, v157
    v_mfma_f32_32x32x16_bf16 v[48:63], a[132:135], a[160:163], v[48:63]
    ds_read_b64_tr_b16 a[148:149], v241 offset:12288
    ds_read_b64_tr_b16 a[150:151], v241 offset:13312
    v_add_f32 v176, v176, v177
    v_mov_b32 v157, v156
    v_mov_b32 v177, v176
    v_mfma_f32_32x32x16_bf16 v[64:79], a[132:135], a[164:167], v[64:79]
    ds_read_b64_tr_b16 a[152:153], v242 offset:12288
    ds_read_b64_tr_b16 a[154:155], v242 offset:13312
    s_add_u32 m0, s48, 8192
    s_nop 0
    v_permlane32_swap_b32 v157, v156
    v_permlane32_swap_b32 v177, v176
    v_mfma_f32_32x32x16_bf16 v[80:95], a[136:139], a[160:163], v[80:95]
    buffer_load_dwordx4 v245, s[24:27], s47 offen lds
    ds_read_b64_tr_b16 a[156:157], v243 offset:12288
    ds_read_b64_tr_b16 a[158:159], v243 offset:13312
    s_add_u32 s47, s47, 31744
    v_add_f32 v156, v156, v157
    v_add_f32 v176, v176, v177
    v_mul_f32 v156, 0x3b000000, v156
    v_mfma_f32_32x32x16_bf16 v[96:111], a[136:139], a[164:167], v[96:111]
    buffer_load_dwordx4 v245, s[24:27], s47 offen offset:1024 lds
    s_add_u32 s47, s47, 31744
    v_mul_f32 v176, 0x3b000000, v176
    v_cvt_pk_bf16_f32 v158, v156, v156
    v_cvt_pk_bf16_f32 v178, v176, v176
    v_mfma_f32_32x32x16_bf16 v[112:127], a[140:143], a[160:163], v[112:127]
    buffer_load_dwordx4 v245, s[24:27], s47 offen offset:2048 lds
    s_add_u32 s47, s47, 31744
    v_lshlrev_b32 v158, 16, v158
    v_lshlrev_b32 v178, 16, v178
    v_sub_f32 v159, v144, v156
    v_mfma_f32_32x32x16_bf16 v[128:143], a[140:143], a[164:167], v[128:143]
    buffer_load_dwordx4 v245, s[24:27], s47 offen offset:3072 lds
    s_add_u32 s47, s47, 35840
    v_sub_f32 v179, v164, v176
    v_mul_f32 v160, v159, v159
    v_mul_f32 v180, v179, v179
    s_waitcnt vmcnt(8) lgkmcnt(0)
    v_mfma_f32_32x32x16_bf16 v[16:31], a[144:147], a[168:171], v[16:31]
    ds_read_b128 a[160:163], v244 offset:8192
    ds_read_b128 a[164:167], v244 offset:9216
    v_sub_f32 v159, v145, v156
    v_sub_f32 v179, v165, v176
    v_fmac_f32 v160, v159, v159
    v_mfma_f32_32x32x16_bf16 v[32:47], a[144:147], a[172:175], v[32:47]
    ds_read_b64_tr_b16 a[128:129], v240 offset:0
    ds_read_b64_tr_b16 a[130:131], v240 offset:1024
    v_fmac_f32 v180, v179, v179
    v_sub_f32 v159, v146, v156
    v_sub_f32 v179, v166, v176
    v_mfma_f32_32x32x16_bf16 v[48:63], a[148:151], a[168:171], v[48:63]
    ds_read_b64_tr_b16 a[132:133], v241 offset:0
    ds_read_b64_tr_b16 a[134:135], v241 offset:1024
    v_fmac_f32 v160, v159, v159
    v_fmac_f32 v180, v179, v179
    v_sub_f32 v159, v147, v156
    v_mfma_f32_32x32x16_bf16 v[64:79], a[148:151], a[172:175], v[64:79]
    ds_read_b64_tr_b16 a[136:137], v242 offset:0
    ds_read_b64_tr_b16 a[138:139], v242 offset:1024
    s_add_u32 m0, s48, 12288
    v_sub_f32 v179, v167, v176
    v_fmac_f32 v160, v159, v159
    v_fmac_f32 v180, v179, v179
    v_mfma_f32_32x32x16_bf16 v[80:95], a[152:155], a[168:171], v[80:95]
    buffer_load_dwordx4 v245, s[24:27], s47 offen lds
    ds_read_b64_tr_b16 a[140:141], v243 offset:0
    ds_read_b64_tr_b16 a[142:143], v243 offset:1024
    s_add_u32 s47, s47, 31744
    v_sub_f32 v159, v148, v156
    v_sub_f32 v179, v168, v176
    v_fmac_f32 v160, v159, v159
    v_mfma_f32_32x32x16_bf16 v[96:111], a[152:155], a[172:175], v[96:111]
    buffer_load_dwordx4 v245, s[24:27], s47 offen offset:1024 lds
    s_add_u32 s47, s47, 31744
    v_fmac_f32 v180, v179, v179
    v_sub_f32 v159, v149, v156
    v_sub_f32 v179, v169, v176
    v_mfma_f32_32x32x16_bf16 v[112:127], a[156:159], a[168:171], v[112:127]
    buffer_load_dwordx4 v245, s[24:27], s47 offen offset:2048 lds
    s_add_u32 s47, s47, 31744
    v_fmac_f32 v160, v159, v159
    v_fmac_f32 v180, v179, v179
    v_sub_f32 v159, v150, v156
    v_mfma_f32_32x32x16_bf16 v[128:143], a[156:159], a[172:175], v[128:143]
    buffer_load_dwordx4 v245, s[24:27], s47 offen offset:3072 lds
    s_add_u32 s47, s47, 35840
    v_sub_f32 v179, v170, v176
    v_add_u32 v244, 8192, v244
    s_waitcnt vmcnt(8) lgkmcnt(0)
    v_mfma_f32_32x32x16_bf16 v[16:31], a[128:131], a[160:163], v[16:31]
    ds_read_b128 a[168:171], v244 offset:2048
    ds_read_b128 a[172:175], v244 offset:3072
    v_fmac_f32 v160, v159, v159
    v_fmac_f32 v180, v179, v179
    v_sub_f32 v159, v151, v156
    v_mfma_f32_32x32x16_bf16 v[32:47], a[128:131], a[164:167], v[32:47]
    ds_read_b64_tr_b16 a[144:145], v240 offset:4096
    ds_read_b64_tr_b16 a[146:147], v240 offset:5120
    v_sub_f32 v179, v171, v176
    v_fmac_f32 v160, v159, v159
    v_fmac_f32 v180, v179, v179
    v_mfma_f32_32x32x16_bf16 v[48:63], a[132:135], a[160:163], v[48:63]
    ds_read_b64_tr_b16 a[148:149], v241 offset:4096
    ds_read_b64_tr_b16 a[150:151], v241 offset:5120
    s_nop 0
    v_add_f32_dpp v160, v160, v160 quad_perm:[1,0,3,2] row_mask:0xf bank_mask:0xf
    v_add_f32_dpp v180, v180, v180 quad_perm:[1,0,3,2] row_mask:0xf bank_mask:0xf
    v_mfma_f32_32x32x16_bf16 v[64:79], a[132:135], a[164:167], v[64:79]
    ds_read_b64_tr_b16 a[152:153], v242 offset:4096
    ds_read_b64_tr_b16 a[154:155], v242 offset:5120
    s_add_u32 m0, s48, 0
    s_nop 0
    v_add_f32_dpp v160, v160, v160 quad_perm:[2,3,0,1] row_mask:0xf bank_mask:0xf
    v_add_f32_dpp v180, v180, v180 quad_perm:[2,3,0,1] row_mask:0xf bank_mask:0xf
    v_mfma_f32_32x32x16_bf16 v[80:95], a[136:139], a[160:163], v[80:95]
    buffer_load_dwordx4 v245, s[24:27], s47 offen lds
    ds_read_b64_tr_b16 a[156:157], v243 offset:4096
    ds_read_b64_tr_b16 a[158:159], v243 offset:5120
    s_add_u32 s47, s47, 31744
    s_nop 0
    v_add_f32_dpp v160, v160, v160 row_half_mirror row_mask:0xf bank_mask:0xf
    v_add_f32_dpp v180, v180, v180 row_half_mirror row_mask:0xf bank_mask:0xf
    v_mfma_f32_32x32x16_bf16 v[96:111], a[136:139], a[164:167], v[96:111]
    buffer_load_dwordx4 v245, s[24:27], s47 offen offset:1024 lds
    s_add_u32 s47, s47, 31744
    s_nop 0
    v_add_f32_dpp v160, v160, v160 row_mirror row_mask:0xf bank_mask:0xf
    v_add_f32_dpp v180, v180, v180 row_mirror row_mask:0xf bank_mask:0xf
    v_mfma_f32_32x32x16_bf16 v[112:127], a[140:143], a[160:163], v[112:127]
    buffer_load_dwordx4 v245, s[24:27], s47 offen offset:2048 lds
    s_add_u32 s47, s47, 31744
    v_mov_b32 v157, v160
    v_mov_b32 v177, v180
    s_nop 0
    v_mfma_f32_32x32x16_bf16 v[128:143], a[140:143], a[164:167], v[128:143]
    buffer_load_dwordx4 v245, s[24:27], s47 offen offset:3072 lds
    s_add_u32 s47, s47, 35840
    v_permlane16_swap_b32 v157, v160
    v_permlane16_swap_b32 v177, v180
    v_add_f32 v160, v160, v157
    s_waitcnt vmcnt(8) lgkmcnt(0)
    v_mfma_f32_32x32x16_bf16 v[16:31], a[144:147], a[168:171], v[16:31]
    ds_read_b128 a[160:163], v244 offset:4096
    ds_read_b128 a[164:167], v244 offset:5120
    v_add_f32 v180, v180, v177
    v_mov_b32 v157, v160
    v_mov_b32 v177, v180
    v_mfma_f32_32x32x16_bf16 v[32:47], a[144:147], a[172:175], v[32:47]
    ds_read_b64_tr_b16 a[128:129], v240 offset:8192
    ds_read_b64_tr_b16 a[130:131], v240 offset:9216
    s_nop 0
    v_permlane32_swap_b32 v157, v160
    v_permlane32_swap_b32 v177, v180
    v_mfma_f32_32x32x16_bf16 v[48:63], a[148:151], a[168:171], v[48:63]
    ds_read_b64_tr_b16 a[132:133], v241 offset:8192
    ds_read_b64_tr_b16 a[134:135], v241 offset:9216
    v_add_f32 v160, v160, v157
    v_add_f32 v180, v180, v177
    v_mul_f32 v160, 0x3b000000, v160
    v_mfma_f32_32x32x16_bf16 v[64:79], a[148:151], a[172:175], v[64:79]
    ds_read_b64_tr_b16 a[136:137], v242 offset:8192
    ds_read_b64_tr_b16 a[138:139], v242 offset:9216
    s_add_u32 m0, s48, 4096
    v_mul_f32 v180, 0x3b000000, v180
    v_cvt_pk_bf16_f32 v160, v160, v160
    v_cvt_pk_bf16_f32 v180, v180, v180
    v_mfma_f32_32x32x16_bf16 v[80:95], a[152:155], a[168:171], v[80:95]
    buffer_load_dwordx4 v245, s[24:27], s47 offen lds
    ds_read_b64_tr_b16 a[140:141], v243 offset:8192
    ds_read_b64_tr_b16 a[142:143], v243 offset:9216
    s_add_u32 s47, s47, 31744
    v_lshlrev_b32 v160, 16, v160
    v_lshlrev_b32 v180, 16, v180
    v_add_f32 v160, 0x3727c5ac, v160
    v_mfma_f32_32x32x16_bf16 v[96:111], a[152:155], a[172:175], v[96:111]
    buffer_load_dwordx4 v245, s[24:27], s47 offen offset:1024 lds
    s_add_u32 s47, s47, 31744
    v_add_f32 v180, 0x3727c5ac, v180
    v_cvt_pk_bf16_f32 v160, v160, v160
    v_cvt_pk_bf16_f32 v180, v180, v180
    v_mfma_f32_32x32x16_bf16 v[112:127], a[156:159], a[168:171], v[112:127]
    buffer_load_dwordx4 v245, s[24:27], s47 offen offset:2048 lds
    s_add_u32 s47, s47, 31744
    v_lshlrev_b32 v160, 16, v160
    v_lshlrev_b32 v180, 16, v180
    v_sqrt_f32 v160, v160
    v_mfma_f32_32x32x16_bf16 v[128:143], a[156:159], a[172:175], v[128:143]
    buffer_load_dwordx4 v245, s[24:27], s47 offen offset:3072 lds
    s_add_u32 s47, s47, 35840
    v_sqrt_f32 v180, v180
    v_cvt_pk_bf16_f32 v160, v160, v160
    v_cvt_pk_bf16_f32 v180, v180, v180
    s_waitcnt vmcnt(8) lgkmcnt(0)
    v_mfma_f32_32x32x16_bf16 v[16:31], a[128:131], a[160:163], v[16:31]
    ds_read_b128 a[168:171], v244 offset:6144
    ds_read_b128 a[172:175], v244 offset:7168
    v_lshlrev_b32 v160, 16, v160
    v_lshlrev_b32 v180, 16, v180
    v_rcp_f32 v157, v160
    v_mfma_f32_32x32x16_bf16 v[32:47], a[128:131], a[164:167], v[32:47]
    ds_read_b64_tr_b16 a[144:145], v240 offset:12288
    ds_read_b64_tr_b16 a[146:147], v240 offset:13312
    v_rcp_f32 v177, v180
    v_fma_f32 v159, -v160, v157, 1.0
    v_fma_f32 v179, -v180, v177, 1.0
    v_mfma_f32_32x32x16_bf16 v[48:63], a[132:135], a[160:163], v[48:63]
    ds_read_b64_tr_b16 a[148:149], v241 offset:12288
    ds_read_b64_tr_b16 a[150:151], v241 offset:13312
    v_fma_f32 v157, v159, v157, v157
    v_fma_f32 v177, v179, v177, v177
    v_sub_f32 v144, v144, v158
    v_mfma_f32_32x32x16_bf16 v[64:79], a[132:135], a[164:167], v[64:79]
    ds_read_b64_tr_b16 a[152:153], v242 offset:12288
    ds_read_b64_tr_b16 a[154:155], v242 offset:13312
    s_add_u32 m0, s48, 8192
    v_sub_f32 v164, v164, v178
    v_sub_f32 v145, v145, v158
    v_sub_f32 v165, v165, v178
    v_mfma_f32_32x32x16_bf16 v[80:95], a[136:139], a[160:163], v[80:95]
    buffer_load_dwordx4 v245, s[24:27], s47 offen lds
    ds_read_b64_tr_b16 a[156:157], v243 offset:12288
    ds_read_b64_tr_b16 a[158:159], v243 offset:13312
    s_add_u32 s47, s47, 31744
    v_cvt_pk_bf16_f32 v159, v144, v145
    v_cvt_pk_bf16_f32 v179, v164, v165
    v_lshlrev_b32 v144, 16, v159
    v_mfma_f32_32x32x16_bf16 v[96:111], a[136:139], a[164:167], v[96:111]
    buffer_load_dwordx4 v245, s[24:27], s47 offen offset:1024 lds
    s_add_u32 s47, s47, 31744
    v_lshlrev_b32 v164, 16, v179
    v_and_b32 v145, 0xffff0000, v159
    v_and_b32 v165, 0xffff0000, v179
    v_mfma_f32_32x32x16_bf16 v[112:127], a[140:143], a[160:163], v[112:127]
    buffer_load_dwordx4 v245, s[24:27], s47 offen offset:2048 lds
    s_add_u32 s47, s47, 31744
    v_mul_f32 v144, v144, v157
    v_mul_f32 v164, v164, v177
    v_mul_f32 v145, v145, v157
    v_mfma_f32_32x32x16_bf16 v[128:143], a[140:143], a[164:167], v[128:143]
    buffer_load_dwordx4 v245, s[24:27], s47 offen offset:3072 lds
    s_add_u32 s47, s47, 35840
    v_mul_f32 v165, v165, v177
    v_cvt_pk_bf16_f32 v152, v144, v145
    v_cvt_pk_bf16_f32 v172, v164, v165
    s_waitcnt vmcnt(8) lgkmcnt(0)
    v_mfma_f32_32x32x16_bf16 v[16:31], a[144:147], a[168:171], v[16:31]
    ds_read_b128 a[160:163], v244 offset:8192
    ds_read_b128 a[164:167], v244 offset:9216
    v_lshlrev_b32 v144, 16, v152
    v_lshlrev_b32 v164, 16, v172
    v_and_b32 v145, 0xffff0000, v152
    v_mfma_f32_32x32x16_bf16 v[32:47], a[144:147], a[172:175], v[32:47]
    ds_read_b64_tr_b16 a[128:129], v240 offset:0
    ds_read_b64_tr_b16 a[130:131], v240 offset:1024
    v_and_b32 v165, 0xffff0000, v172
    v_sub_f32 v146, v146, v158
    v_sub_f32 v166, v166, v178
    v_mfma_f32_32x32x16_bf16 v[48:63], a[148:151], a[168:171], v[48:63]
    ds_read_b64_tr_b16 a[132:133], v241 offset:0
    ds_read_b64_tr_b16 a[134:135], v241 offset:1024
    v_sub_f32 v147, v147, v158
    v_sub_f32 v167, v167, v178
    v_cvt_pk_bf16_f32 v159, v146, v147
    v_mfma_f32_32x32x16_bf16 v[64:79], a[148:151], a[172:175], v[64:79]
    ds_read_b64_tr_b16 a[136:137], v242 offset:0
    ds_read_b64_tr_b16 a[138:139], v242 offset:1024
    s_add_u32 m0, s48, 12288
    v_cvt_pk_bf16_f32 v179, v166, v167
    v_lshlrev_b32 v146, 16, v159
    v_lshlrev_b32 v166, 16, v179
    v_mfma_f32_32x32x16_bf16 v[80:95], a[152:155], a[168:171], v[80:95]
    buffer_load_dwordx4 v245, s[24:27], s47 offen lds
    ds_read_b64_tr_b16 a[140:141], v243 offset:0
    ds_read_b64_tr_b16 a[142:143], v243 offset:1024
    s_add_u32 s47, s47, 31744
    v_and_b32 v147, 0xffff0000, v159
    v_and_b32 v167, 0xffff0000, v179
    v_mul_f32 v146, v146, v157
    v_mfma_f32_32x32x16_bf16 v[96:111], a[152:155], a[172:175], v[96:111]
    buffer_load_dwordx4 v245, s[24:27], s47 offen offset:1024 lds
    s_add_u32 s47, s47, 31744
    v_mul_f32 v166, v166, v177
    v_mul_f32 v147, v147, v157
    v_mul_f32 v167, v167, v177
    v_mfma_f32_32x32x16_bf16 v[112:127], a[156:159], a[168:171], v[112:127]
    buffer_load_dwordx4 v245, s[24:27], s47 offen offset:2048 lds
    s_add_u32 s47, s47, 31744
    v_cvt_pk_bf16_f32 v153, v146, v147
    v_cvt_pk_bf16_f32 v173, v166, v167
    v_lshlrev_b32 v146, 16, v153
    v_mfma_f32_32x32x16_bf16 v[128:143], a[156:159], a[172:175], v[128:143]
    buffer_load_dwordx4 v245, s[24:27], s47 offen offset:3072 lds
    s_add_u32 s47, s47, 35840
    v_add_u32 v244, 8192, v244
    s_waitcnt vmcnt(8) lgkmcnt(0)
    v_mfma_f32_32x32x16_bf16 v[16:31], a[128:131], a[160:163], v[16:31]
    ds_read_b128 a[168:171], v244 offset:2048
    ds_read_b128 a[172:175], v244 offset:3072
    v_lshlrev_b32 v166, 16, v173
    v_and_b32 v147, 0xffff0000, v153
    v_and_b32 v167, 0xffff0000, v173
    v_mfma_f32_32x32x16_bf16 v[32:47], a[128:131], a[164:167], v[32:47]
    ds_read_b64_tr_b16 a[144:145], v240 offset:4096
    ds_read_b64_tr_b16 a[146:147], v240 offset:5120
    v_sub_f32 v148, v148, v158
    v_sub_f32 v168, v168, v178
    v_sub_f32 v149, v149, v158
    v_mfma_f32_32x32x16_bf16 v[48:63], a[132:135], a[160:163], v[48:63]
    ds_read_b64_tr_b16 a[148:149], v241 offset:4096
    ds_read_b64_tr_b16 a[150:151], v241 offset:5120
    v_sub_f32 v169, v169, v178
    v_cvt_pk_bf16_f32 v159, v148, v149
    v_cvt_pk_bf16_f32 v179, v168, v169
    v_mfma_f32_32x32x16_bf16 v[64:79], a[132:135], a[164:167], v[64:79]
    ds_read_b64_tr_b16 a[152:153], v242 offset:4096
    ds_read_b64_tr_b16 a[154:155], v242 offset:5120
    s_add_u32 m0, s48, 0
    v_lshlrev_b32 v148, 16, v159
    v_lshlrev_b32 v168, 16, v179
    v_and_b32 v149, 0xffff0000, v159
    v_mfma_f32_32x32x16_bf16 v[80:95], a[136:139], a[160:163], v[80:95]
    buffer_load_dwordx4 v245, s[24:27], s47 offen lds
    ds_read_b64_tr_b16 a[156:157], v243 offset:4096
    ds_read_b64_tr_b16 a[158:159], v243 offset:5120
    s_add_u32 s47, s47, 31744
    v_and_b32 v169, 0xffff0000, v179
    v_mul_f32 v148, v148, v157
    v_mul_f32 v168, v168, v177
    v_mfma_f32_32x32x16_bf16 v[96:111], a[136:139], a[164:167], v[96:111]
    buffer_load_dwordx4 v245, s[24:27], s47 offen offset:1024 lds
    s_add_u32 s47, s47, 31744
    v_mul_f32 v149, v149, v157
    v_mul_f32 v169, v169, v177
    v_cvt_pk_bf16_f32 v154, v148, v149
    v_mfma_f32_32x32x16_bf16 v[112:127], a[140:143], a[160:163], v[112:127]
    buffer_load_dwordx4 v245, s[24:27], s47 offen offset:2048 lds
    s_add_u32 s47, s47, 31744
    v_cvt_pk_bf16_f32 v174, v168, v169
    v_lshlrev_b32 v148, 16, v154
    v_lshlrev_b32 v168, 16, v174
    v_mfma_f32_32x32x16_bf16 v[128:143], a[140:143], a[164:167], v[128:143]
    buffer_load_dwordx4 v245, s[24:27], s47 offen offset:3072 lds
    s_add_u32 s47, s47, 35840
    v_and_b32 v149, 0xffff0000, v154
    v_and_b32 v169, 0xffff0000, v174
    s_waitcnt vmcnt(8) lgkmcnt(0)
    v_mfma_f32_32x32x16_bf16 v[16:31], a[144:147], a[168:171], v[16:31]
    ds_read_b128 a[160:163], v244 offset:4096
    ds_read_b128 a[164:167], v244 offset:5120
    v_sub_f32 v150, v150, v158
    v_sub_f32 v170, v170, v178
    v_sub_f32 v151, v151, v158
    v_mfma_f32_32x32x16_bf16 v[32:47], a[144:147], a[172:175], v[32:47]
    ds_read_b64_tr_b16 a[128:129], v240 offset:8192
    ds_read_b64_tr_b16 a[130:131], v240 offset:9216
    v_sub_f32 v171, v171, v178
    v_cvt_pk_bf16_f32 v159, v150, v151
    v_cvt_pk_bf16_f32 v179, v170, v171
    v_mfma_f32_32x32x16_bf16 v[48:63], a[148:151], a[168:171], v[48:63]
    ds_read_b64_tr_b16 a[132:133], v241 offset:8192
    ds_read_b64_tr_b16 a[134:135], v241 offset:9216
    v_lshlrev_b32 v150, 16, v159
    v_lshlrev_b32 v170, 16, v179
    v_and_b32 v151, 0xffff0000, v159
    v_mfma_f32_32x32x16_bf16 v[64:79], a[148:151], a[172:175], v[64:79]
    ds_read_b64_tr_b16 a[136:137], v242 offset:8192
    ds_read_b64_tr_b16 a[138:139], v242 offset:9216
    s_add_u32 m0, s48, 4096
    v_and_b32 v171, 0xffff0000, v179
    v_mul_f32 v150, v150, v157
    v_mul_f32 v170, v170, v177
    v_mfma_f32_32x32x16_bf16 v[80:95], a[152:155], a[168:171], v[80:95]
    buffer_load_dwordx4 v245, s[24:27], s47 offen lds
    ds_read_b64_tr_b16 a[140:141], v243 offset:8192
    ds_read_b64_tr_b16 a[142:143], v243 offset:9216
    s_add_u32 s47, s47, 31744
    v_mul_f32 v151, v151, v157
    v_mul_f32 v171, v171, v177
    v_cvt_pk_bf16_f32 v155, v150, v151
    v_mfma_f32_32x32x16_bf16 v[96:111], a[152:155], a[172:175], v[96:111]
    buffer_load_dwordx4 v245, s[24:27], s47 offen offset:1024 lds
    s_add_u32 s47, s47, 31744
    v_cvt_pk_bf16_f32 v175, v170, v171
    v_lshlrev_b32 v150, 16, v155
    v_lshlrev_b32 v170, 16, v175
    v_mfma_f32_32x32x16_bf16 v[112:127], a[156:159], a[168:171], v[112:127]
    buffer_load_dwordx4 v245, s[24:27], s47 offen offset:2048 lds
    s_add_u32 s47, s47, 31744
    v_and_b32 v151, 0xffff0000, v155
    v_and_b32 v171, 0xffff0000, v175
    ds_write_b128 v184, v[152:155]
    v_mfma_f32_32x32x16_bf16 v[128:143], a[156:159], a[172:175], v[128:143]
    buffer_load_dwordx4 v245, s[24:27], s47 offen offset:3072 lds
    s_add_u32 s47, s47, 35840
    ds_write_b128 v185, v[172:175]
    s_lshl_b32 s3, s42, 6
    s_waitcnt vmcnt(8) lgkmcnt(0)
    v_mfma_f32_32x32x16_bf16 v[16:31], a[128:131], a[160:163], v[16:31]
    ds_read_b128 a[168:171], v244 offset:6144
    ds_read_b128 a[172:175], v244 offset:7168
    v_add_u32 v186, s3, v0
    v_lshlrev_b32 v187, 1, v186
    v_add_u32 v187, 0, v187
    v_mfma_f32_32x32x16_bf16 v[32:47], a[128:131], a[164:167], v[32:47]
    ds_read_b64_tr_b16 a[144:145], v240 offset:12288
    ds_read_b64_tr_b16 a[146:147], v240 offset:13312
    s_waitcnt lgkmcnt(0)
    s_barrier
    ds_read_u16 v144, v187 offset:0
    v_mfma_f32_32x32x16_bf16 v[48:63], a[132:135], a[160:163], v[48:63]
    ds_read_b64_tr_b16 a[148:149], v241 offset:12288
    ds_read_b64_tr_b16 a[150:151], v241 offset:13312
    ds_read_u16 v145, v187 offset:1024
    ds_read_u16 v146, v187 offset:2048
    ds_read_u16 v147, v187 offset:3072
    v_mfma_f32_32x32x16_bf16 v[64:79], a[132:135], a[164:167], v[64:79]
    ds_read_b64_tr_b16 a[152:153], v242 offset:12288
    ds_read_b64_tr_b16 a[154:155], v242 offset:13312
    s_add_u32 m0, s48, 8192
    ds_read_u16 v148, v187 offset:4096
    ds_read_u16 v149, v187 offset:5120
    ds_read_u16 v150, v187 offset:6144
    v_mfma_f32_32x32x16_bf16 v[80:95], a[136:139], a[160:163], v[80:95]
    buffer_load_dwordx4 v245, s[24:27], s47 offen lds
    ds_read_b64_tr_b16 a[156:157], v243 offset:12288
    ds_read_b64_tr_b16 a[158:159], v243 offset:13312
    s_add_u32 s47, s47, 31744
    ds_read_u16 v151, v187 offset:7168
    ds_read_u16 v152, v187 offset:512
    ds_read_u16 v153, v187 offset:1536
    v_mfma_f32_32x32x16_bf16 v[96:111], a[136:139], a[164:167], v[96:111]
    buffer_load_dwordx4 v245, s[24:27], s47 offen offset:1024 lds
    s_add_u32 s47, s47, 31744
    ds_read_u16 v154, v187 offset:2560
    ds_read_u16 v155, v187 offset:3584
    ds_read_u16 v156, v187 offset:4608
    v_mfma_f32_32x32x16_bf16 v[112:127], a[140:143], a[160:163], v[112:127]
    buffer_load_dwordx4 v245, s[24:27], s47 offen offset:2048 lds
    s_add_u32 s47, s47, 31744
    ds_read_u16 v157, v187 offset:5632
    ds_read_u16 v158, v187 offset:6656
    ds_read_u16 v159, v187 offset:7680
    v_mfma_f32_32x32x16_bf16 v[128:143], a[140:143], a[164:167], v[128:143]
    buffer_load_dwordx4 v245, s[24:27], s47 offen offset:3072 lds
    s_add_u32 s47, s47, 35840
    s_lshl_b32 s13, s41, 2
    s_lshr_b32 s14, s40, 1
    s_waitcnt vmcnt(8) lgkmcnt(0)
    v_mfma_f32_32x32x16_bf16 v[16:31], a[144:147], a[168:171], v[16:31]
    ds_read_b128 a[160:163], v244 offset:8192
    ds_read_b128 a[164:167], v244 offset:9216
    s_add_u32 s13, s13, s14
    s_lshl_b32 s13, s13, 10
    s_and_b32 s14, s40, 1
    v_mfma_f32_32x32x16_bf16 v[32:47], a[144:147], a[172:175], v[32:47]
    ds_read_b64_tr_b16 a[128:129], v240 offset:0
    ds_read_b64_tr_b16 a[130:131], v240 offset:1024
    s_lshl_b32 s14, s14, 9
    s_add_u32 s13, s13, s14
    s_add_u32 s13, s13, 2097152
    v_mfma_f32_32x32x16_bf16 v[48:63], a[148:151], a[168:171], v[48:63]
    ds_read_b64_tr_b16 a[132:133], v241 offset:0
    ds_read_b64_tr_b16 a[134:135], v241 offset:1024
    v_lshrrev_b32 v188, 5, v186
    v_lshlrev_b32 v188, 17, v188
    v_and_b32 v189, 31, v186
    v_mfma_f32_32x32x16_bf16 v[64:79], a[148:151], a[172:175], v[64:79]
    ds_read_b64_tr_b16 a[136:137], v242 offset:0
    ds_read_b64_tr_b16 a[138:139], v242 offset:1024
    s_add_u32 m0, s48, 12288
    v_lshl_add_u32 v188, v189, 4, v188
    s_add_u32 s15, s13, 1048576
    s_waitcnt lgkmcnt(0)
    v_mfma_f32_32x32x16_bf16 v[80:95], a[152:155], a[168:171], v[80:95]
    buffer_load_dwordx4 v245, s[24:27], s47 offen lds
    ds_read_b64_tr_b16 a[140:141], v243 offset:0
    ds_read_b64_tr_b16 a[142:143], v243 offset:1024
    s_add_u32 s47, s47, 31744
    v_lshl_or_b32 v164, v145, 16, v144
    v_lshl_or_b32 v165, v147, 16, v146
    v_lshl_or_b32 v166, v149, 16, v148
    v_mfma_f32_32x32x16_bf16 v[96:111], a[152:155], a[172:175], v[96:111]
    buffer_load_dwordx4 v245, s[24:27], s47 offen offset:1024 lds
    s_add_u32 s47, s47, 31744
    v_lshl_or_b32 v167, v151, 16, v150
    v_lshl_or_b32 v168, v153, 16, v152
    v_lshl_or_b32 v169, v155, 16, v154
    v_mfma_f32_32x32x16_bf16 v[112:127], a[156:159], a[168:171], v[112:127]
    buffer_load_dwordx4 v245, s[24:27], s47 offen offset:2048 lds
    s_add_u32 s47, s47, 31744
    v_lshl_or_b32 v170, v157, 16, v156
    v_lshl_or_b32 v171, v159, 16, v158
    buffer_store_dwordx4 v[164:167], v188, s[60:63], s13 offen sc1
    v_mfma_f32_32x32x16_bf16 v[128:143], a[156:159], a[172:175], v[128:143]
    buffer_load_dwordx4 v245, s[24:27], s47 offen offset:3072 lds
    s_add_u32 s47, s47, 35840
    buffer_store_dwordx4 v[168:171], v188, s[60:63], s15 offen sc1
    s_barrier
    v_add_u32 v244, 8192, v244
    s_mov_b32 s50, 4
L_proj_q:
    s_waitcnt vmcnt(8) lgkmcnt(0)
    v_mfma_f32_32x32x16_bf16 v[16:31], a[128:131], a[160:163], v[16:31]
    ds_read_b128 a[168:171], v244 offset:2048
    ds_read_b128 a[172:175], v244 offset:3072
    v_mfma_f32_32x32x16_bf16 v[32:47], a[128:131], a[164:167], v[32:47]
    ds_read_b64_tr_b16 a[144:145], v240 offset:4096
    ds_read_b64_tr_b16 a[146:147], v240 offset:5120
    v_mfma_f32_32x32x16_bf16 v[48:63], a[132:135], a[160:163], v[48:63]
    ds_read_b64_tr_b16 a[148:149], v241 offset:4096
    ds_read_b64_tr_b16 a[150:151], v241 offset:5120
    v_mfma_f32_32x32x16_bf16 v[64:79], a[132:135], a[164:167], v[64:79]
    ds_read_b64_tr_b16 a[152:153], v242 offset:4096
    ds_read_b64_tr_b16 a[154:155], v242 offset:5120
    s_add_u32 m0, s48, 0
    v_mfma_f32_32x32x16_bf16 v[80:95], a[136:139], a[160:163], v[80:95]
    buffer_load_dwordx4 v245, s[24:27], s47 offen lds
    ds_read_b64_tr_b16 a[156:157], v243 offset:4096
    ds_read_b64_tr_b16 a[158:159], v243 offset:5120
    s_add_u32 s47, s47, 31744
    v_mfma_f32_32x32x16_bf16 v[96:111], a[136:139], a[164:167], v[96:111]
    buffer_load_dwordx4 v245, s[24:27], s47 offen offset:1024 lds
    s_add_u32 s47, s47, 31744
    v_mfma_f32_32x32x16_bf16 v[112:127], a[140:143], a[160:163], v[112:127]
    buffer_load_dwordx4 v245, s[24:27], s47 offen offset:2048 lds
    s_add_u32 s47, s47, 31744
    v_mfma_f32_32x32x16_bf16 v[128:143], a[140:143], a[164:167], v[128:143]
    buffer_load_dwordx4 v245, s[24:27], s47 offen offset:3072 lds
    s_add_u32 s47, s47, 35840
    s_waitcnt vmcnt(8) lgkmcnt(0)
    v_mfma_f32_32x32x16_bf16 v[16:31], a[144:147], a[168:171], v[16:31]
    ds_read_b128 a[160:163], v244 offset:4096
    ds_read_b128 a[164:167], v244 offset:5120
    v_mfma_f32_32x32x16_bf16 v[32:47], a[144:147], a[172:175], v[32:47]
    ds_read_b64_tr_b16 a[128:129], v240 offset:8192
    ds_read_b64_tr_b16 a[130:131], v240 offset:9216
    v_mfma_f32_32x32x16_bf16 v[48:63], a[148:151], a[168:171], v[48:63]
    ds_read_b64_tr_b16 a[132:133], v241 offset:8192
    ds_read_b64_tr_b16 a[134:135], v241 offset:9216
    v_mfma_f32_32x32x16_bf16 v[64:79], a[148:151], a[172:175], v[64:79]
    ds_read_b64_tr_b16 a[136:137], v242 offset:8192
    ds_read_b64_tr_b16 a[138:139], v242 offset:9216
    s_add_u32 m0, s48, 4096
    v_mfma_f32_32x32x16_bf16 v[80:95], a[152:155], a[168:171], v[80:95]
    buffer_load_dwordx4 v245, s[24:27], s47 offen lds
    ds_read_b64_tr_b16 a[140:141], v243 offset:8192
    ds_read_b64_tr_b16 a[142:143], v243 offset:9216
    s_add_u32 s47, s47, 31744
    v_mfma_f32_32x32x16_bf16 v[96:111], a[152:155], a[172:175], v[96:111]
    buffer_load_dwordx4 v245, s[24:27], s47 offen offset:1024 lds
    s_add_u32 s47, s47, 31744
    v_mfma_f32_32x32x16_bf16 v[112:127], a[156:159], a[168:171], v[112:127]
    buffer_load_dwordx4 v245, s[24:27], s47 offen offset:2048 lds
    s_add_u32 s47, s47, 31744
    v_mfma_f32_32x32x16_bf16 v[128:143], a[156:159], a[172:175], v[128:143]
    buffer_load_dwordx4 v245, s[24:27], s47 offen offset:3072 lds
    s_add_u32 s47, s47, 35840
    s_waitcnt vmcnt(8) lgkmcnt(0)
    v_mfma_f32_32x32x16_bf16 v[16:31], a[128:131], a[160:163], v[16:31]
    ds_read_b128 a[168:171], v244 offset:6144
    ds_read_b128 a[172:175], v244 offset:7168
    v_mfma_f32_32x32x16_bf16 v[32:47], a[128:131], a[164:167], v[32:47]
    ds_read_b64_tr_b16 a[144:145], v240 offset:12288
    ds_read_b64_tr_b16 a[146:147], v240 offset:13312
    v_mfma_f32_32x32x16_bf16 v[48:63], a[132:135], a[160:163], v[48:63]
    ds_read_b64_tr_b16 a[148:149], v241 offset:12288
    ds_read_b64_tr_b16 a[150:151], v241 offset:13312
    v_mfma_f32_32x32x16_bf16 v[64:79], a[132:135], a[164:167], v[64:79]
    ds_read_b64_tr_b16 a[152:153], v242 offset:12288
    ds_read_b64_tr_b16 a[154:155], v242 offset:13312
    s_add_u32 m0, s48, 8192
    v_mfma_f32_32x32x16_bf16 v[80:95], a[136:139], a[160:163], v[80:95]
    buffer_load_dwordx4 v245, s[24:27], s47 offen lds
    ds_read_b64_tr_b16 a[156:157], v243 offset:12288
    ds_read_b64_tr_b16 a[158:159], v243 offset:13312
    s_add_u32 s47, s47, 31744
    v_mfma_f32_32x32x16_bf16 v[96:111], a[136:139], a[164:167], v[96:111]
    buffer_load_dwordx4 v245, s[24:27], s47 offen offset:1024 lds
    s_add_u32 s47, s47, 31744
    v_mfma_f32_32x32x16_bf16 v[112:127], a[140:143], a[160:163], v[112:127]
    buffer_load_dwordx4 v245, s[24:27], s47 offen offset:2048 lds
    s_add_u32 s47, s47, 31744
    v_mfma_f32_32x32x16_bf16 v[128:143], a[140:143], a[164:167], v[128:143]
    buffer_load_dwordx4 v245, s[24:27], s47 offen offset:3072 lds
    s_add_u32 s47, s47, 35840
    s_waitcnt vmcnt(8) lgkmcnt(0)
    v_mfma_f32_32x32x16_bf16 v[16:31], a[144:147], a[168:171], v[16:31]
    ds_read_b128 a[160:163], v244 offset:8192
    ds_read_b128 a[164:167], v244 offset:9216
    v_mfma_f32_32x32x16_bf16 v[32:47], a[144:147], a[172:175], v[32:47]
    ds_read_b64_tr_b16 a[128:129], v240 offset:0
    ds_read_b64_tr_b16 a[130:131], v240 offset:1024
    v_mfma_f32_32x32x16_bf16 v[48:63], a[148:151], a[168:171], v[48:63]
    ds_read_b64_tr_b16 a[132:133], v241 offset:0
    ds_read_b64_tr_b16 a[134:135], v241 offset:1024
    v_mfma_f32_32x32x16_bf16 v[64:79], a[148:151], a[172:175], v[64:79]
    ds_read_b64_tr_b16 a[136:137], v242 offset:0
    ds_read_b64_tr_b16 a[138:139], v242 offset:1024
    s_add_u32 m0, s48, 12288
    v_mfma_f32_32x32x16_bf16 v[80:95], a[152:155], a[168:171], v[80:95]
    buffer_load_dwordx4 v245, s[24:27], s47 offen lds
    ds_read_b64_tr_b16 a[140:141], v243 offset:0
    ds_read_b64_tr_b16 a[142:143], v243 offset:1024
    s_add_u32 s47, s47, 31744
    v_mfma_f32_32x32x16_bf16 v[96:111], a[152:155], a[172:175], v[96:111]
    buffer_load_dwordx4 v245, s[24:27], s47 offen offset:1024 lds
    s_add_u32 s47, s47, 31744
    v_mfma_f32_32x32x16_bf16 v[112:127], a[156:159], a[168:171], v[112:127]
    buffer_load_dwordx4 v245, s[24:27], s47 offen offset:2048 lds
    s_add_u32 s47, s47, 31744
    v_mfma_f32_32x32x16_bf16 v[128:143], a[156:159], a[172:175], v[128:143]
    buffer_load_dwordx4 v245, s[24:27], s47 offen offset:3072 lds
    s_add_u32 s47, s47, 35840
    v_add_u32 v244, 8192, v244
    s_sub_u32 s50, s50, 1
    s_cmp_lg_u32 s50, 0
    s_cbranch_scc1 L_proj_q
    s_add_u32 m0, s45, 0
    s_nop 0
    buffer_load_dwordx4 v234, s[16:19], s43 offen offset:0  lds
    buffer_load_dwordx4 v235, s[16:19], s43 offen offset:1024  lds
    buffer_load_dwordx4 v236, s[16:19], s43 offen offset:2048  lds
    buffer_load_dwordx4 v237, s[16:19], s43 offen offset:3072  lds
    s_add_u32 s43, s43, 16384
    s_add_u32 m0, s45, 16384
    s_nop 0
    buffer_load_dwordx4 v234, s[16:19], s43 offen offset:0  lds
    buffer_load_dwordx4 v235, s[16:19], s43 offen offset:1024  lds
    buffer_load_dwordx4 v236, s[16:19], s43 offen offset:2048  lds
    buffer_load_dwordx4 v237, s[16:19], s43 offen offset:3072  lds
    s_add_u32 s43, s43, 16384
    v_mov_b32 v252, 0
    buffer_load_dword v252, v252, s[4:7], 0 offen sc1
    s_waitcnt vmcnt(17) lgkmcnt(0)
    v_mfma_f32_32x32x16_bf16 v[16:31], a[128:131], a[160:163], v[16:31]
    ds_read_b128 a[168:171], v244 offset:2048
    ds_read_b128 a[172:175], v244 offset:3072
    v_accvgpr_write_b32 a0, 0
    v_accvgpr_write_b32 a1, 0
    v_accvgpr_write_b32 a2, 0
    v_accvgpr_write_b32 a3, 0
    v_mfma_f32_32x32x16_bf16 v[32:47], a[128:131], a[164:167], v[32:47]
    ds_read_b64_tr_b16 a[144:145], v240 offset:4096
    ds_read_b64_tr_b16 a[146:147], v240 offset:5120
    v_accvgpr_write_b32 a4, 0
    v_accvgpr_write_b32 a5, 0
    v_accvgpr_write_b32 a6, 0
    v_accvgpr_write_b32 a7, 0
    v_mfma_f32_32x32x16_bf16 v[48:63], a[132:135], a[160:163], v[48:63]
    ds_read_b64_tr_b16 a[148:149], v241 offset:4096
    ds_read_b64_tr_b16 a[150:151], v241 offset:5120
    v_accvgpr_write_b32 a8, 0
    v_accvgpr_write_b32 a9, 0
    v_accvgpr_write_b32 a10, 0
    v_accvgpr_write_b32 a11, 0
    v_mfma_f32_32x32x16_bf16 v[64:79], a[132:135], a[164:167], v[64:79]
    ds_read_b64_tr_b16 a[152:153], v242 offset:4096
    ds_read_b64_tr_b16 a[154:155], v242 offset:5120
    v_accvgpr_write_b32 a12, 0
    v_accvgpr_write_b32 a13, 0
    v_accvgpr_write_b32 a14, 0
    v_accvgpr_write_b32 a15, 0
    v_mfma_f32_32x32x16_bf16 v[80:95], a[136:139], a[160:163], v[80:95]
    ds_read_b64_tr_b16 a[156:157], v243 offset:4096
    ds_read_b64_tr_b16 a[158:159], v243 offset:5120
    v_accvgpr_write_b32 a16, 0
    v_accvgpr_write_b32 a17, 0
    v_accvgpr_write_b32 a18, 0
    v_accvgpr_write_b32 a19, 0
    v_mfma_f32_32x32x16_bf16 v[96:111], a[136:139], a[164:167], v[96:111]
    v_accvgpr_write_b32 a20, 0
    v_accvgpr_write_b32 a21, 0
    v_accvgpr_write_b32 a22, 0
    v_accvgpr_write_b32 a23, 0
    v_mfma_f32_32x32x16_bf16 v[112:127], a[140:143], a[160:163], v[112:127]
    v_accvgpr_write_b32 a24, 0
    v_accvgpr_write_b32 a25, 0
    v_accvgpr_write_b32 a26, 0
    v_accvgpr_write_b32 a27, 0
    v_mfma_f32_32x32x16_bf16 v[128:143], a[140:143], a[164:167], v[128:143]
    v_accvgpr_write_b32 a28, 0
    v_accvgpr_write_b32 a29, 0
    v_accvgpr_write_b32 a30, 0
    v_accvgpr_write_b32 a31, 0
    s_waitcnt vmcnt(13) lgkmcnt(0)
    v_mfma_f32_32x32x16_bf16 v[16:31], a[144:147], a[168:171], v[16:31]
    ds_read_b128 a[160:163], v244 offset:4096
    ds_read_b128 a[164:167], v244 offset:5120
    v_accvgpr_write_b32 a32, 0
    v_accvgpr_write_b32 a33, 0
    v_accvgpr_write_b32 a34, 0
    v_accvgpr_write_b32 a35, 0
    v_mfma_f32_32x32x16_bf16 v[32:47], a[144:147], a[172:175], v[32:47]
    ds_read_b64_tr_b16 a[128:129], v240 offset:8192
    ds_read_b64_tr_b16 a[130:131], v240 offset:9216
    v_accvgpr_write_b32 a36, 0
    v_accvgpr_write_b32 a37, 0
    v_accvgpr_write_b32 a38, 0
    v_accvgpr_write_b32 a39, 0
    v_mfma_f32_32x32x16_bf16 v[48:63], a[148:151], a[168:171], v[48:63]
    ds_read_b64_tr_b16 a[132:133], v241 offset:8192
    ds_read_b64_tr_b16 a[134:135], v241 offset:9216
    v_accvgpr_write_b32 a40, 0
    v_accvgpr_write_b32 a41, 0
    v_accvgpr_write_b32 a42, 0
    v_accvgpr_write_b32 a43, 0
    v_mfma_f32_32x32x16_bf16 v[64:79], a[148:151], a[172:175], v[64:79]
    ds_read_b64_tr_b16 a[136:137], v242 offset:8192
    ds_read_b64_tr_b16 a[138:139], v242 offset:9216
    v_accvgpr_write_b32 a44, 0
    v_accvgpr_write_b32 a45, 0
    v_accvgpr_write_b32 a46, 0
    v_accvgpr_write_b32 a47, 0
    v_mfma_f32_32x32x16_bf16 v[80:95], a[152:155], a[168:171], v[80:95]
    ds_read_b64_tr_b16 a[140:141], v243 offset:8192
    ds_read_b64_tr_b16 a[142:143], v243 offset:9216
    v_accvgpr_write_b32 a48, 0
    v_accvgpr_write_b32 a49, 0
    v_accvgpr_write_b32 a50, 0
    v_accvgpr_write_b32 a51, 0
    v_mfma_f32_32x32x16_bf16 v[96:111], a[152:155], a[172:175], v[96:111]
    v_accvgpr_write_b32 a52, 0
    v_accvgpr_write_b32 a53, 0
    v_accvgpr_write_b32 a54, 0
    v_accvgpr_write_b32 a55, 0
    v_mfma_f32_32x32x16_bf16 v[112:127], a[156:159], a[168:171], v[112:127]
    v_accvgpr_write_b32 a56, 0
    v_accvgpr_write_b32 a57, 0
    v_accvgpr_write_b32 a58, 0
    v_accvgpr_write_b32 a59, 0
    v_mfma_f32_32x32x16_bf16 v[128:143], a[156:159], a[172:175], v[128:143]
    v_accvgpr_write_b32 a60, 0
    v_accvgpr_write_b32 a61, 0
    v_accvgpr_write_b32 a62, 0
    v_accvgpr_write_b32 a63, 0
    s_waitcnt vmcnt(9) lgkmcnt(0)
    v_mfma_f32_32x32x16_bf16 v[16:31], a[128:131], a[160:163], v[16:31]
    ds_read_b128 a[168:171], v244 offset:6144
    ds_read_b128 a[172:175], v244 offset:7168
    v_accvgpr_write_b32 a64, 0
    v_accvgpr_write_b32 a65, 0
    v_accvgpr_write_b32 a66, 0
    v_accvgpr_write_b32 a67, 0
    v_mfma_f32_32x32x16_bf16 v[32:47], a[128:131], a[164:167], v[32:47]
    ds_read_b64_tr_b16 a[144:145], v240 offset:12288
    ds_read_b64_tr_b16 a[146:147], v240 offset:13312
    v_accvgpr_write_b32 a68, 0
    v_accvgpr_write_b32 a69, 0
    v_accvgpr_write_b32 a70, 0
    v_accvgpr_write_b32 a71, 0
    v_mfma_f32_32x32x16_bf16 v[48:63], a[132:135], a[160:163], v[48:63]
    ds_read_b64_tr_b16 a[148:149], v241 offset:12288
    ds_read_b64_tr_b16 a[150:151], v241 offset:13312
    v_accvgpr_write_b32 a72, 0
    v_accvgpr_write_b32 a73, 0
    v_accvgpr_write_b32 a74, 0
    v_accvgpr_write_b32 a75, 0
    v_mfma_f32_32x32x16_bf16 v[64:79], a[132:135], a[164:167], v[64:79]
    ds_read_b64_tr_b16 a[152:153], v242 offset:12288
    ds_read_b64_tr_b16 a[154:155], v242 offset:13312
    v_accvgpr_write_b32 a76, 0
    v_accvgpr_write_b32 a77, 0
    v_accvgpr_write_b32 a78, 0
    v_accvgpr_write_b32 a79, 0
    v_mfma_f32_32x32x16_bf16 v[80:95], a[136:139], a[160:163], v[80:95]
    ds_read_b64_tr_b16 a[156:157], v243 offset:12288
    ds_read_b64_tr_b16 a[158:159], v243 offset:13312
    v_accvgpr_write_b32 a80, 0
    v_accvgpr_write_b32 a81, 0
    v_accvgpr_write_b32 a82, 0
    v_accvgpr_write_b32 a83, 0
    v_mfma_f32_32x32x16_bf16 v[96:111], a[136:139], a[164:167], v[96:111]
    v_accvgpr_write_b32 a84, 0
    v_accvgpr_write_b32 a85, 0
    v_accvgpr_write_b32 a86, 0
    v_accvgpr_write_b32 a87, 0
    v_mfma_f32_32x32x16_bf16 v[112:127], a[140:143], a[160:163], v[112:127]
    v_accvgpr_write_b32 a88, 0
    v_accvgpr_write_b32 a89, 0
    v_accvgpr_write_b32 a90, 0
    v_accvgpr_write_b32 a91, 0
    v_mfma_f32_32x32x16_bf16 v[128:143], a[140:143], a[164:167], v[128:143]
    v_accvgpr_write_b32 a92, 0
    v_accvgpr_write_b32 a93, 0
    v_accvgpr_write_b32 a94, 0
    v_accvgpr_write_b32 a95, 0
    s_waitcnt vmcnt(9) lgkmcnt(0)
    v_mfma_f32_32x32x16_bf16 v[16:31], a[144:147], a[168:171], v[16:31]
    v_accvgpr_write_b32 a96, 0
    v_accvgpr_write_b32 a97, 0
    v_accvgpr_write_b32 a98, 0
    v_accvgpr_write_b32 a99, 0
    v_mfma_f32_32x32x16_bf16 v[32:47], a[144:147], a[172:175], v[32:47]
    v_accvgpr_write_b32 a100, 0
    v_accvgpr_write_b32 a101, 0
    v_accvgpr_write_b32 a102, 0
    v_accvgpr_write_b32 a103, 0
    v_mfma_f32_32x32x16_bf16 v[48:63], a[148:151], a[168:171], v[48:63]
    v_accvgpr_write_b32 a104, 0
    v_accvgpr_write_b32 a105, 0
    v_accvgpr_write_b32 a106, 0
    v_accvgpr_write_b32 a107, 0
    v_mfma_f32_32x32x16_bf16 v[64:79], a[148:151], a[172:175], v[64:79]
    v_accvgpr_write_b32 a108, 0
    v_accvgpr_write_b32 a109, 0
    v_accvgpr_write_b32 a110, 0
    v_accvgpr_write_b32 a111, 0
    v_mfma_f32_32x32x16_bf16 v[80:95], a[152:155], a[168:171], v[80:95]
    v_accvgpr_write_b32 a112, 0
    v_accvgpr_write_b32 a113, 0
    v_accvgpr_write_b32 a114, 0
    v_accvgpr_write_b32 a115, 0
    v_mfma_f32_32x32x16_bf16 v[96:111], a[152:155], a[172:175], v[96:111]
    v_accvgpr_write_b32 a116, 0
    v_accvgpr_write_b32 a117, 0
    v_accvgpr_write_b32 a118, 0
    v_accvgpr_write_b32 a119, 0
    v_mfma_f32_32x32x16_bf16 v[112:127], a[156:159], a[168:171], v[112:127]
    v_accvgpr_write_b32 a120, 0
    v_accvgpr_write_b32 a121, 0
    v_accvgpr_write_b32 a122, 0
    v_accvgpr_write_b32 a123, 0
    v_mfma_f32_32x32x16_bf16 v[128:143], a[156:159], a[172:175], v[128:143]
    v_accvgpr_write_b32 a124, 0
    v_accvgpr_write_b32 a125, 0
    v_accvgpr_write_b32 a126, 0
    v_accvgpr_write_b32 a127, 0
    v_lshrrev_b32 v3, 3, v0
    v_and_b32 v4, 7, v0
    v_lshrrev_b32 v5, 1, v3
    v_and_b32 v5, 1, v5
    v_lshlrev_b32 v5, 2, v5
    v_xor_b32 v4, v4, v5
    v_mul_u32_u24 v3, 3584, v3
    v_lshl_add_u32 v10, v4, 4, v3
    v_lshlrev_b32 v11, 4, v0
    v_lshrrev_b32 v3, 5, v0
    v_bfe_u32 v4, v0, 4, 1
    v_bfe_u32 v5, v0, 2, 2
    v_and_b32 v6, 3, v0
    v_lshlrev_b32 v7, 3, v3
    v_add_u32 v7, v7, v5
    v_lshlrev_b32 v7, 7, v7
    v_lshl_add_u32 v7, v4, 5, v7
    v_lshl_add_u32 v7, v6, 3, v7
    s_lshl_b32 s3, s42, 14
    s_cmp_eq_u32 s42, 3
    s_cselect_b32 s3, 131072, s3
    v_add_u32 v7, s3, v7
    v_lshrrev_b32 v8, 1, v5
    v_lshlrev_b32 v9, 6, v8
    v_add_u32 v12, v7, v9
    v_xor_b32 v9, 64, v9
    v_add_u32 v13, v7, v9
    v_lshlrev_b32 v14, 3, v3
    s_waitcnt vmcnt(9) lgkmcnt(0)
    s_barrier
    s_add_u32 m0, s46, 0
    s_nop 0
    buffer_load_dwordx4 v238, s[20:23], s44 offen offset:0  lds
    buffer_load_dwordx4 v238, s[20:23], s44 offen offset:1024  lds
    buffer_load_dwordx4 v238, s[20:23], s44 offen offset:2048  lds
    buffer_load_dwordx4 v238, s[20:23], s44 offen offset:3072  lds
    s_add_u32 s44, s44, 16384
    s_add_u32 m0, s45, 32768
    s_nop 0
    buffer_load_dwordx4 v234, s[16:19], s43 offen offset:0  lds
    buffer_load_dwordx4 v235, s[16:19], s43 offen offset:1024  lds
    buffer_load_dwordx4 v236, s[16:19], s43 offen offset:2048  lds
    buffer_load_dwordx4 v237, s[16:19], s43 offen offset:3072  lds
    s_add_u32 s43, s43, 16384
    s_add_u32 m0, s46, 16384
    s_nop 0
    buffer_load_dwordx4 v238, s[20:23], s44 offen offset:0  lds
    buffer_load_dwordx4 v238, s[20:23], s44 offen offset:1024  lds
    buffer_load_dwordx4 v238, s[20:23], s44 offen offset:2048  lds
    buffer_load_dwordx4 v238, s[20:23], s44 offen offset:3072  lds
    s_add_u32 s44, s44, 16384
    s_load_dwordx2 s[8:9], s[0:1], 64
    s_lshl_b32 s14, s42, 6
    v_add_u32 v1, s14, v0
    v_lshrrev_b32 v2, 1, v1
    v_and_b32 v3, 1, v1
    v_lshlrev_b32 v4, 12, v2
    v_lshl_add_u32 v253, v3, 6, v4
    s_movk_i32 s14, 3584
    v_mul_lo_u32 v2, v2, s14
    v_lshl_add_u32 v250, v3, 6, v2
    s_waitcnt lgkmcnt(0)
    s_mov_b32 s24, s8
    s_mov_b32 s25, s9
    s_mov_b32 s26, 7340032
    s_mov_b32 s27, 0x00020000
    s_mov_b32 s14, 0x3e0293ee
    s_mov_b32 s15, 0x3e0293ee
    s_nop 7
    v_pk_mul_f32 v[16:17], v[16:17], s[14:15]
    v_pk_mul_f32 v[18:19], v[18:19], s[14:15]
    v_pk_mul_f32 v[20:21], v[20:21], s[14:15]
    v_pk_mul_f32 v[22:23], v[22:23], s[14:15]
    v_pk_mul_f32 v[24:25], v[24:25], s[14:15]
    v_pk_mul_f32 v[26:27], v[26:27], s[14:15]
    v_pk_mul_f32 v[28:29], v[28:29], s[14:15]
    v_pk_mul_f32 v[30:31], v[30:31], s[14:15]
    v_cvt_pk_bf16_f32 v144, v16, v17
    v_cvt_pk_bf16_f32 v145, v18, v19
    v_cvt_pk_bf16_f32 v146, v20, v21
    v_cvt_pk_bf16_f32 v147, v22, v23
    v_cvt_pk_bf16_f32 v148, v24, v25
    v_cvt_pk_bf16_f32 v149, v26, v27
    v_cvt_pk_bf16_f32 v150, v28, v29
    v_cvt_pk_bf16_f32 v151, v30, v31
    v_pk_mul_f32 v[32:33], v[32:33], s[14:15]
    v_pk_mul_f32 v[34:35], v[34:35], s[14:15]
    v_pk_mul_f32 v[36:37], v[36:37], s[14:15]
    v_pk_mul_f32 v[38:39], v[38:39], s[14:15]
    v_pk_mul_f32 v[40:41], v[40:41], s[14:15]
    v_pk_mul_f32 v[42:43], v[42:43], s[14:15]
    v_pk_mul_f32 v[44:45], v[44:45], s[14:15]
    v_pk_mul_f32 v[46:47], v[46:47], s[14:15]
    v_cvt_pk_bf16_f32 v176, v32, v33
    v_cvt_pk_bf16_f32 v177, v34, v35
    v_cvt_pk_bf16_f32 v178, v36, v37
    v_cvt_pk_bf16_f32 v179, v38, v39
    v_cvt_pk_bf16_f32 v180, v40, v41
    v_cvt_pk_bf16_f32 v181, v42, v43
    v_cvt_pk_bf16_f32 v182, v44, v45
    v_cvt_pk_bf16_f32 v183, v46, v47
    v_pk_mul_f32 v[48:49], v[48:49], s[14:15]
    v_pk_mul_f32 v[50:51], v[50:51], s[14:15]
    v_pk_mul_f32 v[52:53], v[52:53], s[14:15]
    v_pk_mul_f32 v[54:55], v[54:55], s[14:15]
    v_pk_mul_f32 v[56:57], v[56:57], s[14:15]
    v_pk_mul_f32 v[58:59], v[58:59], s[14:15]
    v_pk_mul_f32 v[60:61], v[60:61], s[14:15]
    v_pk_mul_f32 v[62:63], v[62:63], s[14:15]
    v_cvt_pk_bf16_f32 v152, v48, v49
    v_cvt_pk_bf16_f32 v153, v50, v51
    v_cvt_pk_bf16_f32 v154, v52, v53
    v_cvt_pk_bf16_f32 v155, v54, v55
    v_cvt_pk_bf16_f32 v156, v56, v57
    v_cvt_pk_bf16_f32 v157, v58, v59
    v_cvt_pk_bf16_f32 v158, v60, v61
    v_cvt_pk_bf16_f32 v159, v62, v63
    v_pk_mul_f32 v[64:65], v[64:65], s[14:15]
    v_pk_mul_f32 v[66:67], v[66:67], s[14:15]
    v_pk_mul_f32 v[68:69], v[68:69], s[14:15]
    v_pk_mul_f32 v[70:71], v[70:71], s[14:15]
    v_pk_mul_f32 v[72:73], v[72:73], s[14:15]
    v_pk_mul_f32 v[74:75], v[74:75], s[14:15]
    v_pk_mul_f32 v[76:77], v[76:77], s[14:15]
    v_pk_mul_f32 v[78:79], v[78:79], s[14:15]
    v_cvt_pk_bf16_f32 v184, v64, v65
    v_cvt_pk_bf16_f32 v185, v66, v67
    v_cvt_pk_bf16_f32 v186, v68, v69
    v_cvt_pk_bf16_f32 v187, v70, v71
    v_cvt_pk_bf16_f32 v188, v72, v73
    v_cvt_pk_bf16_f32 v189, v74, v75
    v_cvt_pk_bf16_f32 v190, v76, v77
    v_cvt_pk_bf16_f32 v191, v78, v79
    v_pk_mul_f32 v[80:81], v[80:81], s[14:15]
    v_pk_mul_f32 v[82:83], v[82:83], s[14:15]
    v_pk_mul_f32 v[84:85], v[84:85], s[14:15]
    v_pk_mul_f32 v[86:87], v[86:87], s[14:15]
    v_pk_mul_f32 v[88:89], v[88:89], s[14:15]
    v_pk_mul_f32 v[90:91], v[90:91], s[14:15]
    v_pk_mul_f32 v[92:93], v[92:93], s[14:15]
    v_pk_mul_f32 v[94:95], v[94:95], s[14:15]
    v_cvt_pk_bf16_f32 v160, v80, v81
    v_cvt_pk_bf16_f32 v161, v82, v83
    v_cvt_pk_bf16_f32 v162, v84, v85
    v_cvt_pk_bf16_f32 v163, v86, v87
    v_cvt_pk_bf16_f32 v164, v88, v89
    v_cvt_pk_bf16_f32 v165, v90, v91
    v_cvt_pk_bf16_f32 v166, v92, v93
    v_cvt_pk_bf16_f32 v167, v94, v95
    v_pk_mul_f32 v[96:97], v[96:97], s[14:15]
    v_pk_mul_f32 v[98:99], v[98:99], s[14:15]
    v_pk_mul_f32 v[100:101], v[100:101], s[14:15]
    v_pk_mul_f32 v[102:103], v[102:103], s[14:15]
    v_pk_mul_f32 v[104:105], v[104:105], s[14:15]
    v_pk_mul_f32 v[106:107], v[106:107], s[14:15]
    v_pk_mul_f32 v[108:109], v[108:109], s[14:15]
    v_pk_mul_f32 v[110:111], v[110:111], s[14:15]
    v_cvt_pk_bf16_f32 v192, v96, v97
    v_cvt_pk_bf16_f32 v193, v98, v99
    v_cvt_pk_bf16_f32 v194, v100, v101
    v_cvt_pk_bf16_f32 v195, v102, v103
    v_cvt_pk_bf16_f32 v196, v104, v105
    v_cvt_pk_bf16_f32 v197, v106, v107
    v_cvt_pk_bf16_f32 v198, v108, v109
    v_cvt_pk_bf16_f32 v199, v110, v111
    v_pk_mul_f32 v[112:113], v[112:113], s[14:15]
    v_pk_mul_f32 v[114:115], v[114:115], s[14:15]
    v_pk_mul_f32 v[116:117], v[116:117], s[14:15]
    v_pk_mul_f32 v[118:119], v[118:119], s[14:15]
    v_pk_mul_f32 v[120:121], v[120:121], s[14:15]
    v_pk_mul_f32 v[122:123], v[122:123], s[14:15]
    v_pk_mul_f32 v[124:125], v[124:125], s[14:15]
    v_pk_mul_f32 v[126:127], v[126:127], s[14:15]
    v_cvt_pk_bf16_f32 v168, v112, v113
    v_cvt_pk_bf16_f32 v169, v114, v115
    v_cvt_pk_bf16_f32 v170, v116, v117
    v_cvt_pk_bf16_f32 v171, v118, v119
    v_cvt_pk_bf16_f32 v172, v120, v121
    v_cvt_pk_bf16_f32 v173, v122, v123
    v_cvt_pk_bf16_f32 v174, v124, v125
    v_cvt_pk_bf16_f32 v175, v126, v127
    v_pk_mul_f32 v[128:129], v[128:129], s[14:15]
    v_pk_mul_f32 v[130:131], v[130:131], s[14:15]
    v_pk_mul_f32 v[132:133], v[132:133], s[14:15]
    v_pk_mul_f32 v[134:135], v[134:135], s[14:15]
    v_pk_mul_f32 v[136:137], v[136:137], s[14:15]
    v_pk_mul_f32 v[138:139], v[138:139], s[14:15]
    v_pk_mul_f32 v[140:141], v[140:141], s[14:15]
    v_pk_mul_f32 v[142:143], v[142:143], s[14:15]
    v_cvt_pk_bf16_f32 v200, v128, v129
    v_cvt_pk_bf16_f32 v201, v130, v131
    v_cvt_pk_bf16_f32 v202, v132, v133
    v_cvt_pk_bf16_f32 v203, v134, v135
    v_cvt_pk_bf16_f32 v204, v136, v137
    v_cvt_pk_bf16_f32 v205, v138, v139
    v_cvt_pk_bf16_f32 v206, v140, v141
    v_cvt_pk_bf16_f32 v207, v142, v143
    s_waitcnt vmcnt(12)
    s_barrier
    s_cmp_lg_u32 s42, 0
    s_cbranch_scc1 L_hsig_done
    v_readfirstlane_b32 s14, v252
    s_cmp_ge_u32 s14, 56
    s_cbranch_scc1 L_rdy_ok
    s_mov_b32 s51, 1048576
    v_mov_b32 v1, 0
L_rdy_poll:
    buffer_load_dword v4, v1, s[4:7], 0 offen sc1
    s_waitcnt vmcnt(0)
    v_readfirstlane_b32 s14, v4
    s_cmp_ge_u32 s14, 56
    s_cbranch_scc1 L_rdy_ok
    s_sleep 8
    s_sub_u32 s51, s51, 1
    s_cmp_lg_u32 s51, 0
    s_cbranch_scc1 L_rdy_poll
L_rdy_ok:
    s_lshl_b32 s14, s33, 8
    s_add_u32 s14, s14, 6307840
    v_mov_b32 v1, 0
    v_mov_b32 v4, 1
    v_cmp_eq_u32 vcc, 0, v0
    s_and_saveexec_b64 s[12:13], vcc
    buffer_atomic_add v4, v1, s[60:63], s14 offen
    s_mov_b64 exec, s[12:13]
L_hsig_done:
    ds_read_b128 a[128:131], v222 offset:0
    ds_read_b128 a[132:135], v223 offset:0
    ds_read_b128 a[136:139], v224 offset:0
    ds_read_b128 a[140:143], v225 offset:0
    s_waitcnt lgkmcnt(3)
    v_mfma_f32_32x32x16_bf16 v[16:31], a[128:131], v[144:147], 0
    v_mfma_f32_32x32x16_bf16 v[32:47], a[128:131], v[176:179], 0
    ds_read_b128 a[128:131], v226 offset:0
    s_waitcnt lgkmcnt(3)
    v_mfma_f32_32x32x16_bf16 v[16:31], a[132:135], v[148:151], v[16:31]
    v_mfma_f32_32x32x16_bf16 v[32:47], a[132:135], v[180:183], v[32:47]
    ds_read_b128 a[132:135], v227 offset:0
    s_waitcnt lgkmcnt(3)
    v_mfma_f32_32x32x16_bf16 v[16:31], a[136:139], v[152:155], v[16:31]
    v_mfma_f32_32x32x16_bf16 v[32:47], a[136:139], v[184:187], v[32:47]
    ds_read_b128 a[136:139], v228 offset:0
    s_waitcnt lgkmcnt(3)
    v_mfma_f32_32x32x16_bf16 v[16:31], a[140:143], v[156:159], v[16:31]
    v_mfma_f32_32x32x16_bf16 v[32:47], a[140:143], v[188:191], v[32:47]
    ds_read_b128 a[140:143], v229 offset:0
    s_waitcnt lgkmcnt(3)
    v_mfma_f32_32x32x16_bf16 v[16:31], a[128:131], v[160:163], v[16:31]
    v_mfma_f32_32x32x16_bf16 v[32:47], a[128:131], v[192:195], v[32:47]
    ds_read_b128 a[128:131], v222 offset:8192
    s_waitcnt lgkmcnt(3)
    v_mfma_f32_32x32x16_bf16 v[16:31], a[132:135], v[164:167], v[16:31]
    v_mfma_f32_32x32x16_bf16 v[32:47], a[132:135], v[196:199], v[32:47]
    ds_read_b128 a[132:135], v223 offset:8192
    s_waitcnt lgkmcnt(3)
    v_mfma_f32_32x32x16_bf16 v[16:31], a[136:139], v[168:171], v[16:31]
    v_mfma_f32_32x32x16_bf16 v[32:47], a[136:139], v[200:203], v[32:47]
    ds_read_b128 a[136:139], v224 offset:8192
    s_waitcnt lgkmcnt(3)
    v_mfma_f32_32x32x16_bf16 v[16:31], a[140:143], v[172:175], v[16:31]
    v_mfma_f32_32x32x16_bf16 v[32:47], a[140:143], v[204:207], v[32:47]
    ds_read_b128 a[140:143], v225 offset:8192
    s_waitcnt lgkmcnt(3)
    v_mfma_f32_32x32x16_bf16 v[48:63], a[128:131], v[144:147], 0
    v_mfma_f32_32x32x16_bf16 v[64:79], a[128:131], v[176:179], 0
    ds_read_b128 a[128:131], v226 offset:8192
    s_waitcnt lgkmcnt(3)
    v_mfma_f32_32x32x16_bf16 v[48:63], a[132:135], v[148:151], v[48:63]
    v_mfma_f32_32x32x16_bf16 v[64:79], a[132:135], v[180:183], v[64:79]
    ds_read_b128 a[132:135], v227 offset:8192
    s_waitcnt lgkmcnt(3)
    v_mfma_f32_32x32x16_bf16 v[48:63], a[136:139], v[152:155], v[48:63]
    v_mfma_f32_32x32x16_bf16 v[64:79], a[136:139], v[184:187], v[64:79]
    ds_read_b128 a[136:139], v228 offset:8192
    s_waitcnt lgkmcnt(3)
    v_mfma_f32_32x32x16_bf16 v[48:63], a[140:143], v[156:159], v[48:63]
    v_mfma_f32_32x32x16_bf16 v[64:79], a[140:143], v[188:191], v[64:79]
    ds_read_b128 a[140:143], v229 offset:8192
    s_waitcnt lgkmcnt(3)
    v_mfma_f32_32x32x16_bf16 v[48:63], a[128:131], v[160:163], v[48:63]
    v_mfma_f32_32x32x16_bf16 v[64:79], a[128:131], v[192:195], v[64:79]
    s_waitcnt lgkmcnt(2)
    v_mfma_f32_32x32x16_bf16 v[48:63], a[132:135], v[164:167], v[48:63]
    v_mfma_f32_32x32x16_bf16 v[64:79], a[132:135], v[196:199], v[64:79]
    s_waitcnt lgkmcnt(1)
    v_mfma_f32_32x32x16_bf16 v[48:63], a[136:139], v[168:171], v[48:63]
    v_mfma_f32_32x32x16_bf16 v[64:79], a[136:139], v[200:203], v[64:79]
    s_waitcnt lgkmcnt(0)
    v_mfma_f32_32x32x16_bf16 v[48:63], a[140:143], v[172:175], v[48:63]
    v_mfma_f32_32x32x16_bf16 v[64:79], a[140:143], v[204:207], v[64:79]
    v_mov_b32 v220, 0
    v_mov_b32 v221, 0
    v_mov_b32 v218, 0
    v_mov_b32 v219, 0
    s_mov_b32 s49, 0x29800000
    v_max3_f32 v1, v16, v17, v18
    v_max3_f32 v1, v1, v19, v20
    v_max3_f32 v1, v1, v21, v22
    v_max3_f32 v1, v1, v23, v24
    v_max3_f32 v1, v1, v25, v26
    v_max3_f32 v1, v1, v27, v28
    v_max3_f32 v1, v1, v29, v30
    s_nop 7
    v_max3_f32 v1, v1, v31, v48
    v_max3_f32 v1, v1, v49, v50
    v_max3_f32 v1, v1, v51, v52
    v_max3_f32 v1, v1, v53, v54
    v_max3_f32 v1, v1, v55, v56
    v_max3_f32 v1, v1, v57, v58
    v_max3_f32 v1, v1, v59, v60
    v_max3_f32 v1, v1, v61, v62
    v_max_f32 v1, v1, v63
    v_mov_b32 v2, v1
    s_nop 1
    v_permlane32_swap_b32 v2, v1
    v_max_f32 v1, v1, v2
    v_add_f32 v1, 0x42d00000, v1
    v_sub_f32 v16, v16, v1
    v_sub_f32 v48, v48, v1
    v_sub_f32 v80, 0, v1
    v_sub_f32 v17, v17, v1
    v_sub_f32 v49, v49, v1
    v_sub_f32 v81, 0, v1
    v_sub_f32 v18, v18, v1
    v_sub_f32 v50, v50, v1
    v_sub_f32 v82, 0, v1
    v_sub_f32 v19, v19, v1
    v_sub_f32 v51, v51, v1
    v_sub_f32 v83, 0, v1
    v_sub_f32 v20, v20, v1
    v_sub_f32 v52, v52, v1
    v_sub_f32 v84, 0, v1
    v_sub_f32 v21, v21, v1
    v_sub_f32 v53, v53, v1
    v_sub_f32 v85, 0, v1
    v_sub_f32 v22, v22, v1
    v_sub_f32 v54, v54, v1
    v_sub_f32 v86, 0, v1
    v_sub_f32 v23, v23, v1
    v_sub_f32 v55, v55, v1
    v_sub_f32 v87, 0, v1
    v_sub_f32 v24, v24, v1
    v_sub_f32 v56, v56, v1
    v_sub_f32 v88, 0, v1
    v_sub_f32 v25, v25, v1
    v_sub_f32 v57, v57, v1
    v_sub_f32 v89, 0, v1
    v_sub_f32 v26, v26, v1
    v_sub_f32 v58, v58, v1
    v_sub_f32 v90, 0, v1
    v_sub_f32 v27, v27, v1
    v_sub_f32 v59, v59, v1
    v_sub_f32 v91, 0, v1
    v_sub_f32 v28, v28, v1
    v_sub_f32 v60, v60, v1
    v_sub_f32 v92, 0, v1
    v_sub_f32 v29, v29, v1
    v_sub_f32 v61, v61, v1
    v_sub_f32 v93, 0, v1
    v_sub_f32 v30, v30, v1
    v_sub_f32 v62, v62, v1
    v_sub_f32 v94, 0, v1
    v_sub_f32 v31, v31, v1
    v_sub_f32 v63, v63, v1
    v_sub_f32 v95, 0, v1
    v_max3_f32 v1, v32, v33, v34
    v_max3_f32 v1, v1, v35, v36
    v_max3_f32 v1, v1, v37, v38
    v_max3_f32 v1, v1, v39, v40
    v_max3_f32 v1, v1, v41, v42
    v_max3_f32 v1, v1, v43, v44
    v_max3_f32 v1, v1, v45, v46
    v_max3_f32 v1, v1, v47, v64
    v_max3_f32 v1, v1, v65, v66
    v_max3_f32 v1, v1, v67, v68
    v_max3_f32 v1, v1, v69, v70
    v_max3_f32 v1, v1, v71, v72
    v_max3_f32 v1, v1, v73, v74
    v_max3_f32 v1, v1, v75, v76
    v_max3_f32 v1, v1, v77, v78
    v_max_f32 v1, v1, v79
    v_mov_b32 v2, v1
    s_nop 1
    v_permlane32_swap_b32 v2, v1
    v_max_f32 v1, v1, v2
    v_add_f32 v1, 0x42d00000, v1
    v_sub_f32 v32, v32, v1
    v_sub_f32 v64, v64, v1
    v_sub_f32 v96, 0, v1
    v_sub_f32 v33, v33, v1
    v_sub_f32 v65, v65, v1
    v_sub_f32 v97, 0, v1
    v_sub_f32 v34, v34, v1
    v_sub_f32 v66, v66, v1
    v_sub_f32 v98, 0, v1
    v_sub_f32 v35, v35, v1
    v_sub_f32 v67, v67, v1
    v_sub_f32 v99, 0, v1
    v_sub_f32 v36, v36, v1
    v_sub_f32 v68, v68, v1
    v_sub_f32 v100, 0, v1
    v_sub_f32 v37, v37, v1
    v_sub_f32 v69, v69, v1
    v_sub_f32 v101, 0, v1
    v_sub_f32 v38, v38, v1
    v_sub_f32 v70, v70, v1
    v_sub_f32 v102, 0, v1
    v_sub_f32 v39, v39, v1
    v_sub_f32 v71, v71, v1
    v_sub_f32 v103, 0, v1
    v_sub_f32 v40, v40, v1
    v_sub_f32 v72, v72, v1
    v_sub_f32 v104, 0, v1
    v_sub_f32 v41, v41, v1
    v_sub_f32 v73, v73, v1
    v_sub_f32 v105, 0, v1
    v_sub_f32 v42, v42, v1
    v_sub_f32 v74, v74, v1
    v_sub_f32 v106, 0, v1
    v_sub_f32 v43, v43, v1
    v_sub_f32 v75, v75, v1
    v_sub_f32 v107, 0, v1
    v_sub_f32 v44, v44, v1
    v_sub_f32 v76, v76, v1
    v_sub_f32 v108, 0, v1
    v_sub_f32 v45, v45, v1
    v_sub_f32 v77, v77, v1
    v_sub_f32 v109, 0, v1
    v_sub_f32 v46, v46, v1
    v_sub_f32 v78, v78, v1
    v_sub_f32 v110, 0, v1
    v_sub_f32 v47, v47, v1
    v_sub_f32 v79, v79, v1
    v_sub_f32 v111, 0, v1
    v_exp_f32 v208, v16
    v_exp_f32 v209, v17
    s_waitcnt vmcnt(8)
    s_barrier
    s_waitcnt lgkmcnt(0)
    v_exp_f32 v210, v18
    v_add_f32 v216, v208, v209
    v_cvt_pk_bf16_f32 v112, v208, v209
    v_exp_f32 v211, v19
    v_add_f32 v216, v216, v210
    v_exp_f32 v212, v20
    v_add_f32 v216, v216, v211
    v_cvt_pk_bf16_f32 v113, v210, v211
    v_exp_f32 v213, v21
    v_add_f32 v216, v216, v212
    v_add_f32 v220, v220, v218
    s_waitcnt lgkmcnt(0)
    v_exp_f32 v214, v22
    v_add_f32 v216, v216, v213
    v_cvt_pk_bf16_f32 v114, v212, v213
    v_exp_f32 v215, v23
    v_add_f32 v216, v216, v214
    v_exp_f32 v208, v24
    v_add_f32 v216, v216, v215
    v_cvt_pk_bf16_f32 v115, v214, v215
    v_exp_f32 v209, v25
    v_add_f32 v216, v216, v208
    v_add_f32 v221, v221, v219
    s_waitcnt lgkmcnt(0)
    s_add_u32 m0, s45, 49152
    v_exp_f32 v210, v26
    v_add_f32 v216, v216, v209
    v_cvt_pk_bf16_f32 v116, v208, v209
    v_exp_f32 v211, v27
    v_add_f32 v216, v216, v210
    v_exp_f32 v212, v28
    v_add_f32 v216, v216, v211
    v_cvt_pk_bf16_f32 v117, v210, v211
    buffer_load_dwordx4 v234, s[16:19], s43 offen offset:0  lds
    v_exp_f32 v213, v29
    v_add_f32 v216, v216, v212
    s_waitcnt lgkmcnt(0)
    v_exp_f32 v214, v30
    v_add_f32 v216, v216, v213
    v_cvt_pk_bf16_f32 v118, v212, v213
    v_exp_f32 v215, v31
    v_add_f32 v216, v216, v214
    v_exp_f32 v208, v32
    v_add_f32 v216, v216, v215
    v_cvt_pk_bf16_f32 v119, v214, v215
    buffer_load_dwordx4 v235, s[16:19], s43 offen offset:1024  lds
    v_exp_f32 v209, v33
    s_waitcnt lgkmcnt(0)
    v_exp_f32 v210, v34
    v_add_f32 v217, v208, v209
    v_cvt_pk_bf16_f32 v120, v208, v209
    v_exp_f32 v211, v35
    v_add_f32 v217, v217, v210
    v_exp_f32 v212, v36
    v_add_f32 v217, v217, v211
    v_cvt_pk_bf16_f32 v121, v210, v211
    buffer_load_dwordx4 v236, s[16:19], s43 offen offset:2048  lds
    v_exp_f32 v213, v37
    v_add_f32 v217, v217, v212
    s_waitcnt lgkmcnt(0)
    v_exp_f32 v214, v38
    v_add_f32 v217, v217, v213
    v_cvt_pk_bf16_f32 v122, v212, v213
    v_exp_f32 v215, v39
    v_add_f32 v217, v217, v214
    v_exp_f32 v208, v40
    v_add_f32 v217, v217, v215
    v_cvt_pk_bf16_f32 v123, v214, v215
    buffer_load_dwordx4 v237, s[16:19], s43 offen offset:3072  lds
    v_exp_f32 v209, v41
    v_add_f32 v217, v217, v208
    s_waitcnt lgkmcnt(0)
    ds_read_b128 a[128:131], v222 offset:16384
    v_exp_f32 v210, v42
    v_add_f32 v217, v217, v209
    v_cvt_pk_bf16_f32 v124, v208, v209
    ds_read_b64_tr_b16 a[144:145], v230 offset:0
    v_exp_f32 v211, v43
    v_add_f32 v217, v217, v210
    ds_read_b64_tr_b16 a[146:147], v230 offset:2048
    v_exp_f32 v212, v44
    v_add_f32 v217, v217, v211
    v_cvt_pk_bf16_f32 v125, v210, v211
    s_add_u32 s43, s43, 16384
    v_exp_f32 v213, v45
    v_add_f32 v217, v217, v212
    s_waitcnt lgkmcnt(3)
    ds_read_b128 a[132:135], v223 offset:16384
    s_lshr_b32 s14, s32, 1
    s_lshl_b32 s14, s14, 15
    s_lshl_b32 s15, s40, 19
    s_add_u32 s14, s14, s15
    buffer_load_dword v248, v251, s[28:31], s14 offen
    v_exp_f32 v214, v46
    v_add_f32 v217, v217, v213
    v_cvt_pk_bf16_f32 v126, v212, v213
    ds_read_b64_tr_b16 a[148:149], v230 offset:4096
    s_add_u32 s14, s14, 16384
    buffer_load_dword v249, v251, s[28:31], s14 offen
    v_exp_f32 v215, v47
    v_add_f32 v217, v217, v214
    ds_read_b64_tr_b16 a[150:151], v230 offset:6144
    v_add_f32 v217, v217, v215
    v_cvt_pk_bf16_f32 v127, v214, v215
    v_max_f32 v1, v216, v217
    v_cmp_lt_f32 vcc, s49, v1
    v_exp_f32 v208, v48
    v_exp_f32 v209, v49
    s_cbranch_vccnz L_rare_s0
L_back_s0:
    s_mov_b32 s50, 7
L_main:
    s_waitcnt lgkmcnt(3)
    v_mfma_f32_32x32x16_bf16 v[16:31], a[128:131], v[144:147], v[80:95]
    ds_read_b128 a[136:139], v224 offset:16384
    v_exp_f32 v210, v50
    v_add_f32 v218, v208, v209
    v_cvt_pk_bf16_f32 v128, v208, v209
    v_mfma_f32_32x32x16_bf16 v[32:47], a[128:131], v[176:179], v[96:111]
    ds_read_b64_tr_b16 a[152:153], v231 offset:0
    v_exp_f32 v211, v51
    v_add_f32 v218, v218, v210
    v_mfma_f32_32x32x16_bf16 a[0:15], a[144:147], v[112:115], a[0:15]
    ds_read_b64_tr_b16 a[154:155], v231 offset:2048
    v_exp_f32 v212, v52
    v_add_f32 v218, v218, v211
    v_cvt_pk_bf16_f32 v129, v210, v211
    v_mfma_f32_32x32x16_bf16 a[16:31], a[144:147], v[120:123], a[16:31]
    v_exp_f32 v213, v53
    v_add_f32 v218, v218, v212
    v_add_f32 v220, v220, v216
    s_waitcnt lgkmcnt(3)
    v_mfma_f32_32x32x16_bf16 v[16:31], a[132:135], v[148:151], v[16:31]
    ds_read_b128 a[140:143], v225 offset:16384
    v_exp_f32 v214, v54
    v_add_f32 v218, v218, v213
    v_cvt_pk_bf16_f32 v130, v212, v213
    v_mfma_f32_32x32x16_bf16 v[32:47], a[132:135], v[180:183], v[32:47]
    ds_read_b64_tr_b16 a[156:157], v231 offset:4096
    v_exp_f32 v215, v55
    v_add_f32 v218, v218, v214
    v_mfma_f32_32x32x16_bf16 a[0:15], a[148:151], v[116:119], a[0:15]
    ds_read_b64_tr_b16 a[158:159], v231 offset:6144
    v_exp_f32 v208, v56
    v_add_f32 v218, v218, v215
    v_cvt_pk_bf16_f32 v131, v214, v215
    v_mfma_f32_32x32x16_bf16 a[16:31], a[148:151], v[124:127], a[16:31]
    v_exp_f32 v209, v57
    v_add_f32 v218, v218, v208
    v_add_f32 v221, v221, v217
    s_waitcnt lgkmcnt(3)
    v_mfma_f32_32x32x16_bf16 v[16:31], a[136:139], v[152:155], v[16:31]
    ds_read_b128 a[128:131], v226 offset:16384
    s_add_u32 m0, s46, 32768
    v_exp_f32 v210, v58
    v_add_f32 v218, v218, v209
    v_cvt_pk_bf16_f32 v132, v208, v209
    v_mfma_f32_32x32x16_bf16 v[32:47], a[136:139], v[184:187], v[32:47]
    ds_read_b64_tr_b16 a[144:145], v232 offset:0
    v_exp_f32 v211, v59
    v_add_f32 v218, v218, v210
    v_mfma_f32_32x32x16_bf16 a[32:47], a[152:155], v[112:115], a[32:47]
    ds_read_b64_tr_b16 a[146:147], v232 offset:2048
    v_exp_f32 v212, v60
    v_add_f32 v218, v218, v211
    v_cvt_pk_bf16_f32 v133, v210, v211
    v_mfma_f32_32x32x16_bf16 a[48:63], a[152:155], v[120:123], a[48:63]
    buffer_load_dwordx4 v238, s[20:23], s44 offen offset:0  lds
    v_exp_f32 v213, v61
    v_add_f32 v218, v218, v212
    s_waitcnt lgkmcnt(3)
    v_mfma_f32_32x32x16_bf16 v[16:31], a[140:143], v[156:159], v[16:31]
    ds_read_b128 a[132:135], v227 offset:16384
    v_exp_f32 v214, v62
    v_add_f32 v218, v218, v213
    v_cvt_pk_bf16_f32 v134, v212, v213
    v_mfma_f32_32x32x16_bf16 v[32:47], a[140:143], v[188:191], v[32:47]
    ds_read_b64_tr_b16 a[148:149], v232 offset:4096
    v_exp_f32 v215, v63
    v_add_f32 v218, v218, v214
    v_mfma_f32_32x32x16_bf16 a[32:47], a[156:159], v[116:119], a[32:47]
    ds_read_b64_tr_b16 a[150:151], v232 offset:6144
    v_exp_f32 v208, v64
    v_add_f32 v218, v218, v215
    v_cvt_pk_bf16_f32 v135, v214, v215
    v_mfma_f32_32x32x16_bf16 a[48:63], a[156:159], v[124:127], a[48:63]
    buffer_load_dwordx4 v238, s[20:23], s44 offen offset:1024  lds
    v_exp_f32 v209, v65
    s_waitcnt lgkmcnt(3)
    v_mfma_f32_32x32x16_bf16 v[16:31], a[128:131], v[160:163], v[16:31]
    ds_read_b128 a[136:139], v228 offset:16384
    v_exp_f32 v210, v66
    v_add_f32 v219, v208, v209
    v_cvt_pk_bf16_f32 v136, v208, v209
    v_mfma_f32_32x32x16_bf16 v[32:47], a[128:131], v[192:195], v[32:47]
    ds_read_b64_tr_b16 a[152:153], v233 offset:0
    v_exp_f32 v211, v67
    v_add_f32 v219, v219, v210
    v_mfma_f32_32x32x16_bf16 a[64:79], a[144:147], v[112:115], a[64:79]
    ds_read_b64_tr_b16 a[154:155], v233 offset:2048
    v_exp_f32 v212, v68
    v_add_f32 v219, v219, v211
    v_cvt_pk_bf16_f32 v137, v210, v211
    v_mfma_f32_32x32x16_bf16 a[80:95], a[144:147], v[120:123], a[80:95]
    buffer_load_dwordx4 v238, s[20:23], s44 offen offset:2048  lds
    v_exp_f32 v213, v69
    v_add_f32 v219, v219, v212
    s_waitcnt lgkmcnt(3)
    v_mfma_f32_32x32x16_bf16 v[16:31], a[132:135], v[164:167], v[16:31]
    ds_read_b128 a[140:143], v229 offset:16384
    v_exp_f32 v214, v70
    v_add_f32 v219, v219, v213
    v_cvt_pk_bf16_f32 v138, v212, v213
    v_mfma_f32_32x32x16_bf16 v[32:47], a[132:135], v[196:199], v[32:47]
    ds_read_b64_tr_b16 a[156:157], v233 offset:4096
    v_exp_f32 v215, v71
    v_add_f32 v219, v219, v214
    v_mfma_f32_32x32x16_bf16 a[64:79], a[148:151], v[116:119], a[64:79]
    ds_read_b64_tr_b16 a[158:159], v233 offset:6144
    v_exp_f32 v208, v72
    v_add_f32 v219, v219, v215
    v_cvt_pk_bf16_f32 v139, v214, v215
    v_mfma_f32_32x32x16_bf16 a[80:95], a[148:151], v[124:127], a[80:95]
    buffer_load_dwordx4 v238, s[20:23], s44 offen offset:3072  lds
    v_exp_f32 v209, v73
    v_add_f32 v219, v219, v208
    s_waitcnt lgkmcnt(3)
    v_mfma_f32_32x32x16_bf16 v[16:31], a[136:139], v[168:171], v[16:31]
    ds_read_b128 a[128:131], v222 offset:24576
    v_exp_f32 v210, v74
    v_add_f32 v219, v219, v209
    v_cvt_pk_bf16_f32 v140, v208, v209
    v_mfma_f32_32x32x16_bf16 v[32:47], a[136:139], v[200:203], v[32:47]
    ds_read_b64_tr_b16 a[144:145], v230 offset:8192
    v_exp_f32 v211, v75
    v_add_f32 v219, v219, v210
    v_mfma_f32_32x32x16_bf16 a[96:111], a[152:155], v[112:115], a[96:111]
    ds_read_b64_tr_b16 a[146:147], v230 offset:10240
    v_exp_f32 v212, v76
    v_add_f32 v219, v219, v211
    v_cvt_pk_bf16_f32 v141, v210, v211
    v_mfma_f32_32x32x16_bf16 a[112:127], a[152:155], v[120:123], a[112:127]
    s_add_u32 s44, s44, 16384
    v_exp_f32 v213, v77
    v_add_f32 v219, v219, v212
    s_waitcnt lgkmcnt(3)
    v_mfma_f32_32x32x16_bf16 v[16:31], a[140:143], v[172:175], v[16:31]
    ds_read_b128 a[132:135], v223 offset:24576
    v_exp_f32 v214, v78
    v_add_f32 v219, v219, v213
    v_cvt_pk_bf16_f32 v142, v212, v213
    v_mfma_f32_32x32x16_bf16 v[32:47], a[140:143], v[204:207], v[32:47]
    ds_read_b64_tr_b16 a[148:149], v230 offset:12288
    v_exp_f32 v215, v79
    v_add_f32 v219, v219, v214
    v_mfma_f32_32x32x16_bf16 a[96:111], a[156:159], v[116:119], a[96:111]
    ds_read_b64_tr_b16 a[150:151], v230 offset:14336
    v_add_f32 v219, v219, v215
    v_cvt_pk_bf16_f32 v143, v214, v215
    v_max_f32 v1, v218, v219
    v_cmp_lt_f32 vcc, s49, v1
    v_exp_f32 v208, v16
    v_mfma_f32_32x32x16_bf16 a[112:127], a[156:159], v[124:127], a[112:127]
    v_exp_f32 v209, v17
    s_cbranch_vccnz L_rare_m1
L_back_m1:
    s_waitcnt lgkmcnt(3)
    v_mfma_f32_32x32x16_bf16 v[48:63], a[128:131], v[144:147], v[80:95]
    ds_read_b128 a[136:139], v224 offset:24576
    v_exp_f32 v210, v18
    v_add_f32 v216, v208, v209
    v_cvt_pk_bf16_f32 v112, v208, v209
    v_mfma_f32_32x32x16_bf16 v[64:79], a[128:131], v[176:179], v[96:111]
    ds_read_b64_tr_b16 a[152:153], v231 offset:8192
    v_exp_f32 v211, v19
    v_add_f32 v216, v216, v210
    s_waitcnt vmcnt(8)
    s_barrier
    v_mfma_f32_32x32x16_bf16 a[0:15], a[144:147], v[128:131], a[0:15]
    ds_read_b64_tr_b16 a[154:155], v231 offset:10240
    v_exp_f32 v212, v20
    v_add_f32 v216, v216, v211
    v_cvt_pk_bf16_f32 v113, v210, v211
    v_mfma_f32_32x32x16_bf16 a[16:31], a[144:147], v[136:139], a[16:31]
    v_exp_f32 v213, v21
    v_add_f32 v216, v216, v212
    v_add_f32 v220, v220, v218
    s_waitcnt lgkmcnt(3)
    v_mfma_f32_32x32x16_bf16 v[48:63], a[132:135], v[148:151], v[48:63]
    ds_read_b128 a[140:143], v225 offset:24576
    v_exp_f32 v214, v22
    v_add_f32 v216, v216, v213
    v_cvt_pk_bf16_f32 v114, v212, v213
    v_mfma_f32_32x32x16_bf16 v[64:79], a[132:135], v[180:183], v[64:79]
    ds_read_b64_tr_b16 a[156:157], v231 offset:12288
    v_exp_f32 v215, v23
    v_add_f32 v216, v216, v214
    v_mfma_f32_32x32x16_bf16 a[0:15], a[148:151], v[132:135], a[0:15]
    ds_read_b64_tr_b16 a[158:159], v231 offset:14336
    v_exp_f32 v208, v24
    v_add_f32 v216, v216, v215
    v_cvt_pk_bf16_f32 v115, v214, v215
    v_mfma_f32_32x32x16_bf16 a[16:31], a[148:151], v[140:143], a[16:31]
    v_exp_f32 v209, v25
    v_add_f32 v216, v216, v208
    v_add_f32 v221, v221, v219
    s_waitcnt lgkmcnt(3)
    v_mfma_f32_32x32x16_bf16 v[48:63], a[136:139], v[152:155], v[48:63]
    ds_read_b128 a[128:131], v226 offset:24576
    s_add_u32 m0, s45, 0
    v_exp_f32 v210, v26
    v_add_f32 v216, v216, v209
    v_cvt_pk_bf16_f32 v116, v208, v209
    v_mfma_f32_32x32x16_bf16 v[64:79], a[136:139], v[184:187], v[64:79]
    ds_read_b64_tr_b16 a[144:145], v232 offset:8192
    v_exp_f32 v211, v27
    v_add_f32 v216, v216, v210
    v_mfma_f32_32x32x16_bf16 a[32:47], a[152:155], v[128:131], a[32:47]
    ds_read_b64_tr_b16 a[146:147], v232 offset:10240
    v_exp_f32 v212, v28
    v_add_f32 v216, v216, v211
    v_cvt_pk_bf16_f32 v117, v210, v211
    v_mfma_f32_32x32x16_bf16 a[48:63], a[152:155], v[136:139], a[48:63]
    buffer_load_dwordx4 v234, s[16:19], s43 offen offset:0  lds
    v_exp_f32 v213, v29
    v_add_f32 v216, v216, v212
    s_waitcnt lgkmcnt(3)
    v_mfma_f32_32x32x16_bf16 v[48:63], a[140:143], v[156:159], v[48:63]
    ds_read_b128 a[132:135], v227 offset:24576
    v_exp_f32 v214, v30
    v_add_f32 v216, v216, v213
    v_cvt_pk_bf16_f32 v118, v212, v213
    v_mfma_f32_32x32x16_bf16 v[64:79], a[140:143], v[188:191], v[64:79]
    ds_read_b64_tr_b16 a[148:149], v232 offset:12288
    v_exp_f32 v215, v31
    v_add_f32 v216, v216, v214
    v_mfma_f32_32x32x16_bf16 a[32:47], a[156:159], v[132:135], a[32:47]
    ds_read_b64_tr_b16 a[150:151], v232 offset:14336
    v_exp_f32 v208, v32
    v_add_f32 v216, v216, v215
    v_cvt_pk_bf16_f32 v119, v214, v215
    v_mfma_f32_32x32x16_bf16 a[48:63], a[156:159], v[140:143], a[48:63]
    buffer_load_dwordx4 v235, s[16:19], s43 offen offset:1024  lds
    v_exp_f32 v209, v33
    s_waitcnt lgkmcnt(3)
    v_mfma_f32_32x32x16_bf16 v[48:63], a[128:131], v[160:163], v[48:63]
    ds_read_b128 a[136:139], v228 offset:24576
    v_exp_f32 v210, v34
    v_add_f32 v217, v208, v209
    v_cvt_pk_bf16_f32 v120, v208, v209
    v_mfma_f32_32x32x16_bf16 v[64:79], a[128:131], v[192:195], v[64:79]
    ds_read_b64_tr_b16 a[152:153], v233 offset:8192
    v_exp_f32 v211, v35
    v_add_f32 v217, v217, v210
    v_mfma_f32_32x32x16_bf16 a[64:79], a[144:147], v[128:131], a[64:79]
    ds_read_b64_tr_b16 a[154:155], v233 offset:10240
    v_exp_f32 v212, v36
    v_add_f32 v217, v217, v211
    v_cvt_pk_bf16_f32 v121, v210, v211
    v_mfma_f32_32x32x16_bf16 a[80:95], a[144:147], v[136:139], a[80:95]
    buffer_load_dwordx4 v236, s[16:19], s43 offen offset:2048  lds
    v_exp_f32 v213, v37
    v_add_f32 v217, v217, v212
    s_waitcnt lgkmcnt(3)
    v_mfma_f32_32x32x16_bf16 v[48:63], a[132:135], v[164:167], v[48:63]
    ds_read_b128 a[140:143], v229 offset:24576
    v_exp_f32 v214, v38
    v_add_f32 v217, v217, v213
    v_cvt_pk_bf16_f32 v122, v212, v213
    v_mfma_f32_32x32x16_bf16 v[64:79], a[132:135], v[196:199], v[64:79]
    ds_read_b64_tr_b16 a[156:157], v233 offset:12288
    v_exp_f32 v215, v39
    v_add_f32 v217, v217, v214
    v_mfma_f32_32x32x16_bf16 a[64:79], a[148:151], v[132:135], a[64:79]
    ds_read_b64_tr_b16 a[158:159], v233 offset:14336
    v_exp_f32 v208, v40
    v_add_f32 v217, v217, v215
    v_cvt_pk_bf16_f32 v123, v214, v215
    v_mfma_f32_32x32x16_bf16 a[80:95], a[148:151], v[140:143], a[80:95]
    buffer_load_dwordx4 v237, s[16:19], s43 offen offset:3072  lds
    v_exp_f32 v209, v41
    v_add_f32 v217, v217, v208
    s_waitcnt lgkmcnt(3)
    v_mfma_f32_32x32x16_bf16 v[48:63], a[136:139], v[168:171], v[48:63]
    ds_read_b128 a[128:131], v222 offset:32768
    v_exp_f32 v210, v42
    v_add_f32 v217, v217, v209
    v_cvt_pk_bf16_f32 v124, v208, v209
    v_mfma_f32_32x32x16_bf16 v[64:79], a[136:139], v[200:203], v[64:79]
    ds_read_b64_tr_b16 a[144:145], v230 offset:16384
    v_exp_f32 v211, v43
    v_add_f32 v217, v217, v210
    v_mfma_f32_32x32x16_bf16 a[96:111], a[152:155], v[128:131], a[96:111]
    ds_read_b64_tr_b16 a[146:147], v230 offset:18432
    v_exp_f32 v212, v44
    v_add_f32 v217, v217, v211
    v_cvt_pk_bf16_f32 v125, v210, v211
    v_mfma_f32_32x32x16_bf16 a[112:127], a[152:155], v[136:139], a[112:127]
    s_add_u32 s43, s43, 16384
    v_exp_f32 v213, v45
    v_add_f32 v217, v217, v212
    s_waitcnt lgkmcnt(3)
    v_mfma_f32_32x32x16_bf16 v[48:63], a[140:143], v[172:175], v[48:63]
    ds_read_b128 a[132:135], v223 offset:32768
    v_exp_f32 v214, v46
    v_add_f32 v217, v217, v213
    v_cvt_pk_bf16_f32 v126, v212, v213
    v_mfma_f32_32x32x16_bf16 v[64:79], a[140:143], v[204:207], v[64:79]
    ds_read_b64_tr_b16 a[148:149], v230 offset:20480
    v_exp_f32 v215, v47
    v_add_f32 v217, v217, v214
    v_mfma_f32_32x32x16_bf16 a[96:111], a[156:159], v[132:135], a[96:111]
    ds_read_b64_tr_b16 a[150:151], v230 offset:22528
    v_add_f32 v217, v217, v215
    v_cvt_pk_bf16_f32 v127, v214, v215
    v_max_f32 v1, v216, v217
    v_cmp_lt_f32 vcc, s49, v1
    v_exp_f32 v208, v48
    v_mfma_f32_32x32x16_bf16 a[112:127], a[156:159], v[140:143], a[112:127]
    v_exp_f32 v209, v49
    s_cbranch_vccnz L_rare_m2
L_back_m2:
    s_waitcnt lgkmcnt(3)
    v_mfma_f32_32x32x16_bf16 v[16:31], a[128:131], v[144:147], v[80:95]
    ds_read_b128 a[136:139], v224 offset:32768
    v_exp_f32 v210, v50
    v_add_f32 v218, v208, v209
    v_cvt_pk_bf16_f32 v128, v208, v209
    v_mfma_f32_32x32x16_bf16 v[32:47], a[128:131], v[176:179], v[96:111]
    ds_read_b64_tr_b16 a[152:153], v231 offset:16384
    v_exp_f32 v211, v51
    v_add_f32 v218, v218, v210
    v_mfma_f32_32x32x16_bf16 a[0:15], a[144:147], v[112:115], a[0:15]
    ds_read_b64_tr_b16 a[154:155], v231 offset:18432
    v_exp_f32 v212, v52
    v_add_f32 v218, v218, v211
    v_cvt_pk_bf16_f32 v129, v210, v211
    v_mfma_f32_32x32x16_bf16 a[16:31], a[144:147], v[120:123], a[16:31]
    v_exp_f32 v213, v53
    v_add_f32 v218, v218, v212
    v_add_f32 v220, v220, v216
    s_waitcnt lgkmcnt(3)
    v_mfma_f32_32x32x16_bf16 v[16:31], a[132:135], v[148:151], v[16:31]
    ds_read_b128 a[140:143], v225 offset:32768
    v_exp_f32 v214, v54
    v_add_f32 v218, v218, v213
    v_cvt_pk_bf16_f32 v130, v212, v213
    v_mfma_f32_32x32x16_bf16 v[32:47], a[132:135], v[180:183], v[32:47]
    ds_read_b64_tr_b16 a[156:157], v231 offset:20480
    v_exp_f32 v215, v55
    v_add_f32 v218, v218, v214
    v_mfma_f32_32x32x16_bf16 a[0:15], a[148:151], v[116:119], a[0:15]
    ds_read_b64_tr_b16 a[158:159], v231 offset:22528
    v_exp_f32 v208, v56
    v_add_f32 v218, v218, v215
    v_cvt_pk_bf16_f32 v131, v214, v215
    v_mfma_f32_32x32x16_bf16 a[16:31], a[148:151], v[124:127], a[16:31]
    v_exp_f32 v209, v57
    v_add_f32 v218, v218, v208
    v_add_f32 v221, v221, v217
    s_waitcnt lgkmcnt(3)
    v_mfma_f32_32x32x16_bf16 v[16:31], a[136:139], v[152:155], v[16:31]
    ds_read_b128 a[128:131], v226 offset:32768
    s_add_u32 m0, s46, 49152
    v_exp_f32 v210, v58
    v_add_f32 v218, v218, v209
    v_cvt_pk_bf16_f32 v132, v208, v209
    v_mfma_f32_32x32x16_bf16 v[32:47], a[136:139], v[184:187], v[32:47]
    ds_read_b64_tr_b16 a[144:145], v232 offset:16384
    v_exp_f32 v211, v59
    v_add_f32 v218, v218, v210
    v_mfma_f32_32x32x16_bf16 a[32:47], a[152:155], v[112:115], a[32:47]
    ds_read_b64_tr_b16 a[146:147], v232 offset:18432
    v_exp_f32 v212, v60
    v_add_f32 v218, v218, v211
    v_cvt_pk_bf16_f32 v133, v210, v211
    v_mfma_f32_32x32x16_bf16 a[48:63], a[152:155], v[120:123], a[48:63]
    buffer_load_dwordx4 v238, s[20:23], s44 offen offset:0  lds
    v_exp_f32 v213, v61
    v_add_f32 v218, v218, v212
    s_waitcnt lgkmcnt(3)
    v_mfma_f32_32x32x16_bf16 v[16:31], a[140:143], v[156:159], v[16:31]
    ds_read_b128 a[132:135], v227 offset:32768
    v_exp_f32 v214, v62
    v_add_f32 v218, v218, v213
    v_cvt_pk_bf16_f32 v134, v212, v213
    v_mfma_f32_32x32x16_bf16 v[32:47], a[140:143], v[188:191], v[32:47]
    ds_read_b64_tr_b16 a[148:149], v232 offset:20480
    v_exp_f32 v215, v63
    v_add_f32 v218, v218, v214
    v_mfma_f32_32x32x16_bf16 a[32:47], a[156:159], v[116:119], a[32:47]
    ds_read_b64_tr_b16 a[150:151], v232 offset:22528
    v_exp_f32 v208, v64
    v_add_f32 v218, v218, v215
    v_cvt_pk_bf16_f32 v135, v214, v215
    v_mfma_f32_32x32x16_bf16 a[48:63], a[156:159], v[124:127], a[48:63]
    buffer_load_dwordx4 v238, s[20:23], s44 offen offset:1024  lds
    v_exp_f32 v209, v65
    s_waitcnt lgkmcnt(3)
    v_mfma_f32_32x32x16_bf16 v[16:31], a[128:131], v[160:163], v[16:31]
    ds_read_b128 a[136:139], v228 offset:32768
    v_exp_f32 v210, v66
    v_add_f32 v219, v208, v209
    v_cvt_pk_bf16_f32 v136, v208, v209
    v_mfma_f32_32x32x16_bf16 v[32:47], a[128:131], v[192:195], v[32:47]
    ds_read_b64_tr_b16 a[152:153], v233 offset:16384
    v_exp_f32 v211, v67
    v_add_f32 v219, v219, v210
    v_mfma_f32_32x32x16_bf16 a[64:79], a[144:147], v[112:115], a[64:79]
    ds_read_b64_tr_b16 a[154:155], v233 offset:18432
    v_exp_f32 v212, v68
    v_add_f32 v219, v219, v211
    v_cvt_pk_bf16_f32 v137, v210, v211
    v_mfma_f32_32x32x16_bf16 a[80:95], a[144:147], v[120:123], a[80:95]
    buffer_load_dwordx4 v238, s[20:23], s44 offen offset:2048  lds
    v_exp_f32 v213, v69
    v_add_f32 v219, v219, v212
    s_waitcnt lgkmcnt(3)
    v_mfma_f32_32x32x16_bf16 v[16:31], a[132:135], v[164:167], v[16:31]
    ds_read_b128 a[140:143], v229 offset:32768
    v_exp_f32 v214, v70
    v_add_f32 v219, v219, v213
    v_cvt_pk_bf16_f32 v138, v212, v213
    v_mfma_f32_32x32x16_bf16 v[32:47], a[132:135], v[196:199], v[32:47]
    ds_read_b64_tr_b16 a[156:157], v233 offset:20480
    v_exp_f32 v215, v71
    v_add_f32 v219, v219, v214
    v_mfma_f32_32x32x16_bf16 a[64:79], a[148:151], v[116:119], a[64:79]
    ds_read_b64_tr_b16 a[158:159], v233 offset:22528
    v_exp_f32 v208, v72
    v_add_f32 v219, v219, v215
    v_cvt_pk_bf16_f32 v139, v214, v215
    v_mfma_f32_32x32x16_bf16 a[80:95], a[148:151], v[124:127], a[80:95]
    buffer_load_dwordx4 v238, s[20:23], s44 offen offset:3072  lds
    v_exp_f32 v209, v73
    v_add_f32 v219, v219, v208
    s_waitcnt lgkmcnt(3)
    v_mfma_f32_32x32x16_bf16 v[16:31], a[136:139], v[168:171], v[16:31]
    ds_read_b128 a[128:131], v222 offset:40960
    v_exp_f32 v210, v74
    v_add_f32 v219, v219, v209
    v_cvt_pk_bf16_f32 v140, v208, v209
    v_mfma_f32_32x32x16_bf16 v[32:47], a[136:139], v[200:203], v[32:47]
    ds_read_b64_tr_b16 a[144:145], v230 offset:24576
    v_exp_f32 v211, v75
    v_add_f32 v219, v219, v210
    v_mfma_f32_32x32x16_bf16 a[96:111], a[152:155], v[112:115], a[96:111]
    ds_read_b64_tr_b16 a[146:147], v230 offset:26624
    v_exp_f32 v212, v76
    v_add_f32 v219, v219, v211
    v_cvt_pk_bf16_f32 v141, v210, v211
    v_mfma_f32_32x32x16_bf16 a[112:127], a[152:155], v[120:123], a[112:127]
    s_add_u32 s44, s44, 16384
    v_exp_f32 v213, v77
    v_add_f32 v219, v219, v212
    s_waitcnt lgkmcnt(3)
    v_mfma_f32_32x32x16_bf16 v[16:31], a[140:143], v[172:175], v[16:31]
    ds_read_b128 a[132:135], v223 offset:40960
    v_exp_f32 v214, v78
    v_add_f32 v219, v219, v213
    v_cvt_pk_bf16_f32 v142, v212, v213
    v_mfma_f32_32x32x16_bf16 v[32:47], a[140:143], v[204:207], v[32:47]
    ds_read_b64_tr_b16 a[148:149], v230 offset:28672
    v_exp_f32 v215, v79
    v_add_f32 v219, v219, v214
    v_mfma_f32_32x32x16_bf16 a[96:111], a[156:159], v[116:119], a[96:111]
    ds_read_b64_tr_b16 a[150:151], v230 offset:30720
    v_add_f32 v219, v219, v215
    v_cvt_pk_bf16_f32 v143, v214, v215
    v_max_f32 v1, v218, v219
    v_cmp_lt_f32 vcc, s49, v1
    v_exp_f32 v208, v16
    v_mfma_f32_32x32x16_bf16 a[112:127], a[156:159], v[124:127], a[112:127]
    v_exp_f32 v209, v17
    s_cbranch_vccnz L_rare_m3
L_back_m3:
    s_waitcnt lgkmcnt(3)
    v_mfma_f32_32x32x16_bf16 v[48:63], a[128:131], v[144:147], v[80:95]
    ds_read_b128 a[136:139], v224 offset:40960
    v_exp_f32 v210, v18
    v_add_f32 v216, v208, v209
    v_cvt_pk_bf16_f32 v112, v208, v209
    v_mfma_f32_32x32x16_bf16 v[64:79], a[128:131], v[176:179], v[96:111]
    ds_read_b64_tr_b16 a[152:153], v231 offset:24576
    v_exp_f32 v211, v19
    v_add_f32 v216, v216, v210
    s_waitcnt vmcnt(8)
    s_barrier
    v_mfma_f32_32x32x16_bf16 a[0:15], a[144:147], v[128:131], a[0:15]
    ds_read_b64_tr_b16 a[154:155], v231 offset:26624
    v_exp_f32 v212, v20
    v_add_f32 v216, v216, v211
    v_cvt_pk_bf16_f32 v113, v210, v211
    v_mfma_f32_32x32x16_bf16 a[16:31], a[144:147], v[136:139], a[16:31]
    v_exp_f32 v213, v21
    v_add_f32 v216, v216, v212
    v_add_f32 v220, v220, v218
    s_waitcnt lgkmcnt(3)
    v_mfma_f32_32x32x16_bf16 v[48:63], a[132:135], v[148:151], v[48:63]
    ds_read_b128 a[140:143], v225 offset:40960
    v_exp_f32 v214, v22
    v_add_f32 v216, v216, v213
    v_cvt_pk_bf16_f32 v114, v212, v213
    v_mfma_f32_32x32x16_bf16 v[64:79], a[132:135], v[180:183], v[64:79]
    ds_read_b64_tr_b16 a[156:157], v231 offset:28672
    v_exp_f32 v215, v23
    v_add_f32 v216, v216, v214
    v_mfma_f32_32x32x16_bf16 a[0:15], a[148:151], v[132:135], a[0:15]
    ds_read_b64_tr_b16 a[158:159], v231 offset:30720
    v_exp_f32 v208, v24
    v_add_f32 v216, v216, v215
    v_cvt_pk_bf16_f32 v115, v214, v215
    v_mfma_f32_32x32x16_bf16 a[16:31], a[148:151], v[140:143], a[16:31]
    v_exp_f32 v209, v25
    v_add_f32 v216, v216, v208
    v_add_f32 v221, v221, v219
    s_waitcnt lgkmcnt(3)
    v_mfma_f32_32x32x16_bf16 v[48:63], a[136:139], v[152:155], v[48:63]
    ds_read_b128 a[128:131], v226 offset:40960
    s_add_u32 m0, s45, 16384
    v_exp_f32 v210, v26
    v_add_f32 v216, v216, v209
    v_cvt_pk_bf16_f32 v116, v208, v209
    v_mfma_f32_32x32x16_bf16 v[64:79], a[136:139], v[184:187], v[64:79]
    ds_read_b64_tr_b16 a[144:145], v232 offset:24576
    v_exp_f32 v211, v27
    v_add_f32 v216, v216, v210
    v_mfma_f32_32x32x16_bf16 a[32:47], a[152:155], v[128:131], a[32:47]
    ds_read_b64_tr_b16 a[146:147], v232 offset:26624
    v_exp_f32 v212, v28
    v_add_f32 v216, v216, v211
    v_cvt_pk_bf16_f32 v117, v210, v211
    v_mfma_f32_32x32x16_bf16 a[48:63], a[152:155], v[136:139], a[48:63]
    buffer_load_dwordx4 v234, s[16:19], s43 offen offset:0  lds
    v_exp_f32 v213, v29
    v_add_f32 v216, v216, v212
    s_waitcnt lgkmcnt(3)
    v_mfma_f32_32x32x16_bf16 v[48:63], a[140:143], v[156:159], v[48:63]
    ds_read_b128 a[132:135], v227 offset:40960
    v_exp_f32 v214, v30
    v_add_f32 v216, v216, v213
    v_cvt_pk_bf16_f32 v118, v212, v213
    v_mfma_f32_32x32x16_bf16 v[64:79], a[140:143], v[188:191], v[64:79]
    ds_read_b64_tr_b16 a[148:149], v232 offset:28672
    v_exp_f32 v215, v31
    v_add_f32 v216, v216, v214
    v_mfma_f32_32x32x16_bf16 a[32:47], a[156:159], v[132:135], a[32:47]
    ds_read_b64_tr_b16 a[150:151], v232 offset:30720
    v_exp_f32 v208, v32
    v_add_f32 v216, v216, v215
    v_cvt_pk_bf16_f32 v119, v214, v215
    v_mfma_f32_32x32x16_bf16 a[48:63], a[156:159], v[140:143], a[48:63]
    buffer_load_dwordx4 v235, s[16:19], s43 offen offset:1024  lds
    v_exp_f32 v209, v33
    s_waitcnt lgkmcnt(3)
    v_mfma_f32_32x32x16_bf16 v[48:63], a[128:131], v[160:163], v[48:63]
    ds_read_b128 a[136:139], v228 offset:40960
    v_exp_f32 v210, v34
    v_add_f32 v217, v208, v209
    v_cvt_pk_bf16_f32 v120, v208, v209
    v_mfma_f32_32x32x16_bf16 v[64:79], a[128:131], v[192:195], v[64:79]
    ds_read_b64_tr_b16 a[152:153], v233 offset:24576
    v_exp_f32 v211, v35
    v_add_f32 v217, v217, v210
    v_mfma_f32_32x32x16_bf16 a[64:79], a[144:147], v[128:131], a[64:79]
    ds_read_b64_tr_b16 a[154:155], v233 offset:26624
    v_exp_f32 v212, v36
    v_add_f32 v217, v217, v211
    v_cvt_pk_bf16_f32 v121, v210, v211
    v_mfma_f32_32x32x16_bf16 a[80:95], a[144:147], v[136:139], a[80:95]
    buffer_load_dwordx4 v236, s[16:19], s43 offen offset:2048  lds
    v_exp_f32 v213, v37
    v_add_f32 v217, v217, v212
    s_waitcnt lgkmcnt(3)
    v_mfma_f32_32x32x16_bf16 v[48:63], a[132:135], v[164:167], v[48:63]
    ds_read_b128 a[140:143], v229 offset:40960
    v_exp_f32 v214, v38
    v_add_f32 v217, v217, v213
    v_cvt_pk_bf16_f32 v122, v212, v213
    v_mfma_f32_32x32x16_bf16 v[64:79], a[132:135], v[196:199], v[64:79]
    ds_read_b64_tr_b16 a[156:157], v233 offset:28672
    v_exp_f32 v215, v39
    v_add_f32 v217, v217, v214
    v_mfma_f32_32x32x16_bf16 a[64:79], a[148:151], v[132:135], a[64:79]
    ds_read_b64_tr_b16 a[158:159], v233 offset:30720
    v_exp_f32 v208, v40
    v_add_f32 v217, v217, v215
    v_cvt_pk_bf16_f32 v123, v214, v215
    v_mfma_f32_32x32x16_bf16 a[80:95], a[148:151], v[140:143], a[80:95]
    buffer_load_dwordx4 v237, s[16:19], s43 offen offset:3072  lds
    v_exp_f32 v209, v41
    v_add_f32 v217, v217, v208
    s_waitcnt lgkmcnt(3)
    v_mfma_f32_32x32x16_bf16 v[48:63], a[136:139], v[168:171], v[48:63]
    ds_read_b128 a[128:131], v222 offset:49152
    v_exp_f32 v210, v42
    v_add_f32 v217, v217, v209
    v_cvt_pk_bf16_f32 v124, v208, v209
    v_mfma_f32_32x32x16_bf16 v[64:79], a[136:139], v[200:203], v[64:79]
    ds_read_b64_tr_b16 a[144:145], v230 offset:32768
    v_exp_f32 v211, v43
    v_add_f32 v217, v217, v210
    v_mfma_f32_32x32x16_bf16 a[96:111], a[152:155], v[128:131], a[96:111]
    ds_read_b64_tr_b16 a[146:147], v230 offset:34816
    v_exp_f32 v212, v44
    v_add_f32 v217, v217, v211
    v_cvt_pk_bf16_f32 v125, v210, v211
    v_mfma_f32_32x32x16_bf16 a[112:127], a[152:155], v[136:139], a[112:127]
    s_add_u32 s43, s43, 16384
    v_exp_f32 v213, v45
    v_add_f32 v217, v217, v212
    s_waitcnt lgkmcnt(3)
    v_mfma_f32_32x32x16_bf16 v[48:63], a[140:143], v[172:175], v[48:63]
    ds_read_b128 a[132:135], v223 offset:49152
    v_exp_f32 v214, v46
    v_add_f32 v217, v217, v213
    v_cvt_pk_bf16_f32 v126, v212, v213
    v_mfma_f32_32x32x16_bf16 v[64:79], a[140:143], v[204:207], v[64:79]
    ds_read_b64_tr_b16 a[148:149], v230 offset:36864
    v_exp_f32 v215, v47
    v_add_f32 v217, v217, v214
    v_mfma_f32_32x32x16_bf16 a[96:111], a[156:159], v[132:135], a[96:111]
    ds_read_b64_tr_b16 a[150:151], v230 offset:38912
    v_add_f32 v217, v217, v215
    v_cvt_pk_bf16_f32 v127, v214, v215
    v_max_f32 v1, v216, v217
    v_cmp_lt_f32 vcc, s49, v1
    v_exp_f32 v208, v48
    v_mfma_f32_32x32x16_bf16 a[112:127], a[156:159], v[140:143], a[112:127]
    v_exp_f32 v209, v49
    s_cbranch_vccnz L_rare_m4
L_back_m4:
    s_waitcnt lgkmcnt(3)
    v_mfma_f32_32x32x16_bf16 v[16:31], a[128:131], v[144:147], v[80:95]
    ds_read_b128 a[136:139], v224 offset:49152
    v_exp_f32 v210, v50
    v_add_f32 v218, v208, v209
    v_cvt_pk_bf16_f32 v128, v208, v209
    v_mfma_f32_32x32x16_bf16 v[32:47], a[128:131], v[176:179], v[96:111]
    ds_read_b64_tr_b16 a[152:153], v231 offset:32768
    v_exp_f32 v211, v51
    v_add_f32 v218, v218, v210
    v_mfma_f32_32x32x16_bf16 a[0:15], a[144:147], v[112:115], a[0:15]
    ds_read_b64_tr_b16 a[154:155], v231 offset:34816
    v_exp_f32 v212, v52
    v_add_f32 v218, v218, v211
    v_cvt_pk_bf16_f32 v129, v210, v211
    v_mfma_f32_32x32x16_bf16 a[16:31], a[144:147], v[120:123], a[16:31]
    v_exp_f32 v213, v53
    v_add_f32 v218, v218, v212
    v_add_f32 v220, v220, v216
    s_waitcnt lgkmcnt(3)
    v_mfma_f32_32x32x16_bf16 v[16:31], a[132:135], v[148:151], v[16:31]
    ds_read_b128 a[140:143], v225 offset:49152
    v_exp_f32 v214, v54
    v_add_f32 v218, v218, v213
    v_cvt_pk_bf16_f32 v130, v212, v213
    v_mfma_f32_32x32x16_bf16 v[32:47], a[132:135], v[180:183], v[32:47]
    ds_read_b64_tr_b16 a[156:157], v231 offset:36864
    v_exp_f32 v215, v55
    v_add_f32 v218, v218, v214
    v_mfma_f32_32x32x16_bf16 a[0:15], a[148:151], v[116:119], a[0:15]
    ds_read_b64_tr_b16 a[158:159], v231 offset:38912
    v_exp_f32 v208, v56
    v_add_f32 v218, v218, v215
    v_cvt_pk_bf16_f32 v131, v214, v215
    v_mfma_f32_32x32x16_bf16 a[16:31], a[148:151], v[124:127], a[16:31]
    v_exp_f32 v209, v57
    v_add_f32 v218, v218, v208
    v_add_f32 v221, v221, v217
    s_waitcnt lgkmcnt(3)
    v_mfma_f32_32x32x16_bf16 v[16:31], a[136:139], v[152:155], v[16:31]
    ds_read_b128 a[128:131], v226 offset:49152
    s_add_u32 m0, s46, 0
    v_exp_f32 v210, v58
    v_add_f32 v218, v218, v209
    v_cvt_pk_bf16_f32 v132, v208, v209
    v_mfma_f32_32x32x16_bf16 v[32:47], a[136:139], v[184:187], v[32:47]
    ds_read_b64_tr_b16 a[144:145], v232 offset:32768
    v_exp_f32 v211, v59
    v_add_f32 v218, v218, v210
    v_mfma_f32_32x32x16_bf16 a[32:47], a[152:155], v[112:115], a[32:47]
    ds_read_b64_tr_b16 a[146:147], v232 offset:34816
    v_exp_f32 v212, v60
    v_add_f32 v218, v218, v211
    v_cvt_pk_bf16_f32 v133, v210, v211
    v_mfma_f32_32x32x16_bf16 a[48:63], a[152:155], v[120:123], a[48:63]
    buffer_load_dwordx4 v238, s[20:23], s44 offen offset:0  lds
    v_exp_f32 v213, v61
    v_add_f32 v218, v218, v212
    s_waitcnt lgkmcnt(3)
    v_mfma_f32_32x32x16_bf16 v[16:31], a[140:143], v[156:159], v[16:31]
    ds_read_b128 a[132:135], v227 offset:49152
    v_exp_f32 v214, v62
    v_add_f32 v218, v218, v213
    v_cvt_pk_bf16_f32 v134, v212, v213
    v_mfma_f32_32x32x16_bf16 v[32:47], a[140:143], v[188:191], v[32:47]
    ds_read_b64_tr_b16 a[148:149], v232 offset:36864
    v_exp_f32 v215, v63
    v_add_f32 v218, v218, v214
    v_mfma_f32_32x32x16_bf16 a[32:47], a[156:159], v[116:119], a[32:47]
    ds_read_b64_tr_b16 a[150:151], v232 offset:38912
    v_exp_f32 v208, v64
    v_add_f32 v218, v218, v215
    v_cvt_pk_bf16_f32 v135, v214, v215
    v_mfma_f32_32x32x16_bf16 a[48:63], a[156:159], v[124:127], a[48:63]
    buffer_load_dwordx4 v238, s[20:23], s44 offen offset:1024  lds
    v_exp_f32 v209, v65
    s_waitcnt lgkmcnt(3)
    v_mfma_f32_32x32x16_bf16 v[16:31], a[128:131], v[160:163], v[16:31]
    ds_read_b128 a[136:139], v228 offset:49152
    v_exp_f32 v210, v66
    v_add_f32 v219, v208, v209
    v_cvt_pk_bf16_f32 v136, v208, v209
    v_mfma_f32_32x32x16_bf16 v[32:47], a[128:131], v[192:195], v[32:47]
    ds_read_b64_tr_b16 a[152:153], v233 offset:32768
    v_exp_f32 v211, v67
    v_add_f32 v219, v219, v210
    v_mfma_f32_32x32x16_bf16 a[64:79], a[144:147], v[112:115], a[64:79]
    ds_read_b64_tr_b16 a[154:155], v233 offset:34816
    v_exp_f32 v212, v68
    v_add_f32 v219, v219, v211
    v_cvt_pk_bf16_f32 v137, v210, v211
    v_mfma_f32_32x32x16_bf16 a[80:95], a[144:147], v[120:123], a[80:95]
    buffer_load_dwordx4 v238, s[20:23], s44 offen offset:2048  lds
    v_exp_f32 v213, v69
    v_add_f32 v219, v219, v212
    s_waitcnt lgkmcnt(3)
    v_mfma_f32_32x32x16_bf16 v[16:31], a[132:135], v[164:167], v[16:31]
    ds_read_b128 a[140:143], v229 offset:49152
    v_exp_f32 v214, v70
    v_add_f32 v219, v219, v213
    v_cvt_pk_bf16_f32 v138, v212, v213
    v_mfma_f32_32x32x16_bf16 v[32:47], a[132:135], v[196:199], v[32:47]
    ds_read_b64_tr_b16 a[156:157], v233 offset:36864
    v_exp_f32 v215, v71
    v_add_f32 v219, v219, v214
    v_mfma_f32_32x32x16_bf16 a[64:79], a[148:151], v[116:119], a[64:79]
    ds_read_b64_tr_b16 a[158:159], v233 offset:38912
    v_exp_f32 v208, v72
    v_add_f32 v219, v219, v215
    v_cvt_pk_bf16_f32 v139, v214, v215
    v_mfma_f32_32x32x16_bf16 a[80:95], a[148:151], v[124:127], a[80:95]
    buffer_load_dwordx4 v238, s[20:23], s44 offen offset:3072  lds
    v_exp_f32 v209, v73
    v_add_f32 v219, v219, v208
    s_waitcnt lgkmcnt(3)
    v_mfma_f32_32x32x16_bf16 v[16:31], a[136:139], v[168:171], v[16:31]
    ds_read_b128 a[128:131], v222 offset:57344
    v_exp_f32 v210, v74
    v_add_f32 v219, v219, v209
    v_cvt_pk_bf16_f32 v140, v208, v209
    v_mfma_f32_32x32x16_bf16 v[32:47], a[136:139], v[200:203], v[32:47]
    ds_read_b64_tr_b16 a[144:145], v230 offset:40960
    v_exp_f32 v211, v75
    v_add_f32 v219, v219, v210
    v_mfma_f32_32x32x16_bf16 a[96:111], a[152:155], v[112:115], a[96:111]
    ds_read_b64_tr_b16 a[146:147], v230 offset:43008
    v_exp_f32 v212, v76
    v_add_f32 v219, v219, v211
    v_cvt_pk_bf16_f32 v141, v210, v211
    v_mfma_f32_32x32x16_bf16 a[112:127], a[152:155], v[120:123], a[112:127]
    s_add_u32 s44, s44, 16384
    v_exp_f32 v213, v77
    v_add_f32 v219, v219, v212
    s_waitcnt lgkmcnt(3)
    v_mfma_f32_32x32x16_bf16 v[16:31], a[140:143], v[172:175], v[16:31]
    ds_read_b128 a[132:135], v223 offset:57344
    v_exp_f32 v214, v78
    v_add_f32 v219, v219, v213
    v_cvt_pk_bf16_f32 v142, v212, v213
    v_mfma_f32_32x32x16_bf16 v[32:47], a[140:143], v[204:207], v[32:47]
    ds_read_b64_tr_b16 a[148:149], v230 offset:45056
    v_exp_f32 v215, v79
    v_add_f32 v219, v219, v214
    v_mfma_f32_32x32x16_bf16 a[96:111], a[156:159], v[116:119], a[96:111]
    ds_read_b64_tr_b16 a[150:151], v230 offset:47104
    v_add_f32 v219, v219, v215
    v_cvt_pk_bf16_f32 v143, v214, v215
    v_max_f32 v1, v218, v219
    v_cmp_lt_f32 vcc, s49, v1
    v_exp_f32 v208, v16
    v_mfma_f32_32x32x16_bf16 a[112:127], a[156:159], v[124:127], a[112:127]
    v_exp_f32 v209, v17
    s_cbranch_vccnz L_rare_m5
L_back_m5:
    s_waitcnt lgkmcnt(3)
    v_mfma_f32_32x32x16_bf16 v[48:63], a[128:131], v[144:147], v[80:95]
    ds_read_b128 a[136:139], v224 offset:57344
    v_exp_f32 v210, v18
    v_add_f32 v216, v208, v209
    v_cvt_pk_bf16_f32 v112, v208, v209
    v_mfma_f32_32x32x16_bf16 v[64:79], a[128:131], v[176:179], v[96:111]
    ds_read_b64_tr_b16 a[152:153], v231 offset:40960
    v_exp_f32 v211, v19
    v_add_f32 v216, v216, v210
    s_waitcnt vmcnt(8)
    s_barrier
    v_mfma_f32_32x32x16_bf16 a[0:15], a[144:147], v[128:131], a[0:15]
    ds_read_b64_tr_b16 a[154:155], v231 offset:43008
    v_exp_f32 v212, v20
    v_add_f32 v216, v216, v211
    v_cvt_pk_bf16_f32 v113, v210, v211
    v_mfma_f32_32x32x16_bf16 a[16:31], a[144:147], v[136:139], a[16:31]
    v_exp_f32 v213, v21
    v_add_f32 v216, v216, v212
    v_add_f32 v220, v220, v218
    s_waitcnt lgkmcnt(3)
    v_mfma_f32_32x32x16_bf16 v[48:63], a[132:135], v[148:151], v[48:63]
    ds_read_b128 a[140:143], v225 offset:57344
    v_exp_f32 v214, v22
    v_add_f32 v216, v216, v213
    v_cvt_pk_bf16_f32 v114, v212, v213
    v_mfma_f32_32x32x16_bf16 v[64:79], a[132:135], v[180:183], v[64:79]
    ds_read_b64_tr_b16 a[156:157], v231 offset:45056
    v_exp_f32 v215, v23
    v_add_f32 v216, v216, v214
    v_mfma_f32_32x32x16_bf16 a[0:15], a[148:151], v[132:135], a[0:15]
    ds_read_b64_tr_b16 a[158:159], v231 offset:47104
    v_exp_f32 v208, v24
    v_add_f32 v216, v216, v215
    v_cvt_pk_bf16_f32 v115, v214, v215
    v_mfma_f32_32x32x16_bf16 a[16:31], a[148:151], v[140:143], a[16:31]
    v_exp_f32 v209, v25
    v_add_f32 v216, v216, v208
    v_add_f32 v221, v221, v219
    s_waitcnt lgkmcnt(3)
    v_mfma_f32_32x32x16_bf16 v[48:63], a[136:139], v[152:155], v[48:63]
    ds_read_b128 a[128:131], v226 offset:57344
    s_add_u32 m0, s45, 32768
    v_exp_f32 v210, v26
    v_add_f32 v216, v216, v209
    v_cvt_pk_bf16_f32 v116, v208, v209
    v_mfma_f32_32x32x16_bf16 v[64:79], a[136:139], v[184:187], v[64:79]
    ds_read_b64_tr_b16 a[144:145], v232 offset:40960
    v_exp_f32 v211, v27
    v_add_f32 v216, v216, v210
    v_mfma_f32_32x32x16_bf16 a[32:47], a[152:155], v[128:131], a[32:47]
    ds_read_b64_tr_b16 a[146:147], v232 offset:43008
    v_exp_f32 v212, v28
    v_add_f32 v216, v216, v211
    v_cvt_pk_bf16_f32 v117, v210, v211
    v_mfma_f32_32x32x16_bf16 a[48:63], a[152:155], v[136:139], a[48:63]
    buffer_load_dwordx4 v234, s[16:19], s43 offen offset:0  lds
    v_exp_f32 v213, v29
    v_add_f32 v216, v216, v212
    s_waitcnt lgkmcnt(3)
    v_mfma_f32_32x32x16_bf16 v[48:63], a[140:143], v[156:159], v[48:63]
    ds_read_b128 a[132:135], v227 offset:57344
    v_exp_f32 v214, v30
    v_add_f32 v216, v216, v213
    v_cvt_pk_bf16_f32 v118, v212, v213
    v_mfma_f32_32x32x16_bf16 v[64:79], a[140:143], v[188:191], v[64:79]
    ds_read_b64_tr_b16 a[148:149], v232 offset:45056
    v_exp_f32 v215, v31
    v_add_f32 v216, v216, v214
    v_mfma_f32_32x32x16_bf16 a[32:47], a[156:159], v[132:135], a[32:47]
    ds_read_b64_tr_b16 a[150:151], v232 offset:47104
    v_exp_f32 v208, v32
    v_add_f32 v216, v216, v215
    v_cvt_pk_bf16_f32 v119, v214, v215
    v_mfma_f32_32x32x16_bf16 a[48:63], a[156:159], v[140:143], a[48:63]
    buffer_load_dwordx4 v235, s[16:19], s43 offen offset:1024  lds
    v_exp_f32 v209, v33
    s_waitcnt lgkmcnt(3)
    v_mfma_f32_32x32x16_bf16 v[48:63], a[128:131], v[160:163], v[48:63]
    ds_read_b128 a[136:139], v228 offset:57344
    v_exp_f32 v210, v34
    v_add_f32 v217, v208, v209
    v_cvt_pk_bf16_f32 v120, v208, v209
    v_mfma_f32_32x32x16_bf16 v[64:79], a[128:131], v[192:195], v[64:79]
    ds_read_b64_tr_b16 a[152:153], v233 offset:40960
    v_exp_f32 v211, v35
    v_add_f32 v217, v217, v210
    v_mfma_f32_32x32x16_bf16 a[64:79], a[144:147], v[128:131], a[64:79]
    ds_read_b64_tr_b16 a[154:155], v233 offset:43008
    v_exp_f32 v212, v36
    v_add_f32 v217, v217, v211
    v_cvt_pk_bf16_f32 v121, v210, v211
    v_mfma_f32_32x32x16_bf16 a[80:95], a[144:147], v[136:139], a[80:95]
    buffer_load_dwordx4 v236, s[16:19], s43 offen offset:2048  lds
    v_exp_f32 v213, v37
    v_add_f32 v217, v217, v212
    s_waitcnt lgkmcnt(3)
    v_mfma_f32_32x32x16_bf16 v[48:63], a[132:135], v[164:167], v[48:63]
    ds_read_b128 a[140:143], v229 offset:57344
    v_exp_f32 v214, v38
    v_add_f32 v217, v217, v213
    v_cvt_pk_bf16_f32 v122, v212, v213
    v_mfma_f32_32x32x16_bf16 v[64:79], a[132:135], v[196:199], v[64:79]
    ds_read_b64_tr_b16 a[156:157], v233 offset:45056
    v_exp_f32 v215, v39
    v_add_f32 v217, v217, v214
    v_mfma_f32_32x32x16_bf16 a[64:79], a[148:151], v[132:135], a[64:79]
    ds_read_b64_tr_b16 a[158:159], v233 offset:47104
    v_exp_f32 v208, v40
    v_add_f32 v217, v217, v215
    v_cvt_pk_bf16_f32 v123, v214, v215
    v_mfma_f32_32x32x16_bf16 a[80:95], a[148:151], v[140:143], a[80:95]
    buffer_load_dwordx4 v237, s[16:19], s43 offen offset:3072  lds
    v_exp_f32 v209, v41
    v_add_f32 v217, v217, v208
    s_waitcnt lgkmcnt(3)
    v_mfma_f32_32x32x16_bf16 v[48:63], a[136:139], v[168:171], v[48:63]
    ds_read_b128 a[128:131], v222 offset:0
    v_exp_f32 v210, v42
    v_add_f32 v217, v217, v209
    v_cvt_pk_bf16_f32 v124, v208, v209
    v_mfma_f32_32x32x16_bf16 v[64:79], a[136:139], v[200:203], v[64:79]
    ds_read_b64_tr_b16 a[144:145], v230 offset:49152
    v_exp_f32 v211, v43
    v_add_f32 v217, v217, v210
    v_mfma_f32_32x32x16_bf16 a[96:111], a[152:155], v[128:131], a[96:111]
    ds_read_b64_tr_b16 a[146:147], v230 offset:51200
    v_exp_f32 v212, v44
    v_add_f32 v217, v217, v211
    v_cvt_pk_bf16_f32 v125, v210, v211
    v_mfma_f32_32x32x16_bf16 a[112:127], a[152:155], v[136:139], a[112:127]
    s_add_u32 s43, s43, 16384
    v_exp_f32 v213, v45
    v_add_f32 v217, v217, v212
    s_waitcnt lgkmcnt(3)
    v_mfma_f32_32x32x16_bf16 v[48:63], a[140:143], v[172:175], v[48:63]
    ds_read_b128 a[132:135], v223 offset:0
    v_exp_f32 v214, v46
    v_add_f32 v217, v217, v213
    v_cvt_pk_bf16_f32 v126, v212, v213
    v_mfma_f32_32x32x16_bf16 v[64:79], a[140:143], v[204:207], v[64:79]
    ds_read_b64_tr_b16 a[148:149], v230 offset:53248
    v_exp_f32 v215, v47
    v_add_f32 v217, v217, v214
    v_mfma_f32_32x32x16_bf16 a[96:111], a[156:159], v[132:135], a[96:111]
    ds_read_b64_tr_b16 a[150:151], v230 offset:55296
    v_add_f32 v217, v217, v215
    v_cvt_pk_bf16_f32 v127, v214, v215
    v_max_f32 v1, v216, v217
    v_cmp_lt_f32 vcc, s49, v1
    v_exp_f32 v208, v48
    v_mfma_f32_32x32x16_bf16 a[112:127], a[156:159], v[140:143], a[112:127]
    v_exp_f32 v209, v49
    s_cbranch_vccnz L_rare_m6
L_back_m6:
    s_waitcnt lgkmcnt(3)
    v_mfma_f32_32x32x16_bf16 v[16:31], a[128:131], v[144:147], v[80:95]
    ds_read_b128 a[136:139], v224 offset:0
    v_exp_f32 v210, v50
    v_add_f32 v218, v208, v209
    v_cvt_pk_bf16_f32 v128, v208, v209
    v_mfma_f32_32x32x16_bf16 v[32:47], a[128:131], v[176:179], v[96:111]
    ds_read_b64_tr_b16 a[152:153], v231 offset:49152
    v_exp_f32 v211, v51
    v_add_f32 v218, v218, v210
    v_mfma_f32_32x32x16_bf16 a[0:15], a[144:147], v[112:115], a[0:15]
    ds_read_b64_tr_b16 a[154:155], v231 offset:51200
    v_exp_f32 v212, v52
    v_add_f32 v218, v218, v211
    v_cvt_pk_bf16_f32 v129, v210, v211
    v_mfma_f32_32x32x16_bf16 a[16:31], a[144:147], v[120:123], a[16:31]
    v_exp_f32 v213, v53
    v_add_f32 v218, v218, v212
    v_add_f32 v220, v220, v216
    s_waitcnt lgkmcnt(3)
    v_mfma_f32_32x32x16_bf16 v[16:31], a[132:135], v[148:151], v[16:31]
    ds_read_b128 a[140:143], v225 offset:0
    v_exp_f32 v214, v54
    v_add_f32 v218, v218, v213
    v_cvt_pk_bf16_f32 v130, v212, v213
    v_mfma_f32_32x32x16_bf16 v[32:47], a[132:135], v[180:183], v[32:47]
    ds_read_b64_tr_b16 a[156:157], v231 offset:53248
    v_exp_f32 v215, v55
    v_add_f32 v218, v218, v214
    v_mfma_f32_32x32x16_bf16 a[0:15], a[148:151], v[116:119], a[0:15]
    ds_read_b64_tr_b16 a[158:159], v231 offset:55296
    v_exp_f32 v208, v56
    v_add_f32 v218, v218, v215
    v_cvt_pk_bf16_f32 v131, v214, v215
    v_mfma_f32_32x32x16_bf16 a[16:31], a[148:151], v[124:127], a[16:31]
    v_exp_f32 v209, v57
    v_add_f32 v218, v218, v208
    v_add_f32 v221, v221, v217
    s_waitcnt lgkmcnt(3)
    v_mfma_f32_32x32x16_bf16 v[16:31], a[136:139], v[152:155], v[16:31]
    ds_read_b128 a[128:131], v226 offset:0
    s_add_u32 m0, s46, 16384
    v_exp_f32 v210, v58
    v_add_f32 v218, v218, v209
    v_cvt_pk_bf16_f32 v132, v208, v209
    v_mfma_f32_32x32x16_bf16 v[32:47], a[136:139], v[184:187], v[32:47]
    ds_read_b64_tr_b16 a[144:145], v232 offset:49152
    v_exp_f32 v211, v59
    v_add_f32 v218, v218, v210
    v_mfma_f32_32x32x16_bf16 a[32:47], a[152:155], v[112:115], a[32:47]
    ds_read_b64_tr_b16 a[146:147], v232 offset:51200
    v_exp_f32 v212, v60
    v_add_f32 v218, v218, v211
    v_cvt_pk_bf16_f32 v133, v210, v211
    v_mfma_f32_32x32x16_bf16 a[48:63], a[152:155], v[120:123], a[48:63]
    buffer_load_dwordx4 v238, s[20:23], s44 offen offset:0  lds
    v_exp_f32 v213, v61
    v_add_f32 v218, v218, v212
    s_waitcnt lgkmcnt(3)
    v_mfma_f32_32x32x16_bf16 v[16:31], a[140:143], v[156:159], v[16:31]
    ds_read_b128 a[132:135], v227 offset:0
    v_exp_f32 v214, v62
    v_add_f32 v218, v218, v213
    v_cvt_pk_bf16_f32 v134, v212, v213
    v_mfma_f32_32x32x16_bf16 v[32:47], a[140:143], v[188:191], v[32:47]
    ds_read_b64_tr_b16 a[148:149], v232 offset:53248
    v_exp_f32 v215, v63
    v_add_f32 v218, v218, v214
    v_mfma_f32_32x32x16_bf16 a[32:47], a[156:159], v[116:119], a[32:47]
    ds_read_b64_tr_b16 a[150:151], v232 offset:55296
    v_exp_f32 v208, v64
    v_add_f32 v218, v218, v215
    v_cvt_pk_bf16_f32 v135, v214, v215
    v_mfma_f32_32x32x16_bf16 a[48:63], a[156:159], v[124:127], a[48:63]
    buffer_load_dwordx4 v238, s[20:23], s44 offen offset:1024  lds
    v_exp_f32 v209, v65
    s_waitcnt lgkmcnt(3)
    v_mfma_f32_32x32x16_bf16 v[16:31], a[128:131], v[160:163], v[16:31]
    ds_read_b128 a[136:139], v228 offset:0
    v_exp_f32 v210, v66
    v_add_f32 v219, v208, v209
    v_cvt_pk_bf16_f32 v136, v208, v209
    v_mfma_f32_32x32x16_bf16 v[32:47], a[128:131], v[192:195], v[32:47]
    ds_read_b64_tr_b16 a[152:153], v233 offset:49152
    v_exp_f32 v211, v67
    v_add_f32 v219, v219, v210
    v_mfma_f32_32x32x16_bf16 a[64:79], a[144:147], v[112:115], a[64:79]
    ds_read_b64_tr_b16 a[154:155], v233 offset:51200
    v_exp_f32 v212, v68
    v_add_f32 v219, v219, v211
    v_cvt_pk_bf16_f32 v137, v210, v211
    v_mfma_f32_32x32x16_bf16 a[80:95], a[144:147], v[120:123], a[80:95]
    buffer_load_dwordx4 v238, s[20:23], s44 offen offset:2048  lds
    v_exp_f32 v213, v69
    v_add_f32 v219, v219, v212
    s_waitcnt lgkmcnt(3)
    v_mfma_f32_32x32x16_bf16 v[16:31], a[132:135], v[164:167], v[16:31]
    ds_read_b128 a[140:143], v229 offset:0
    v_exp_f32 v214, v70
    v_add_f32 v219, v219, v213
    v_cvt_pk_bf16_f32 v138, v212, v213
    v_mfma_f32_32x32x16_bf16 v[32:47], a[132:135], v[196:199], v[32:47]
    ds_read_b64_tr_b16 a[156:157], v233 offset:53248
    v_exp_f32 v215, v71
    v_add_f32 v219, v219, v214
    v_mfma_f32_32x32x16_bf16 a[64:79], a[148:151], v[116:119], a[64:79]
    ds_read_b64_tr_b16 a[158:159], v233 offset:55296
    v_exp_f32 v208, v72
    v_add_f32 v219, v219, v215
    v_cvt_pk_bf16_f32 v139, v214, v215
    v_mfma_f32_32x32x16_bf16 a[80:95], a[148:151], v[124:127], a[80:95]
    buffer_load_dwordx4 v238, s[20:23], s44 offen offset:3072  lds
    v_exp_f32 v209, v73
    v_add_f32 v219, v219, v208
    s_waitcnt lgkmcnt(3)
    v_mfma_f32_32x32x16_bf16 v[16:31], a[136:139], v[168:171], v[16:31]
    ds_read_b128 a[128:131], v222 offset:8192
    v_exp_f32 v210, v74
    v_add_f32 v219, v219, v209
    v_cvt_pk_bf16_f32 v140, v208, v209
    v_mfma_f32_32x32x16_bf16 v[32:47], a[136:139], v[200:203], v[32:47]
    ds_read_b64_tr_b16 a[144:145], v230 offset:57344
    v_exp_f32 v211, v75
    v_add_f32 v219, v219, v210
    v_mfma_f32_32x32x16_bf16 a[96:111], a[152:155], v[112:115], a[96:111]
    ds_read_b64_tr_b16 a[146:147], v230 offset:59392
    v_exp_f32 v212, v76
    v_add_f32 v219, v219, v211
    v_cvt_pk_bf16_f32 v141, v210, v211
    v_mfma_f32_32x32x16_bf16 a[112:127], a[152:155], v[120:123], a[112:127]
    s_add_u32 s44, s44, 16384
    v_exp_f32 v213, v77
    v_add_f32 v219, v219, v212
    s_waitcnt lgkmcnt(3)
    v_mfma_f32_32x32x16_bf16 v[16:31], a[140:143], v[172:175], v[16:31]
    ds_read_b128 a[132:135], v223 offset:8192
    v_exp_f32 v214, v78
    v_add_f32 v219, v219, v213
    v_cvt_pk_bf16_f32 v142, v212, v213
    v_mfma_f32_32x32x16_bf16 v[32:47], a[140:143], v[204:207], v[32:47]
    ds_read_b64_tr_b16 a[148:149], v230 offset:61440
    v_exp_f32 v215, v79
    v_add_f32 v219, v219, v214
    v_mfma_f32_32x32x16_bf16 a[96:111], a[156:159], v[116:119], a[96:111]
    ds_read_b64_tr_b16 a[150:151], v230 offset:63488
    v_add_f32 v219, v219, v215
    v_cvt_pk_bf16_f32 v143, v214, v215
    v_max_f32 v1, v218, v219
    v_cmp_lt_f32 vcc, s49, v1
    v_exp_f32 v208, v16
    v_mfma_f32_32x32x16_bf16 a[112:127], a[156:159], v[124:127], a[112:127]
    v_exp_f32 v209, v17
    s_cbranch_vccnz L_rare_m7
L_back_m7:
    s_waitcnt lgkmcnt(3)
    v_mfma_f32_32x32x16_bf16 v[48:63], a[128:131], v[144:147], v[80:95]
    ds_read_b128 a[136:139], v224 offset:8192
    v_exp_f32 v210, v18
    v_add_f32 v216, v208, v209
    v_cvt_pk_bf16_f32 v112, v208, v209
    v_mfma_f32_32x32x16_bf16 v[64:79], a[128:131], v[176:179], v[96:111]
    ds_read_b64_tr_b16 a[152:153], v231 offset:57344
    v_exp_f32 v211, v19
    v_add_f32 v216, v216, v210
    s_waitcnt vmcnt(8)
    s_barrier
    v_mfma_f32_32x32x16_bf16 a[0:15], a[144:147], v[128:131], a[0:15]
    ds_read_b64_tr_b16 a[154:155], v231 offset:59392
    v_exp_f32 v212, v20
    v_add_f32 v216, v216, v211
    v_cvt_pk_bf16_f32 v113, v210, v211
    v_mfma_f32_32x32x16_bf16 a[16:31], a[144:147], v[136:139], a[16:31]
    v_exp_f32 v213, v21
    v_add_f32 v216, v216, v212
    v_add_f32 v220, v220, v218
    s_waitcnt lgkmcnt(3)
    v_mfma_f32_32x32x16_bf16 v[48:63], a[132:135], v[148:151], v[48:63]
    ds_read_b128 a[140:143], v225 offset:8192
    v_exp_f32 v214, v22
    v_add_f32 v216, v216, v213
    v_cvt_pk_bf16_f32 v114, v212, v213
    v_mfma_f32_32x32x16_bf16 v[64:79], a[132:135], v[180:183], v[64:79]
    ds_read_b64_tr_b16 a[156:157], v231 offset:61440
    v_exp_f32 v215, v23
    v_add_f32 v216, v216, v214
    v_mfma_f32_32x32x16_bf16 a[0:15], a[148:151], v[132:135], a[0:15]
    ds_read_b64_tr_b16 a[158:159], v231 offset:63488
    v_exp_f32 v208, v24
    v_add_f32 v216, v216, v215
    v_cvt_pk_bf16_f32 v115, v214, v215
    v_mfma_f32_32x32x16_bf16 a[16:31], a[148:151], v[140:143], a[16:31]
    v_exp_f32 v209, v25
    v_add_f32 v216, v216, v208
    v_add_f32 v221, v221, v219
    s_waitcnt lgkmcnt(3)
    v_mfma_f32_32x32x16_bf16 v[48:63], a[136:139], v[152:155], v[48:63]
    ds_read_b128 a[128:131], v226 offset:8192
    s_add_u32 m0, s45, 49152
    v_exp_f32 v210, v26
    v_add_f32 v216, v216, v209
    v_cvt_pk_bf16_f32 v116, v208, v209
    v_mfma_f32_32x32x16_bf16 v[64:79], a[136:139], v[184:187], v[64:79]
    ds_read_b64_tr_b16 a[144:145], v232 offset:57344
    v_exp_f32 v211, v27
    v_add_f32 v216, v216, v210
    v_mfma_f32_32x32x16_bf16 a[32:47], a[152:155], v[128:131], a[32:47]
    ds_read_b64_tr_b16 a[146:147], v232 offset:59392
    v_exp_f32 v212, v28
    v_add_f32 v216, v216, v211
    v_cvt_pk_bf16_f32 v117, v210, v211
    v_mfma_f32_32x32x16_bf16 a[48:63], a[152:155], v[136:139], a[48:63]
    buffer_load_dwordx4 v234, s[16:19], s43 offen offset:0  lds
    v_exp_f32 v213, v29
    v_add_f32 v216, v216, v212
    s_waitcnt lgkmcnt(3)
    v_mfma_f32_32x32x16_bf16 v[48:63], a[140:143], v[156:159], v[48:63]
    ds_read_b128 a[132:135], v227 offset:8192
    v_exp_f32 v214, v30
    v_add_f32 v216, v216, v213
    v_cvt_pk_bf16_f32 v118, v212, v213
    v_mfma_f32_32x32x16_bf16 v[64:79], a[140:143], v[188:191], v[64:79]
    ds_read_b64_tr_b16 a[148:149], v232 offset:61440
    v_exp_f32 v215, v31
    v_add_f32 v216, v216, v214
    v_mfma_f32_32x32x16_bf16 a[32:47], a[156:159], v[132:135], a[32:47]
    ds_read_b64_tr_b16 a[150:151], v232 offset:63488
    v_exp_f32 v208, v32
    v_add_f32 v216, v216, v215
    v_cvt_pk_bf16_f32 v119, v214, v215
    v_mfma_f32_32x32x16_bf16 a[48:63], a[156:159], v[140:143], a[48:63]
    buffer_load_dwordx4 v235, s[16:19], s43 offen offset:1024  lds
    v_exp_f32 v209, v33
    s_waitcnt lgkmcnt(3)
    v_mfma_f32_32x32x16_bf16 v[48:63], a[128:131], v[160:163], v[48:63]
    ds_read_b128 a[136:139], v228 offset:8192
    v_exp_f32 v210, v34
    v_add_f32 v217, v208, v209
    v_cvt_pk_bf16_f32 v120, v208, v209
    v_mfma_f32_32x32x16_bf16 v[64:79], a[128:131], v[192:195], v[64:79]
    ds_read_b64_tr_b16 a[152:153], v233 offset:57344
    v_exp_f32 v211, v35
    v_add_f32 v217, v217, v210
    v_mfma_f32_32x32x16_bf16 a[64:79], a[144:147], v[128:131], a[64:79]
    ds_read_b64_tr_b16 a[154:155], v233 offset:59392
    v_exp_f32 v212, v36
    v_add_f32 v217, v217, v211
    v_cvt_pk_bf16_f32 v121, v210, v211
    v_mfma_f32_32x32x16_bf16 a[80:95], a[144:147], v[136:139], a[80:95]
    buffer_load_dwordx4 v236, s[16:19], s43 offen offset:2048  lds
    v_exp_f32 v213, v37
    v_add_f32 v217, v217, v212
    s_waitcnt lgkmcnt(3)
    v_mfma_f32_32x32x16_bf16 v[48:63], a[132:135], v[164:167], v[48:63]
    ds_read_b128 a[140:143], v229 offset:8192
    v_exp_f32 v214, v38
    v_add_f32 v217, v217, v213
    v_cvt_pk_bf16_f32 v122, v212, v213
    v_mfma_f32_32x32x16_bf16 v[64:79], a[132:135], v[196:199], v[64:79]
    ds_read_b64_tr_b16 a[156:157], v233 offset:61440
    v_exp_f32 v215, v39
    v_add_f32 v217, v217, v214
    v_mfma_f32_32x32x16_bf16 a[64:79], a[148:151], v[132:135], a[64:79]
    ds_read_b64_tr_b16 a[158:159], v233 offset:63488
    v_exp_f32 v208, v40
    v_add_f32 v217, v217, v215
    v_cvt_pk_bf16_f32 v123, v214, v215
    v_mfma_f32_32x32x16_bf16 a[80:95], a[148:151], v[140:143], a[80:95]
    buffer_load_dwordx4 v237, s[16:19], s43 offen offset:3072  lds
    v_exp_f32 v209, v41
    v_add_f32 v217, v217, v208
    s_waitcnt lgkmcnt(3)
    v_mfma_f32_32x32x16_bf16 v[48:63], a[136:139], v[168:171], v[48:63]
    ds_read_b128 a[128:131], v222 offset:16384
    v_exp_f32 v210, v42
    v_add_f32 v217, v217, v209
    v_cvt_pk_bf16_f32 v124, v208, v209
    v_mfma_f32_32x32x16_bf16 v[64:79], a[136:139], v[200:203], v[64:79]
    ds_read_b64_tr_b16 a[144:145], v230 offset:0
    v_exp_f32 v211, v43
    v_add_f32 v217, v217, v210
    v_mfma_f32_32x32x16_bf16 a[96:111], a[152:155], v[128:131], a[96:111]
    ds_read_b64_tr_b16 a[146:147], v230 offset:2048
    v_exp_f32 v212, v44
    v_add_f32 v217, v217, v211
    v_cvt_pk_bf16_f32 v125, v210, v211
    v_mfma_f32_32x32x16_bf16 a[112:127], a[152:155], v[136:139], a[112:127]
    s_add_u32 s43, s43, 16384
    v_exp_f32 v213, v45
    v_add_f32 v217, v217, v212
    s_waitcnt lgkmcnt(3)
    v_mfma_f32_32x32x16_bf16 v[48:63], a[140:143], v[172:175], v[48:63]
    ds_read_b128 a[132:135], v223 offset:16384
    v_exp_f32 v214, v46
    v_add_f32 v217, v217, v213
    v_cvt_pk_bf16_f32 v126, v212, v213
    v_mfma_f32_32x32x16_bf16 v[64:79], a[140:143], v[204:207], v[64:79]
    ds_read_b64_tr_b16 a[148:149], v230 offset:4096
    v_exp_f32 v215, v47
    v_add_f32 v217, v217, v214
    v_mfma_f32_32x32x16_bf16 a[96:111], a[156:159], v[132:135], a[96:111]
    ds_read_b64_tr_b16 a[150:151], v230 offset:6144
    v_add_f32 v217, v217, v215
    v_cvt_pk_bf16_f32 v127, v214, v215
    v_max_f32 v1, v216, v217
    v_cmp_lt_f32 vcc, s49, v1
    v_exp_f32 v208, v48
    v_mfma_f32_32x32x16_bf16 a[112:127], a[156:159], v[140:143], a[112:127]
    v_exp_f32 v209, v49
    s_cbranch_vccnz L_rare_m8
L_back_m8:
    s_sub_u32 s50, s50, 1
    s_cmp_lg_u32 s50, 0
    s_cbranch_scc1 L_main
    v_and_b32 v252, 7, v0
    v_lshlrev_b32 v252, 8, v252
    s_mov_b32 s14, 6307840
    buffer_load_dword v252, v252, s[60:63], s14 offen sc1
    s_waitcnt lgkmcnt(3)
    v_mfma_f32_32x32x16_bf16 v[16:31], a[128:131], v[144:147], v[80:95]
    ds_read_b128 a[136:139], v224 offset:16384
    v_exp_f32 v210, v50
    v_add_f32 v218, v208, v209
    v_cvt_pk_bf16_f32 v128, v208, v209
    v_mfma_f32_32x32x16_bf16 v[32:47], a[128:131], v[176:179], v[96:111]
    ds_read_b64_tr_b16 a[152:153], v231 offset:0
    v_exp_f32 v211, v51
    v_add_f32 v218, v218, v210
    v_mfma_f32_32x32x16_bf16 a[0:15], a[144:147], v[112:115], a[0:15]
    ds_read_b64_tr_b16 a[154:155], v231 offset:2048
    v_exp_f32 v212, v52
    v_add_f32 v218, v218, v211
    v_cvt_pk_bf16_f32 v129, v210, v211
    v_mfma_f32_32x32x16_bf16 a[16:31], a[144:147], v[120:123], a[16:31]
    v_exp_f32 v213, v53
    v_add_f32 v218, v218, v212
    v_add_f32 v220, v220, v216
    s_waitcnt lgkmcnt(3)
    v_mfma_f32_32x32x16_bf16 v[16:31], a[132:135], v[148:151], v[16:31]
    ds_read_b128 a[140:143], v225 offset:16384
    v_exp_f32 v214, v54
    v_add_f32 v218, v218, v213
    v_cvt_pk_bf16_f32 v130, v212, v213
    v_mfma_f32_32x32x16_bf16 v[32:47], a[132:135], v[180:183], v[32:47]
    ds_read_b64_tr_b16 a[156:157], v231 offset:4096
    v_exp_f32 v215, v55
    v_add_f32 v218, v218, v214
    v_mfma_f32_32x32x16_bf16 a[0:15], a[148:151], v[116:119], a[0:15]
    ds_read_b64_tr_b16 a[158:159], v231 offset:6144
    v_exp_f32 v208, v56
    v_add_f32 v218, v218, v215
    v_cvt_pk_bf16_f32 v131, v214, v215
    v_mfma_f32_32x32x16_bf16 a[16:31], a[148:151], v[124:127], a[16:31]
    v_exp_f32 v209, v57
    v_add_f32 v218, v218, v208
    v_add_f32 v221, v221, v217
    s_waitcnt lgkmcnt(3)
    v_mfma_f32_32x32x16_bf16 v[16:31], a[136:139], v[152:155], v[16:31]
    ds_read_b128 a[128:131], v226 offset:16384
    s_add_u32 m0, s46, 32768
    v_exp_f32 v210, v58
    v_add_f32 v218, v218, v209
    v_cvt_pk_bf16_f32 v132, v208, v209
    v_mfma_f32_32x32x16_bf16 v[32:47], a[136:139], v[184:187], v[32:47]
    ds_read_b64_tr_b16 a[144:145], v232 offset:0
    v_exp_f32 v211, v59
    v_add_f32 v218, v218, v210
    v_mfma_f32_32x32x16_bf16 a[32:47], a[152:155], v[112:115], a[32:47]
    ds_read_b64_tr_b16 a[146:147], v232 offset:2048
    v_exp_f32 v212, v60
    v_add_f32 v218, v218, v211
    v_cvt_pk_bf16_f32 v133, v210, v211
    v_mfma_f32_32x32x16_bf16 a[48:63], a[152:155], v[120:123], a[48:63]
    buffer_load_dwordx4 v238, s[20:23], s44 offen offset:0  lds
    v_exp_f32 v213, v61
    v_add_f32 v218, v218, v212
    s_waitcnt lgkmcnt(3)
    v_mfma_f32_32x32x16_bf16 v[16:31], a[140:143], v[156:159], v[16:31]
    ds_read_b128 a[132:135], v227 offset:16384
    v_exp_f32 v214, v62
    v_add_f32 v218, v218, v213
    v_cvt_pk_bf16_f32 v134, v212, v213
    v_mfma_f32_32x32x16_bf16 v[32:47], a[140:143], v[188:191], v[32:47]
    ds_read_b64_tr_b16 a[148:149], v232 offset:4096
    v_exp_f32 v215, v63
    v_add_f32 v218, v218, v214
    v_mfma_f32_32x32x16_bf16 a[32:47], a[156:159], v[116:119], a[32:47]
    ds_read_b64_tr_b16 a[150:151], v232 offset:6144
    v_exp_f32 v208, v64
    v_add_f32 v218, v218, v215
    v_cvt_pk_bf16_f32 v135, v214, v215
    v_mfma_f32_32x32x16_bf16 a[48:63], a[156:159], v[124:127], a[48:63]
    buffer_load_dwordx4 v238, s[20:23], s44 offen offset:1024  lds
    v_exp_f32 v209, v65
    s_waitcnt lgkmcnt(3)
    v_mfma_f32_32x32x16_bf16 v[16:31], a[128:131], v[160:163], v[16:31]
    ds_read_b128 a[136:139], v228 offset:16384
    v_exp_f32 v210, v66
    v_add_f32 v219, v208, v209
    v_cvt_pk_bf16_f32 v136, v208, v209
    v_mfma_f32_32x32x16_bf16 v[32:47], a[128:131], v[192:195], v[32:47]
    ds_read_b64_tr_b16 a[152:153], v233 offset:0
    v_exp_f32 v211, v67
    v_add_f32 v219, v219, v210
    v_mfma_f32_32x32x16_bf16 a[64:79], a[144:147], v[112:115], a[64:79]
    ds_read_b64_tr_b16 a[154:155], v233 offset:2048
    v_exp_f32 v212, v68
    v_add_f32 v219, v219, v211
    v_cvt_pk_bf16_f32 v137, v210, v211
    v_mfma_f32_32x32x16_bf16 a[80:95], a[144:147], v[120:123], a[80:95]
    buffer_load_dwordx4 v238, s[20:23], s44 offen offset:2048  lds
    v_exp_f32 v213, v69
    v_add_f32 v219, v219, v212
    s_waitcnt lgkmcnt(3)
    v_mfma_f32_32x32x16_bf16 v[16:31], a[132:135], v[164:167], v[16:31]
    ds_read_b128 a[140:143], v229 offset:16384
    v_exp_f32 v214, v70
    v_add_f32 v219, v219, v213
    v_cvt_pk_bf16_f32 v138, v212, v213
    v_mfma_f32_32x32x16_bf16 v[32:47], a[132:135], v[196:199], v[32:47]
    ds_read_b64_tr_b16 a[156:157], v233 offset:4096
    v_exp_f32 v215, v71
    v_add_f32 v219, v219, v214
    v_mfma_f32_32x32x16_bf16 a[64:79], a[148:151], v[116:119], a[64:79]
    ds_read_b64_tr_b16 a[158:159], v233 offset:6144
    v_exp_f32 v208, v72
    v_add_f32 v219, v219, v215
    v_cvt_pk_bf16_f32 v139, v214, v215
    v_mfma_f32_32x32x16_bf16 a[80:95], a[148:151], v[124:127], a[80:95]
    buffer_load_dwordx4 v238, s[20:23], s44 offen offset:3072  lds
    v_exp_f32 v209, v73
    v_add_f32 v219, v219, v208
    s_waitcnt lgkmcnt(3)
    v_mfma_f32_32x32x16_bf16 v[16:31], a[136:139], v[168:171], v[16:31]
    ds_read_b128 a[128:131], v222 offset:24576
    v_exp_f32 v210, v74
    v_add_f32 v219, v219, v209
    v_cvt_pk_bf16_f32 v140, v208, v209
    v_mfma_f32_32x32x16_bf16 v[32:47], a[136:139], v[200:203], v[32:47]
    ds_read_b64_tr_b16 a[144:145], v230 offset:8192
    v_exp_f32 v211, v75
    v_add_f32 v219, v219, v210
    v_mfma_f32_32x32x16_bf16 a[96:111], a[152:155], v[112:115], a[96:111]
    ds_read_b64_tr_b16 a[146:147], v230 offset:10240
    v_exp_f32 v212, v76
    v_add_f32 v219, v219, v211
    v_cvt_pk_bf16_f32 v141, v210, v211
    v_mfma_f32_32x32x16_bf16 a[112:127], a[152:155], v[120:123], a[112:127]
    s_add_u32 s44, s44, 16384
    v_exp_f32 v213, v77
    v_add_f32 v219, v219, v212
    s_waitcnt lgkmcnt(3)
    v_mfma_f32_32x32x16_bf16 v[16:31], a[140:143], v[172:175], v[16:31]
    ds_read_b128 a[132:135], v223 offset:24576
    v_exp_f32 v214, v78
    v_add_f32 v219, v219, v213
    v_cvt_pk_bf16_f32 v142, v212, v213
    v_mfma_f32_32x32x16_bf16 v[32:47], a[140:143], v[204:207], v[32:47]
    ds_read_b64_tr_b16 a[148:149], v230 offset:12288
    s_and_b32 s14, s32, 3
    s_mul_i32 s14, s14, 1835008
    s_lshl_b32 s15, s96, 7
    s_add_u32 s14, s14, s15
    s_add_u32 s14, s14, 0
    buffer_load_dword v246, v250, s[56:59], s14 offen
    v_exp_f32 v215, v79
    v_add_f32 v219, v219, v214
    v_mfma_f32_32x32x16_bf16 a[96:111], a[156:159], v[116:119], a[96:111]
    ds_read_b64_tr_b16 a[150:151], v230 offset:14336
    v_add_f32 v219, v219, v215
    v_cvt_pk_bf16_f32 v143, v214, v215
    v_max_f32 v1, v218, v219
    v_cmp_lt_f32 vcc, s49, v1
    v_exp_f32 v208, v16
    v_mfma_f32_32x32x16_bf16 a[112:127], a[156:159], v[124:127], a[112:127]
    v_exp_f32 v209, v17
    s_cbranch_vccnz L_rare_t57
L_back_t57:
    s_waitcnt vmcnt(5)
    s_barrier
    v_cmp_le_u32 vcc, 32, v252
    s_cmp_eq_u64 vcc, -1
    s_cbranch_scc1 L_hok
    s_mov_b32 s51, 1048576
    v_and_b32 v1, 7, v0
    v_lshlrev_b32 v1, 8, v1
    s_mov_b32 s3, 6307840
L_poll8_h:
    buffer_load_dword v4, v1, s[60:63], s3 offen sc1
    s_waitcnt vmcnt(0)
    v_cmp_le_u32 vcc, 32, v4
    s_cmp_eq_u64 vcc, -1
    s_cbranch_scc1 L_poll8d_h
    s_sleep 16
    s_sub_u32 s51, s51, 1
    s_cmp_lg_u32 s51, 0
    s_cbranch_scc1 L_poll8_h
L_poll8d_h:
L_hok:
    s_waitcnt lgkmcnt(3)
    v_mfma_f32_32x32x16_bf16 v[48:63], a[128:131], v[144:147], v[80:95]
    ds_read_b128 a[136:139], v224 offset:24576
    v_exp_f32 v210, v18
    v_add_f32 v216, v208, v209
    v_cvt_pk_bf16_f32 v112, v208, v209
    v_mfma_f32_32x32x16_bf16 v[64:79], a[128:131], v[176:179], v[96:111]
    ds_read_b64_tr_b16 a[152:153], v231 offset:8192
    v_exp_f32 v211, v19
    v_add_f32 v216, v216, v210
    v_mfma_f32_32x32x16_bf16 a[0:15], a[144:147], v[128:131], a[0:15]
    ds_read_b64_tr_b16 a[154:155], v231 offset:10240
    v_exp_f32 v212, v20
    v_add_f32 v216, v216, v211
    v_cvt_pk_bf16_f32 v113, v210, v211
    v_mfma_f32_32x32x16_bf16 a[16:31], a[144:147], v[136:139], a[16:31]
    s_and_b32 s14, s32, 3
    s_mul_i32 s14, s14, 1835008
    s_lshl_b32 s15, s96, 7
    s_add_u32 s14, s14, s15
    s_add_u32 s14, s14, 458752
    buffer_load_dword v247, v250, s[56:59], s14 offen
    v_exp_f32 v213, v21
    v_add_f32 v216, v216, v212
    v_add_f32 v220, v220, v218
    s_waitcnt lgkmcnt(3)
    v_mfma_f32_32x32x16_bf16 v[48:63], a[132:135], v[148:151], v[48:63]
    ds_read_b128 a[140:143], v225 offset:24576
    v_exp_f32 v214, v22
    v_add_f32 v216, v216, v213
    v_cvt_pk_bf16_f32 v114, v212, v213
    v_mfma_f32_32x32x16_bf16 v[64:79], a[132:135], v[180:183], v[64:79]
    ds_read_b64_tr_b16 a[156:157], v231 offset:12288
    v_exp_f32 v215, v23
    v_add_f32 v216, v216, v214
    v_mfma_f32_32x32x16_bf16 a[0:15], a[148:151], v[132:135], a[0:15]
    ds_read_b64_tr_b16 a[158:159], v231 offset:14336
    v_exp_f32 v208, v24
    v_add_f32 v216, v216, v215
    v_cvt_pk_bf16_f32 v115, v214, v215
    v_mfma_f32_32x32x16_bf16 a[16:31], a[148:151], v[140:143], a[16:31]
    v_exp_f32 v209, v25
    v_add_f32 v216, v216, v208
    v_add_f32 v221, v221, v219
    s_waitcnt lgkmcnt(3)
    v_mfma_f32_32x32x16_bf16 v[48:63], a[136:139], v[152:155], v[48:63]
    ds_read_b128 a[128:131], v226 offset:24576
    v_exp_f32 v210, v26
    v_add_f32 v216, v216, v209
    v_cvt_pk_bf16_f32 v116, v208, v209
    v_mfma_f32_32x32x16_bf16 v[64:79], a[136:139], v[184:187], v[64:79]
    ds_read_b64_tr_b16 a[144:145], v232 offset:8192
    v_exp_f32 v211, v27
    v_add_f32 v216, v216, v210
    v_mfma_f32_32x32x16_bf16 a[32:47], a[152:155], v[128:131], a[32:47]
    ds_read_b64_tr_b16 a[146:147], v232 offset:10240
    v_exp_f32 v212, v28
    v_add_f32 v216, v216, v211
    v_cvt_pk_bf16_f32 v117, v210, v211
    v_mfma_f32_32x32x16_bf16 a[48:63], a[152:155], v[136:139], a[48:63]
    s_lshl_b32 s14, s97, 18
    s_lshr_b32 s15, s32, 2
    s_and_b32 s15, s15, 3
    s_lshl_b32 s15, s15, 16
    s_add_u32 s14, s14, s15
    s_add_u32 s14, s14, 2097152
    buffer_load_dword v248, v251, s[60:63], s14 offen sc1
    v_exp_f32 v213, v29
    v_add_f32 v216, v216, v212
    s_waitcnt lgkmcnt(3)
    v_mfma_f32_32x32x16_bf16 v[48:63], a[140:143], v[156:159], v[48:63]
    ds_read_b128 a[132:135], v227 offset:24576
    v_exp_f32 v214, v30
    v_add_f32 v216, v216, v213
    v_cvt_pk_bf16_f32 v118, v212, v213
    v_mfma_f32_32x32x16_bf16 v[64:79], a[140:143], v[188:191], v[64:79]
    ds_read_b64_tr_b16 a[148:149], v232 offset:12288
    v_exp_f32 v215, v31
    v_add_f32 v216, v216, v214
    v_mfma_f32_32x32x16_bf16 a[32:47], a[156:159], v[132:135], a[32:47]
    ds_read_b64_tr_b16 a[150:151], v232 offset:14336
    v_exp_f32 v208, v32
    v_add_f32 v216, v216, v215
    v_cvt_pk_bf16_f32 v119, v214, v215
    v_mfma_f32_32x32x16_bf16 a[48:63], a[156:159], v[140:143], a[48:63]
    v_exp_f32 v209, v33
    s_waitcnt lgkmcnt(3)
    v_mfma_f32_32x32x16_bf16 v[48:63], a[128:131], v[160:163], v[48:63]
    ds_read_b128 a[136:139], v228 offset:24576
    v_exp_f32 v210, v34
    v_add_f32 v217, v208, v209
    v_cvt_pk_bf16_f32 v120, v208, v209
    v_mfma_f32_32x32x16_bf16 v[64:79], a[128:131], v[192:195], v[64:79]
    ds_read_b64_tr_b16 a[152:153], v233 offset:8192
    v_exp_f32 v211, v35
    v_add_f32 v217, v217, v210
    v_mfma_f32_32x32x16_bf16 a[64:79], a[144:147], v[128:131], a[64:79]
    ds_read_b64_tr_b16 a[154:155], v233 offset:10240
    v_exp_f32 v212, v36
    v_add_f32 v217, v217, v211
    v_cvt_pk_bf16_f32 v121, v210, v211
    v_mfma_f32_32x32x16_bf16 a[80:95], a[144:147], v[136:139], a[80:95]
    s_and_b32 s14, s32, 3
    s_mul_i32 s14, s14, 1835008
    s_lshl_b32 s15, s96, 7
    s_add_u32 s14, s14, s15
    s_add_u32 s14, s14, 917504
    buffer_load_dword v246, v250, s[56:59], s14 offen
    v_exp_f32 v213, v37
    v_add_f32 v217, v217, v212
    s_waitcnt lgkmcnt(3)
    v_mfma_f32_32x32x16_bf16 v[48:63], a[132:135], v[164:167], v[48:63]
    ds_read_b128 a[140:143], v229 offset:24576
    v_exp_f32 v214, v38
    v_add_f32 v217, v217, v213
    v_cvt_pk_bf16_f32 v122, v212, v213
    v_mfma_f32_32x32x16_bf16 v[64:79], a[132:135], v[196:199], v[64:79]
    ds_read_b64_tr_b16 a[156:157], v233 offset:12288
    v_exp_f32 v215, v39
    v_add_f32 v217, v217, v214
    v_mfma_f32_32x32x16_bf16 a[64:79], a[148:151], v[132:135], a[64:79]
    ds_read_b64_tr_b16 a[158:159], v233 offset:14336
    v_exp_f32 v208, v40
    v_add_f32 v217, v217, v215
    v_cvt_pk_bf16_f32 v123, v214, v215
    v_mfma_f32_32x32x16_bf16 a[80:95], a[148:151], v[140:143], a[80:95]
    v_exp_f32 v209, v41
    v_add_f32 v217, v217, v208
    s_waitcnt lgkmcnt(3)
    v_mfma_f32_32x32x16_bf16 v[48:63], a[136:139], v[168:171], v[48:63]
    ds_read_b128 a[128:131], v222 offset:32768
    v_exp_f32 v210, v42
    v_add_f32 v217, v217, v209
    v_cvt_pk_bf16_f32 v124, v208, v209
    v_mfma_f32_32x32x16_bf16 v[64:79], a[136:139], v[200:203], v[64:79]
    ds_read_b64_tr_b16 a[144:145], v230 offset:16384
    v_exp_f32 v211, v43
    v_add_f32 v217, v217, v210
    v_mfma_f32_32x32x16_bf16 a[96:111], a[152:155], v[128:131], a[96:111]
    ds_read_b64_tr_b16 a[146:147], v230 offset:18432
    v_exp_f32 v212, v44
    v_add_f32 v217, v217, v211
    v_cvt_pk_bf16_f32 v125, v210, v211
    v_mfma_f32_32x32x16_bf16 a[112:127], a[152:155], v[136:139], a[112:127]
    s_lshl_b32 s14, s97, 18
    s_lshr_b32 s15, s32, 2
    s_and_b32 s15, s15, 3
    s_lshl_b32 s15, s15, 16
    s_add_u32 s14, s14, s15
    s_add_u32 s14, s14, 2113536
    buffer_load_dword v249, v251, s[60:63], s14 offen sc1
    v_exp_f32 v213, v45
    v_add_f32 v217, v217, v212
    s_waitcnt lgkmcnt(3)
    v_mfma_f32_32x32x16_bf16 v[48:63], a[140:143], v[172:175], v[48:63]
    ds_read_b128 a[132:135], v223 offset:32768
    v_exp_f32 v214, v46
    v_add_f32 v217, v217, v213
    v_cvt_pk_bf16_f32 v126, v212, v213
    v_mfma_f32_32x32x16_bf16 v[64:79], a[140:143], v[204:207], v[64:79]
    ds_read_b64_tr_b16 a[148:149], v230 offset:20480
    v_exp_f32 v215, v47
    v_add_f32 v217, v217, v214
    v_mfma_f32_32x32x16_bf16 a[96:111], a[156:159], v[132:135], a[96:111]
    ds_read_b64_tr_b16 a[150:151], v230 offset:22528
    v_add_f32 v217, v217, v215
    v_cvt_pk_bf16_f32 v127, v214, v215
    v_max_f32 v1, v216, v217
    v_cmp_lt_f32 vcc, s49, v1
    v_exp_f32 v208, v48
    v_mfma_f32_32x32x16_bf16 a[112:127], a[156:159], v[140:143], a[112:127]
    v_exp_f32 v209, v49
    s_cbranch_vccnz L_rare_t58
L_back_t58:
    s_waitcnt lgkmcnt(3)
    v_mfma_f32_32x32x16_bf16 v[16:31], a[128:131], v[144:147], v[80:95]
    ds_read_b128 a[136:139], v224 offset:32768
    v_exp_f32 v210, v50
    v_add_f32 v218, v208, v209
    v_cvt_pk_bf16_f32 v128, v208, v209
    v_mfma_f32_32x32x16_bf16 v[32:47], a[128:131], v[176:179], v[96:111]
    ds_read_b64_tr_b16 a[152:153], v231 offset:16384
    v_exp_f32 v211, v51
    v_add_f32 v218, v218, v210
    v_mfma_f32_32x32x16_bf16 a[0:15], a[144:147], v[112:115], a[0:15]
    ds_read_b64_tr_b16 a[154:155], v231 offset:18432
    v_exp_f32 v212, v52
    v_add_f32 v218, v218, v211
    v_cvt_pk_bf16_f32 v129, v210, v211
    v_mfma_f32_32x32x16_bf16 a[16:31], a[144:147], v[120:123], a[16:31]
    v_exp_f32 v213, v53
    v_add_f32 v218, v218, v212
    v_add_f32 v220, v220, v216
    s_waitcnt lgkmcnt(3)
    v_mfma_f32_32x32x16_bf16 v[16:31], a[132:135], v[148:151], v[16:31]
    ds_read_b128 a[140:143], v225 offset:32768
    v_exp_f32 v214, v54
    v_add_f32 v218, v218, v213
    v_cvt_pk_bf16_f32 v130, v212, v213
    v_mfma_f32_32x32x16_bf16 v[32:47], a[132:135], v[180:183], v[32:47]
    ds_read_b64_tr_b16 a[156:157], v231 offset:20480
    v_exp_f32 v215, v55
    v_add_f32 v218, v218, v214
    v_mfma_f32_32x32x16_bf16 a[0:15], a[148:151], v[116:119], a[0:15]
    ds_read_b64_tr_b16 a[158:159], v231 offset:22528
    v_exp_f32 v208, v56
    v_add_f32 v218, v218, v215
    v_cvt_pk_bf16_f32 v131, v214, v215
    v_mfma_f32_32x32x16_bf16 a[16:31], a[148:151], v[124:127], a[16:31]
    v_exp_f32 v209, v57
    v_add_f32 v218, v218, v208
    v_add_f32 v221, v221, v217
    s_waitcnt lgkmcnt(3)
    v_mfma_f32_32x32x16_bf16 v[16:31], a[136:139], v[152:155], v[16:31]
    ds_read_b128 a[128:131], v226 offset:32768
    s_add_u32 m0, s46, 49152
    v_exp_f32 v210, v58
    v_add_f32 v218, v218, v209
    v_cvt_pk_bf16_f32 v132, v208, v209
    v_mfma_f32_32x32x16_bf16 v[32:47], a[136:139], v[184:187], v[32:47]
    ds_read_b64_tr_b16 a[144:145], v232 offset:16384
    v_exp_f32 v211, v59
    v_add_f32 v218, v218, v210
    v_mfma_f32_32x32x16_bf16 a[32:47], a[152:155], v[112:115], a[32:47]
    ds_read_b64_tr_b16 a[146:147], v232 offset:18432
    v_exp_f32 v212, v60
    v_add_f32 v218, v218, v211
    v_cvt_pk_bf16_f32 v133, v210, v211
    v_mfma_f32_32x32x16_bf16 a[48:63], a[152:155], v[120:123], a[48:63]
    buffer_load_dwordx4 v238, s[20:23], s44 offen offset:0  lds
    v_exp_f32 v213, v61
    v_add_f32 v218, v218, v212
    s_waitcnt lgkmcnt(3)
    v_mfma_f32_32x32x16_bf16 v[16:31], a[140:143], v[156:159], v[16:31]
    ds_read_b128 a[132:135], v227 offset:32768
    v_exp_f32 v214, v62
    v_add_f32 v218, v218, v213
    v_cvt_pk_bf16_f32 v134, v212, v213
    v_mfma_f32_32x32x16_bf16 v[32:47], a[140:143], v[188:191], v[32:47]
    ds_read_b64_tr_b16 a[148:149], v232 offset:20480
    v_exp_f32 v215, v63
    v_add_f32 v218, v218, v214
    v_mfma_f32_32x32x16_bf16 a[32:47], a[156:159], v[116:119], a[32:47]
    ds_read_b64_tr_b16 a[150:151], v232 offset:22528
    v_exp_f32 v208, v64
    v_add_f32 v218, v218, v215
    v_cvt_pk_bf16_f32 v135, v214, v215
    v_mfma_f32_32x32x16_bf16 a[48:63], a[156:159], v[124:127], a[48:63]
    buffer_load_dwordx4 v238, s[20:23], s44 offen offset:1024  lds
    v_exp_f32 v209, v65
    s_waitcnt lgkmcnt(3)
    v_mfma_f32_32x32x16_bf16 v[16:31], a[128:131], v[160:163], v[16:31]
    ds_read_b128 a[136:139], v228 offset:32768
    v_exp_f32 v210, v66
    v_add_f32 v219, v208, v209
    v_cvt_pk_bf16_f32 v136, v208, v209
    v_mfma_f32_32x32x16_bf16 v[32:47], a[128:131], v[192:195], v[32:47]
    ds_read_b64_tr_b16 a[152:153], v233 offset:16384
    v_exp_f32 v211, v67
    v_add_f32 v219, v219, v210
    v_mfma_f32_32x32x16_bf16 a[64:79], a[144:147], v[112:115], a[64:79]
    ds_read_b64_tr_b16 a[154:155], v233 offset:18432
    v_exp_f32 v212, v68
    v_add_f32 v219, v219, v211
    v_cvt_pk_bf16_f32 v137, v210, v211
    v_mfma_f32_32x32x16_bf16 a[80:95], a[144:147], v[120:123], a[80:95]
    buffer_load_dwordx4 v238, s[20:23], s44 offen offset:2048  lds
    v_exp_f32 v213, v69
    v_add_f32 v219, v219, v212
    s_waitcnt lgkmcnt(3)
    v_mfma_f32_32x32x16_bf16 v[16:31], a[132:135], v[164:167], v[16:31]
    ds_read_b128 a[140:143], v229 offset:32768
    v_exp_f32 v214, v70
    v_add_f32 v219, v219, v213
    v_cvt_pk_bf16_f32 v138, v212, v213
    v_mfma_f32_32x32x16_bf16 v[32:47], a[132:135], v[196:199], v[32:47]
    ds_read_b64_tr_b16 a[156:157], v233 offset:20480
    v_exp_f32 v215, v71
    v_add_f32 v219, v219, v214
    v_mfma_f32_32x32x16_bf16 a[64:79], a[148:151], v[116:119], a[64:79]
    ds_read_b64_tr_b16 a[158:159], v233 offset:22528
    v_exp_f32 v208, v72
    v_add_f32 v219, v219, v215
    v_cvt_pk_bf16_f32 v139, v214, v215
    v_mfma_f32_32x32x16_bf16 a[80:95], a[148:151], v[124:127], a[80:95]
    buffer_load_dwordx4 v238, s[20:23], s44 offen offset:3072  lds
    v_exp_f32 v209, v73
    v_add_f32 v219, v219, v208
    s_waitcnt lgkmcnt(3)
    v_mfma_f32_32x32x16_bf16 v[16:31], a[136:139], v[168:171], v[16:31]
    ds_read_b128 a[128:131], v222 offset:40960
    v_exp_f32 v210, v74
    v_add_f32 v219, v219, v209
    v_cvt_pk_bf16_f32 v140, v208, v209
    v_mfma_f32_32x32x16_bf16 v[32:47], a[136:139], v[200:203], v[32:47]
    ds_read_b64_tr_b16 a[144:145], v230 offset:24576
    v_exp_f32 v211, v75
    v_add_f32 v219, v219, v210
    v_mfma_f32_32x32x16_bf16 a[96:111], a[152:155], v[112:115], a[96:111]
    ds_read_b64_tr_b16 a[146:147], v230 offset:26624
    v_exp_f32 v212, v76
    v_add_f32 v219, v219, v211
    v_cvt_pk_bf16_f32 v141, v210, v211
    v_mfma_f32_32x32x16_bf16 a[112:127], a[152:155], v[120:123], a[112:127]
    s_add_u32 s44, s44, 16384
    s_and_b32 s14, s32, 3
    s_mul_i32 s14, s14, 1835008
    s_lshl_b32 s15, s96, 7
    s_add_u32 s14, s14, s15
    s_add_u32 s14, s14, 1376256
    buffer_load_dword v247, v250, s[56:59], s14 offen
    v_exp_f32 v213, v77
    v_add_f32 v219, v219, v212
    s_waitcnt lgkmcnt(3)
    v_mfma_f32_32x32x16_bf16 v[16:31], a[140:143], v[172:175], v[16:31]
    ds_read_b128 a[132:135], v223 offset:40960
    s_lshl_b32 s14, s97, 18
    s_lshr_b32 s15, s32, 2
    s_and_b32 s15, s15, 3
    s_lshl_b32 s15, s15, 16
    s_add_u32 s14, s14, s15
    s_add_u32 s14, s14, 2129920
    buffer_load_dword v248, v251, s[60:63], s14 offen sc1
    v_exp_f32 v214, v78
    v_add_f32 v219, v219, v213
    v_cvt_pk_bf16_f32 v142, v212, v213
    v_mfma_f32_32x32x16_bf16 v[32:47], a[140:143], v[204:207], v[32:47]
    ds_read_b64_tr_b16 a[148:149], v230 offset:28672
    s_lshl_b32 s14, s97, 18
    s_lshr_b32 s15, s32, 2
    s_and_b32 s15, s15, 3
    s_lshl_b32 s15, s15, 16
    s_add_u32 s14, s14, s15
    s_add_u32 s14, s14, 2146304
    buffer_load_dword v249, v251, s[60:63], s14 offen sc1
    v_exp_f32 v215, v79
    v_add_f32 v219, v219, v214
    v_mfma_f32_32x32x16_bf16 a[96:111], a[156:159], v[116:119], a[96:111]
    ds_read_b64_tr_b16 a[150:151], v230 offset:30720
    v_add_f32 v219, v219, v215
    v_cvt_pk_bf16_f32 v143, v214, v215
    v_max_f32 v1, v218, v219
    v_cmp_lt_f32 vcc, s49, v1
    s_cmp_lg_u32 s42, 0
    s_cbranch_scc1 L_tk_skip
    v_mov_b32 v254, 1
    v_mov_b32 v2, 0
    s_lshl_b32 s14, s33, 8
    s_add_u32 s14, s14, 6309888
    s_mov_b64 s[12:13], exec
    s_mov_b64 exec, 1
    buffer_atomic_add v254, v2, s[60:63], s14 offen sc0
    s_mov_b64 exec, s[12:13]
L_tk_skip:
    v_exp_f32 v208, v16
    v_mfma_f32_32x32x16_bf16 a[112:127], a[156:159], v[124:127], a[112:127]
    v_exp_f32 v209, v17
    s_cbranch_vccnz L_rare_t59
L_back_t59:
    s_waitcnt vmcnt(11)
    s_barrier
    s_waitcnt lgkmcnt(3)
    v_mfma_f32_32x32x16_bf16 v[48:63], a[128:131], v[144:147], v[80:95]
    ds_read_b128 a[136:139], v224 offset:40960
    v_exp_f32 v210, v18
    v_add_f32 v216, v208, v209
    v_cvt_pk_bf16_f32 v112, v208, v209
    v_mfma_f32_32x32x16_bf16 v[64:79], a[128:131], v[176:179], v[96:111]
    ds_read_b64_tr_b16 a[152:153], v231 offset:24576
    v_exp_f32 v211, v19
    v_add_f32 v216, v216, v210
    v_mfma_f32_32x32x16_bf16 a[0:15], a[144:147], v[128:131], a[0:15]
    ds_read_b64_tr_b16 a[154:155], v231 offset:26624
    v_exp_f32 v212, v20
    v_add_f32 v216, v216, v211
    v_cvt_pk_bf16_f32 v113, v210, v211
    v_mfma_f32_32x32x16_bf16 a[16:31], a[144:147], v[136:139], a[16:31]
    v_exp_f32 v213, v21
    v_add_f32 v216, v216, v212
    v_add_f32 v220, v220, v218
    s_waitcnt lgkmcnt(3)
    v_mfma_f32_32x32x16_bf16 v[48:63], a[132:135], v[148:151], v[48:63]
    ds_read_b128 a[140:143], v225 offset:40960
    v_exp_f32 v214, v22
    v_add_f32 v216, v216, v213
    v_cvt_pk_bf16_f32 v114, v212, v213
    v_mfma_f32_32x32x16_bf16 v[64:79], a[132:135], v[180:183], v[64:79]
    ds_read_b64_tr_b16 a[156:157], v231 offset:28672
    v_exp_f32 v215, v23
    v_add_f32 v216, v216, v214
    v_mfma_f32_32x32x16_bf16 a[0:15], a[148:151], v[132:135], a[0:15]
    ds_read_b64_tr_b16 a[158:159], v231 offset:30720
    v_exp_f32 v208, v24
    v_add_f32 v216, v216, v215
    v_cvt_pk_bf16_f32 v115, v214, v215
    v_mfma_f32_32x32x16_bf16 a[16:31], a[148:151], v[140:143], a[16:31]
    v_exp_f32 v209, v25
    v_add_f32 v216, v216, v208
    v_add_f32 v221, v221, v219
    s_waitcnt lgkmcnt(3)
    v_mfma_f32_32x32x16_bf16 v[48:63], a[136:139], v[152:155], v[48:63]
    ds_read_b128 a[128:131], v226 offset:40960
    v_exp_f32 v210, v26
    v_add_f32 v216, v216, v209
    v_cvt_pk_bf16_f32 v116, v208, v209
    v_mfma_f32_32x32x16_bf16 v[64:79], a[136:139], v[184:187], v[64:79]
    ds_read_b64_tr_b16 a[144:145], v232 offset:24576
    v_exp_f32 v211, v27
    v_add_f32 v216, v216, v210
    v_mfma_f32_32x32x16_bf16 a[32:47], a[152:155], v[128:131], a[32:47]
    ds_read_b64_tr_b16 a[146:147], v232 offset:26624
    v_exp_f32 v212, v28
    v_add_f32 v216, v216, v211
    v_cvt_pk_bf16_f32 v117, v210, v211
    v_mfma_f32_32x32x16_bf16 a[48:63], a[152:155], v[136:139], a[48:63]
    v_exp_f32 v213, v29
    v_add_f32 v216, v216, v212
    s_waitcnt lgkmcnt(3)
    v_mfma_f32_32x32x16_bf16 v[48:63], a[140:143], v[156:159], v[48:63]
    ds_read_b128 a[132:135], v227 offset:40960
    v_exp_f32 v214, v30
    v_add_f32 v216, v216, v213
    v_cvt_pk_bf16_f32 v118, v212, v213
    v_mfma_f32_32x32x16_bf16 v[64:79], a[140:143], v[188:191], v[64:79]
    ds_read_b64_tr_b16 a[148:149], v232 offset:28672
    v_exp_f32 v215, v31
    v_add_f32 v216, v216, v214
    v_mfma_f32_32x32x16_bf16 a[32:47], a[156:159], v[132:135], a[32:47]
    ds_read_b64_tr_b16 a[150:151], v232 offset:30720
    v_exp_f32 v208, v32
    v_add_f32 v216, v216, v215
    v_cvt_pk_bf16_f32 v119, v214, v215
    v_mfma_f32_32x32x16_bf16 a[48:63], a[156:159], v[140:143], a[48:63]
    v_exp_f32 v209, v33
    s_waitcnt lgkmcnt(3)
    v_mfma_f32_32x32x16_bf16 v[48:63], a[128:131], v[160:163], v[48:63]
    ds_read_b128 a[136:139], v228 offset:40960
    v_exp_f32 v210, v34
    v_add_f32 v217, v208, v209
    v_cvt_pk_bf16_f32 v120, v208, v209
    v_mfma_f32_32x32x16_bf16 v[64:79], a[128:131], v[192:195], v[64:79]
    ds_read_b64_tr_b16 a[152:153], v233 offset:24576
    v_exp_f32 v211, v35
    v_add_f32 v217, v217, v210
    v_mfma_f32_32x32x16_bf16 a[64:79], a[144:147], v[128:131], a[64:79]
    ds_read_b64_tr_b16 a[154:155], v233 offset:26624
    v_exp_f32 v212, v36
    v_add_f32 v217, v217, v211
    v_cvt_pk_bf16_f32 v121, v210, v211
    v_mfma_f32_32x32x16_bf16 a[80:95], a[144:147], v[136:139], a[80:95]
    v_exp_f32 v213, v37
    v_add_f32 v217, v217, v212
    s_waitcnt lgkmcnt(3)
    v_mfma_f32_32x32x16_bf16 v[48:63], a[132:135], v[164:167], v[48:63]
    ds_read_b128 a[140:143], v229 offset:40960
    v_exp_f32 v214, v38
    v_add_f32 v217, v217, v213
    v_cvt_pk_bf16_f32 v122, v212, v213
    v_mfma_f32_32x32x16_bf16 v[64:79], a[132:135], v[196:199], v[64:79]
    ds_read_b64_tr_b16 a[156:157], v233 offset:28672
    v_exp_f32 v215, v39
    v_add_f32 v217, v217, v214
    v_mfma_f32_32x32x16_bf16 a[64:79], a[148:151], v[132:135], a[64:79]
    ds_read_b64_tr_b16 a[158:159], v233 offset:30720
    v_exp_f32 v208, v40
    v_add_f32 v217, v217, v215
    v_cvt_pk_bf16_f32 v123, v214, v215
    v_mfma_f32_32x32x16_bf16 a[80:95], a[148:151], v[140:143], a[80:95]
    v_exp_f32 v209, v41
    v_add_f32 v217, v217, v208
    s_waitcnt lgkmcnt(3)
    v_mfma_f32_32x32x16_bf16 v[48:63], a[136:139], v[168:171], v[48:63]
    ds_read_b128 a[128:131], v222 offset:49152
    v_exp_f32 v210, v42
    v_add_f32 v217, v217, v209
    v_cvt_pk_bf16_f32 v124, v208, v209
    v_mfma_f32_32x32x16_bf16 v[64:79], a[136:139], v[200:203], v[64:79]
    ds_read_b64_tr_b16 a[144:145], v230 offset:32768
    v_exp_f32 v211, v43
    v_add_f32 v217, v217, v210
    v_mfma_f32_32x32x16_bf16 a[96:111], a[152:155], v[128:131], a[96:111]
    ds_read_b64_tr_b16 a[146:147], v230 offset:34816
    v_exp_f32 v212, v44
    v_add_f32 v217, v217, v211
    v_cvt_pk_bf16_f32 v125, v210, v211
    v_mfma_f32_32x32x16_bf16 a[112:127], a[152:155], v[136:139], a[112:127]
    v_exp_f32 v213, v45
    v_add_f32 v217, v217, v212
    s_waitcnt lgkmcnt(3)
    v_mfma_f32_32x32x16_bf16 v[48:63], a[140:143], v[172:175], v[48:63]
    ds_read_b128 a[132:135], v223 offset:49152
    v_exp_f32 v214, v46
    v_add_f32 v217, v217, v213
    v_cvt_pk_bf16_f32 v126, v212, v213
    v_mfma_f32_32x32x16_bf16 v[64:79], a[140:143], v[204:207], v[64:79]
    ds_read_b64_tr_b16 a[148:149], v230 offset:36864
    v_exp_f32 v215, v47
    v_add_f32 v217, v217, v214
    v_mfma_f32_32x32x16_bf16 a[96:111], a[156:159], v[132:135], a[96:111]
    ds_read_b64_tr_b16 a[150:151], v230 offset:38912
    v_add_f32 v217, v217, v215
    v_cvt_pk_bf16_f32 v127, v214, v215
    v_max_f32 v1, v216, v217
    v_cmp_lt_f32 vcc, s49, v1
    v_exp_f32 v208, v48
    v_mfma_f32_32x32x16_bf16 a[112:127], a[156:159], v[140:143], a[112:127]
    v_exp_f32 v209, v49
    s_cbranch_vccnz L_rare_t60
L_back_t60:
    s_waitcnt lgkmcnt(3)
    v_mfma_f32_32x32x16_bf16 v[16:31], a[128:131], v[144:147], v[80:95]
    ds_read_b128 a[136:139], v224 offset:49152
    v_exp_f32 v210, v50
    v_add_f32 v218, v208, v209
    v_cvt_pk_bf16_f32 v128, v208, v209
    v_mfma_f32_32x32x16_bf16 v[32:47], a[128:131], v[176:179], v[96:111]
    ds_read_b64_tr_b16 a[152:153], v231 offset:32768
    v_exp_f32 v211, v51
    v_add_f32 v218, v218, v210
    v_mfma_f32_32x32x16_bf16 a[0:15], a[144:147], v[112:115], a[0:15]
    ds_read_b64_tr_b16 a[154:155], v231 offset:34816
    v_exp_f32 v212, v52
    v_add_f32 v218, v218, v211
    v_cvt_pk_bf16_f32 v129, v210, v211
    v_mfma_f32_32x32x16_bf16 a[16:31], a[144:147], v[120:123], a[16:31]
    v_exp_f32 v213, v53
    v_add_f32 v218, v218, v212
    v_add_f32 v220, v220, v216
    s_waitcnt lgkmcnt(3)
    v_mfma_f32_32x32x16_bf16 v[16:31], a[132:135], v[148:151], v[16:31]
    ds_read_b128 a[140:143], v225 offset:49152
    v_exp_f32 v214, v54
    v_add_f32 v218, v218, v213
    v_cvt_pk_bf16_f32 v130, v212, v213
    v_mfma_f32_32x32x16_bf16 v[32:47], a[132:135], v[180:183], v[32:47]
    ds_read_b64_tr_b16 a[156:157], v231 offset:36864
    v_exp_f32 v215, v55
    v_add_f32 v218, v218, v214
    v_mfma_f32_32x32x16_bf16 a[0:15], a[148:151], v[116:119], a[0:15]
    ds_read_b64_tr_b16 a[158:159], v231 offset:38912
    v_exp_f32 v208, v56
    v_add_f32 v218, v218, v215
    v_cvt_pk_bf16_f32 v131, v214, v215
    v_mfma_f32_32x32x16_bf16 a[16:31], a[148:151], v[124:127], a[16:31]
    v_exp_f32 v209, v57
    v_add_f32 v218, v218, v208
    v_add_f32 v221, v221, v217
    s_waitcnt lgkmcnt(3)
    v_mfma_f32_32x32x16_bf16 v[16:31], a[136:139], v[152:155], v[16:31]
    ds_read_b128 a[128:131], v226 offset:49152
    v_exp_f32 v210, v58
    v_add_f32 v218, v218, v209
    v_cvt_pk_bf16_f32 v132, v208, v209
    v_mfma_f32_32x32x16_bf16 v[32:47], a[136:139], v[184:187], v[32:47]
    ds_read_b64_tr_b16 a[144:145], v232 offset:32768
    v_exp_f32 v211, v59
    v_add_f32 v218, v218, v210
    v_mfma_f32_32x32x16_bf16 a[32:47], a[152:155], v[112:115], a[32:47]
    ds_read_b64_tr_b16 a[146:147], v232 offset:34816
    v_exp_f32 v212, v60
    v_add_f32 v218, v218, v211
    v_cvt_pk_bf16_f32 v133, v210, v211
    v_mfma_f32_32x32x16_bf16 a[48:63], a[152:155], v[120:123], a[48:63]
    v_exp_f32 v213, v61
    v_add_f32 v218, v218, v212
    s_waitcnt lgkmcnt(3)
    v_mfma_f32_32x32x16_bf16 v[16:31], a[140:143], v[156:159], v[16:31]
    ds_read_b128 a[132:135], v227 offset:49152
    v_exp_f32 v214, v62
    v_add_f32 v218, v218, v213
    v_cvt_pk_bf16_f32 v134, v212, v213
    v_mfma_f32_32x32x16_bf16 v[32:47], a[140:143], v[188:191], v[32:47]
    ds_read_b64_tr_b16 a[148:149], v232 offset:36864
    v_exp_f32 v215, v63
    v_add_f32 v218, v218, v214
    v_mfma_f32_32x32x16_bf16 a[32:47], a[156:159], v[116:119], a[32:47]
    ds_read_b64_tr_b16 a[150:151], v232 offset:38912
    v_exp_f32 v208, v64
    v_add_f32 v218, v218, v215
    v_cvt_pk_bf16_f32 v135, v214, v215
    v_mfma_f32_32x32x16_bf16 a[48:63], a[156:159], v[124:127], a[48:63]
    v_exp_f32 v209, v65
    s_waitcnt lgkmcnt(3)
    v_mfma_f32_32x32x16_bf16 v[16:31], a[128:131], v[160:163], v[16:31]
    ds_read_b128 a[136:139], v228 offset:49152
    v_exp_f32 v210, v66
    v_add_f32 v219, v208, v209
    v_cvt_pk_bf16_f32 v136, v208, v209
    v_mfma_f32_32x32x16_bf16 v[32:47], a[128:131], v[192:195], v[32:47]
    ds_read_b64_tr_b16 a[152:153], v233 offset:32768
    v_exp_f32 v211, v67
    v_add_f32 v219, v219, v210
    v_mfma_f32_32x32x16_bf16 a[64:79], a[144:147], v[112:115], a[64:79]
    ds_read_b64_tr_b16 a[154:155], v233 offset:34816
    v_exp_f32 v212, v68
    v_add_f32 v219, v219, v211
    v_cvt_pk_bf16_f32 v137, v210, v211
    v_mfma_f32_32x32x16_bf16 a[80:95], a[144:147], v[120:123], a[80:95]
    v_exp_f32 v213, v69
    v_add_f32 v219, v219, v212
    s_waitcnt lgkmcnt(3)
    v_mfma_f32_32x32x16_bf16 v[16:31], a[132:135], v[164:167], v[16:31]
    ds_read_b128 a[140:143], v229 offset:49152
    v_exp_f32 v214, v70
    v_add_f32 v219, v219, v213
    v_cvt_pk_bf16_f32 v138, v212, v213
    v_mfma_f32_32x32x16_bf16 v[32:47], a[132:135], v[196:199], v[32:47]
    ds_read_b64_tr_b16 a[156:157], v233 offset:36864
    v_exp_f32 v215, v71
    v_add_f32 v219, v219, v214
    v_mfma_f32_32x32x16_bf16 a[64:79], a[148:151], v[116:119], a[64:79]
    ds_read_b64_tr_b16 a[158:159], v233 offset:38912
    v_exp_f32 v208, v72
    v_add_f32 v219, v219, v215
    v_cvt_pk_bf16_f32 v139, v214, v215
    v_mfma_f32_32x32x16_bf16 a[80:95], a[148:151], v[124:127], a[80:95]
    v_exp_f32 v209, v73
    v_add_f32 v219, v219, v208
    s_waitcnt lgkmcnt(3)
    v_mfma_f32_32x32x16_bf16 v[16:31], a[136:139], v[168:171], v[16:31]
    ds_read_b128 a[128:131], v222 offset:57344
    v_exp_f32 v210, v74
    v_add_f32 v219, v219, v209
    v_cvt_pk_bf16_f32 v140, v208, v209
    v_mfma_f32_32x32x16_bf16 v[32:47], a[136:139], v[200:203], v[32:47]
    ds_read_b64_tr_b16 a[144:145], v230 offset:40960
    v_exp_f32 v211, v75
    v_add_f32 v219, v219, v210
    v_mfma_f32_32x32x16_bf16 a[96:111], a[152:155], v[112:115], a[96:111]
    ds_read_b64_tr_b16 a[146:147], v230 offset:43008
    v_exp_f32 v212, v76
    v_add_f32 v219, v219, v211
    v_cvt_pk_bf16_f32 v141, v210, v211
    v_mfma_f32_32x32x16_bf16 a[112:127], a[152:155], v[120:123], a[112:127]
    v_exp_f32 v213, v77
    v_add_f32 v219, v219, v212
    s_waitcnt lgkmcnt(3)
    v_mfma_f32_32x32x16_bf16 v[16:31], a[140:143], v[172:175], v[16:31]
    ds_read_b128 a[132:135], v223 offset:57344
    v_exp_f32 v214, v78
    v_add_f32 v219, v219, v213
    v_cvt_pk_bf16_f32 v142, v212, v213
    v_mfma_f32_32x32x16_bf16 v[32:47], a[140:143], v[204:207], v[32:47]
    ds_read_b64_tr_b16 a[148:149], v230 offset:45056
    v_exp_f32 v215, v79
    v_add_f32 v219, v219, v214
    v_mfma_f32_32x32x16_bf16 a[96:111], a[156:159], v[116:119], a[96:111]
    ds_read_b64_tr_b16 a[150:151], v230 offset:47104
    v_add_f32 v219, v219, v215
    v_cvt_pk_bf16_f32 v143, v214, v215
    v_max_f32 v1, v218, v219
    v_cmp_lt_f32 vcc, s49, v1
    v_exp_f32 v208, v16
    v_mfma_f32_32x32x16_bf16 a[112:127], a[156:159], v[124:127], a[112:127]
    v_exp_f32 v209, v17
    s_cbranch_vccnz L_rare_t61
L_back_t61:
    s_waitcnt vmcnt(3)
    s_cmp_lg_u32 s42, 0
    s_cbranch_scc1 L_tkd_done
    s_waitcnt vmcnt(0)
    v_readfirstlane_b32 s12, v254
    s_mov_b32 s13, s33
    s_cmp_lt_u32 s12, 28
    s_cbranch_scc1 L_tkd_have
    s_cmp_ge_u32 s12, 32
    s_cbranch_scc1 L_tkd_none
    v_and_b32 v255, 7, v0
    v_lshlrev_b32 v255, 8, v255
    s_mov_b32 s15, 6309888
    buffer_load_dword v255, v255, s[60:63], s15 offen sc1
    s_waitcnt vmcnt(0)
    v_readlane_b32 s12, v255, 0
    s_mov_b32 s13, 0
    v_readlane_b32 s14, v255, 1
    s_nop 0
    s_cmp_lt_u32 s14, s12
    s_cselect_b32 s12, s14, s12
    s_cselect_b32 s13, 1, s13
    v_readlane_b32 s14, v255, 2
    s_nop 0
    s_cmp_lt_u32 s14, s12
    s_cselect_b32 s12, s14, s12
    s_cselect_b32 s13, 2, s13
    v_readlane_b32 s14, v255, 3
    s_nop 0
    s_cmp_lt_u32 s14, s12
    s_cselect_b32 s12, s14, s12
    s_cselect_b32 s13, 3, s13
    v_readlane_b32 s14, v255, 4
    s_nop 0
    s_cmp_lt_u32 s14, s12
    s_cselect_b32 s12, s14, s12
    s_cselect_b32 s13, 4, s13
    v_readlane_b32 s14, v255, 5
    s_nop 0
    s_cmp_lt_u32 s14, s12
    s_cselect_b32 s12, s14, s12
    s_cselect_b32 s13, 5, s13
    v_readlane_b32 s14, v255, 6
    s_nop 0
    s_cmp_lt_u32 s14, s12
    s_cselect_b32 s12, s14, s12
    s_cselect_b32 s13, 6, s13
    v_readlane_b32 s14, v255, 7
    s_nop 0
    s_cmp_lt_u32 s14, s12
    s_cselect_b32 s12, s14, s12
    s_cselect_b32 s13, 7, s13
    s_cmp_ge_u32 s12, 28
    s_cbranch_scc1 L_tkd_none
    s_lshl_b32 s14, s13, 8
    s_add_u32 s14, s14, 6309888
    v_mov_b32 v254, 1
    v_mov_b32 v2, 0
    v_cmp_eq_u32 vcc, 0, v0
    s_and_saveexec_b64 s[8:9], vcc
    buffer_atomic_add v254, v2, s[60:63], s14 offen sc0
    s_mov_b64 exec, s[8:9]
    s_waitcnt vmcnt(0)
    v_readfirstlane_b32 s12, v254
    s_cmp_lt_u32 s12, 28
    s_cbranch_scc1 L_tkd_have
L_tkd_none:
    s_mov_b32 s12, 0
    s_branch L_tkd_wr
L_tkd_have:
    s_lshl_b32 s13, s13, 8
    s_or_b32 s12, s12, s13
    s_or_b32 s12, s12, 0x10000
L_tkd_wr:
    v_mov_b32 v2, 163836
    v_mov_b32 v3, s12
    ds_write_b32 v2, v3
    s_waitcnt lgkmcnt(0)
L_tkd_done:
    s_barrier
    v_mov_b32 v2, 163836
    ds_read_b32 v3, v2
    s_waitcnt lgkmcnt(0)
    v_readfirstlane_b32 s12, v3
    s_lshr_b32 s98, s12, 16
    s_cmp_eq_u32 s98, 0
    s_cbranch_scc1 L_tkr_done
    s_bfe_u32 s13, s12, 0x80008
    s_and_b32 s12, s12, 0xff
    s_and_b32 s55, s13, 1
    s_lshl_b32 s55, s55, 2
    s_and_b32 s14, s12, 3
    s_add_u32 s55, s55, s14
    s_lshr_b32 s54, s13, 1
    s_mul_i32 s54, s54, 7
    s_lshr_b32 s14, s12, 2
    s_add_u32 s54, s54, s14
L_tkr_done:
    s_lshl_b32 s46, s42, 14
    s_cmp_eq_u32 s42, 3
    s_cselect_b32 s46, 131072, s46
    s_mul_i32 s43, s42, 1835008
    s_lshl_b32 s3, s54, 7
    s_add_u32 s43, s43, s3
    s_lshl_b32 s44, s55, 1
    s_mul_i32 s44, s44, 128
    s_mul_i32 s3, s42, 32
    s_add_u32 s44, s44, s3
    s_lshl_b32 s44, s44, 10
    s_add_u32 s44, s44, 2097152
    s_add_u32 s45, s44, 131072
    s_waitcnt lgkmcnt(3)
    v_mfma_f32_32x32x16_bf16 v[48:63], a[128:131], v[144:147], v[80:95]
    ds_read_b128 a[136:139], v224 offset:57344
    v_exp_f32 v210, v18
    v_add_f32 v216, v208, v209
    v_cvt_pk_bf16_f32 v112, v208, v209
    v_mfma_f32_32x32x16_bf16 v[64:79], a[128:131], v[176:179], v[96:111]
    ds_read_b64_tr_b16 a[152:153], v231 offset:40960
    s_add_u32 m0, s46, 0
    s_add_u32 s47, s43, 27648
    buffer_load_dwordx4 v10, s[56:59], s43 offen lds
    v_exp_f32 v211, v19
    v_add_f32 v216, v216, v210
    v_mfma_f32_32x32x16_bf16 a[0:15], a[144:147], v[128:131], a[0:15]
    ds_read_b64_tr_b16 a[154:155], v231 offset:43008
    v_exp_f32 v212, v20
    v_add_f32 v216, v216, v211
    v_cvt_pk_bf16_f32 v113, v210, v211
    v_mfma_f32_32x32x16_bf16 a[16:31], a[144:147], v[136:139], a[16:31]
    buffer_load_dwordx4 v10, s[56:59], s47 offen offset:1024 lds
    s_add_u32 s43, s43, 57344
    s_add_u32 m0, s46, 2048
    v_exp_f32 v213, v21
    v_add_f32 v216, v216, v212
    v_add_f32 v220, v220, v218
    s_waitcnt lgkmcnt(3)
    v_mfma_f32_32x32x16_bf16 v[48:63], a[132:135], v[148:151], v[48:63]
    ds_read_b128 a[140:143], v225 offset:57344
    v_exp_f32 v214, v22
    v_add_f32 v216, v216, v213
    v_cvt_pk_bf16_f32 v114, v212, v213
    v_mfma_f32_32x32x16_bf16 v[64:79], a[132:135], v[180:183], v[64:79]
    ds_read_b64_tr_b16 a[156:157], v231 offset:45056
    s_add_u32 s47, s43, 27648
    buffer_load_dwordx4 v10, s[56:59], s43 offen lds
    buffer_load_dwordx4 v10, s[56:59], s47 offen offset:1024 lds
    v_exp_f32 v215, v23
    v_add_f32 v216, v216, v214
    v_mfma_f32_32x32x16_bf16 a[0:15], a[148:151], v[132:135], a[0:15]
    ds_read_b64_tr_b16 a[158:159], v231 offset:47104
    v_exp_f32 v208, v24
    v_add_f32 v216, v216, v215
    v_cvt_pk_bf16_f32 v115, v214, v215
    v_mfma_f32_32x32x16_bf16 a[16:31], a[148:151], v[140:143], a[16:31]
    s_add_u32 s43, s43, 57344
    s_add_u32 m0, s46, 4096
    s_add_u32 s47, s43, 27648
    v_exp_f32 v209, v25
    v_add_f32 v216, v216, v208
    v_add_f32 v221, v221, v219
    s_waitcnt lgkmcnt(3)
    v_mfma_f32_32x32x16_bf16 v[48:63], a[136:139], v[152:155], v[48:63]
    ds_read_b128 a[128:131], v226 offset:57344
    v_exp_f32 v210, v26
    v_add_f32 v216, v216, v209
    v_cvt_pk_bf16_f32 v116, v208, v209
    v_mfma_f32_32x32x16_bf16 v[64:79], a[136:139], v[184:187], v[64:79]
    ds_read_b64_tr_b16 a[144:145], v232 offset:40960
    buffer_load_dwordx4 v10, s[56:59], s43 offen lds
    buffer_load_dwordx4 v10, s[56:59], s47 offen offset:1024 lds
    s_add_u32 s43, s43, 57344
    v_exp_f32 v211, v27
    v_add_f32 v216, v216, v210
    v_mfma_f32_32x32x16_bf16 a[32:47], a[152:155], v[128:131], a[32:47]
    ds_read_b64_tr_b16 a[146:147], v232 offset:43008
    v_exp_f32 v212, v28
    v_add_f32 v216, v216, v211
    v_cvt_pk_bf16_f32 v117, v210, v211
    v_mfma_f32_32x32x16_bf16 a[48:63], a[152:155], v[136:139], a[48:63]
    s_add_u32 m0, s46, 6144
    s_add_u32 s47, s43, 27648
    buffer_load_dwordx4 v10, s[56:59], s43 offen lds
    v_exp_f32 v213, v29
    v_add_f32 v216, v216, v212
    s_waitcnt lgkmcnt(3)
    v_mfma_f32_32x32x16_bf16 v[48:63], a[140:143], v[156:159], v[48:63]
    ds_read_b128 a[132:135], v227 offset:57344
    v_exp_f32 v214, v30
    v_add_f32 v216, v216, v213
    v_cvt_pk_bf16_f32 v118, v212, v213
    v_mfma_f32_32x32x16_bf16 v[64:79], a[140:143], v[188:191], v[64:79]
    ds_read_b64_tr_b16 a[148:149], v232 offset:45056
    buffer_load_dwordx4 v10, s[56:59], s47 offen offset:1024 lds
    s_add_u32 s43, s43, 57344
    s_add_u32 m0, s46, 8192
    v_exp_f32 v215, v31
    v_add_f32 v216, v216, v214
    v_mfma_f32_32x32x16_bf16 a[32:47], a[156:159], v[132:135], a[32:47]
    ds_read_b64_tr_b16 a[150:151], v232 offset:47104
    v_exp_f32 v208, v32
    v_add_f32 v216, v216, v215
    v_cvt_pk_bf16_f32 v119, v214, v215
    v_mfma_f32_32x32x16_bf16 a[48:63], a[156:159], v[140:143], a[48:63]
    s_add_u32 s47, s43, 27648
    buffer_load_dwordx4 v10, s[56:59], s43 offen lds
    buffer_load_dwordx4 v10, s[56:59], s47 offen offset:1024 lds
    v_exp_f32 v209, v33
    s_waitcnt lgkmcnt(3)
    v_mfma_f32_32x32x16_bf16 v[48:63], a[128:131], v[160:163], v[48:63]
    ds_read_b128 a[136:139], v228 offset:57344
    v_exp_f32 v210, v34
    v_add_f32 v217, v208, v209
    v_cvt_pk_bf16_f32 v120, v208, v209
    v_mfma_f32_32x32x16_bf16 v[64:79], a[128:131], v[192:195], v[64:79]
    ds_read_b64_tr_b16 a[152:153], v233 offset:40960
    s_add_u32 s43, s43, 57344
    s_add_u32 m0, s46, 10240
    s_add_u32 s47, s43, 27648
    v_exp_f32 v211, v35
    v_add_f32 v217, v217, v210
    v_mfma_f32_32x32x16_bf16 a[64:79], a[144:147], v[128:131], a[64:79]
    ds_read_b64_tr_b16 a[154:155], v233 offset:43008
    v_exp_f32 v212, v36
    v_add_f32 v217, v217, v211
    v_cvt_pk_bf16_f32 v121, v210, v211
    v_mfma_f32_32x32x16_bf16 a[80:95], a[144:147], v[136:139], a[80:95]
    buffer_load_dwordx4 v10, s[56:59], s43 offen lds
    buffer_load_dwordx4 v10, s[56:59], s47 offen offset:1024 lds
    s_add_u32 s43, s43, 57344
    v_exp_f32 v213, v37
    v_add_f32 v217, v217, v212
    s_waitcnt lgkmcnt(3)
    v_mfma_f32_32x32x16_bf16 v[48:63], a[132:135], v[164:167], v[48:63]
    ds_read_b128 a[140:143], v229 offset:57344
    v_exp_f32 v214, v38
    v_add_f32 v217, v217, v213
    v_cvt_pk_bf16_f32 v122, v212, v213
    v_mfma_f32_32x32x16_bf16 v[64:79], a[132:135], v[196:199], v[64:79]
    ds_read_b64_tr_b16 a[156:157], v233 offset:45056
    s_add_u32 m0, s46, 12288
    s_add_u32 s47, s43, 27648
    buffer_load_dwordx4 v10, s[56:59], s43 offen lds
    v_exp_f32 v215, v39
    v_add_f32 v217, v217, v214
    v_mfma_f32_32x32x16_bf16 a[64:79], a[148:151], v[132:135], a[64:79]
    ds_read_b64_tr_b16 a[158:159], v233 offset:47104
    v_exp_f32 v208, v40
    v_add_f32 v217, v217, v215
    v_cvt_pk_bf16_f32 v123, v214, v215
    v_mfma_f32_32x32x16_bf16 a[80:95], a[148:151], v[140:143], a[80:95]
    buffer_load_dwordx4 v10, s[56:59], s47 offen offset:1024 lds
    s_add_u32 s43, s43, 57344
    v_exp_f32 v209, v41
    v_add_f32 v217, v217, v208
    s_waitcnt lgkmcnt(3)
    v_mfma_f32_32x32x16_bf16 v[48:63], a[136:139], v[168:171], v[48:63]
    ds_read_b64_tr_b16 a[144:145], v230 offset:49152
    v_exp_f32 v210, v42
    v_add_f32 v217, v217, v209
    v_cvt_pk_bf16_f32 v124, v208, v209
    v_mfma_f32_32x32x16_bf16 v[64:79], a[136:139], v[200:203], v[64:79]
    ds_read_b64_tr_b16 a[146:147], v230 offset:51200
    v_exp_f32 v211, v43
    v_add_f32 v217, v217, v210
    v_mfma_f32_32x32x16_bf16 a[96:111], a[152:155], v[128:131], a[96:111]
    v_exp_f32 v212, v44
    v_add_f32 v217, v217, v211
    v_cvt_pk_bf16_f32 v125, v210, v211
    v_mfma_f32_32x32x16_bf16 a[112:127], a[152:155], v[136:139], a[112:127]
    v_exp_f32 v213, v45
    v_add_f32 v217, v217, v212
    s_waitcnt lgkmcnt(2)
    v_mfma_f32_32x32x16_bf16 v[48:63], a[140:143], v[172:175], v[48:63]
    ds_read_b64_tr_b16 a[148:149], v230 offset:53248
    v_exp_f32 v214, v46
    v_add_f32 v217, v217, v213
    v_cvt_pk_bf16_f32 v126, v212, v213
    v_mfma_f32_32x32x16_bf16 v[64:79], a[140:143], v[204:207], v[64:79]
    ds_read_b64_tr_b16 a[150:151], v230 offset:55296
    v_exp_f32 v215, v47
    v_add_f32 v217, v217, v214
    v_mfma_f32_32x32x16_bf16 a[96:111], a[156:159], v[132:135], a[96:111]
    v_add_f32 v217, v217, v215
    v_cvt_pk_bf16_f32 v127, v214, v215
    v_max_f32 v1, v216, v217
    v_cmp_lt_f32 vcc, s49, v1
    v_exp_f32 v208, v48
    v_mfma_f32_32x32x16_bf16 a[112:127], a[156:159], v[140:143], a[112:127]
    v_exp_f32 v209, v49
    s_cbranch_vccnz L_rare_t62
L_back_t62:
    s_waitcnt lgkmcnt(2)
    ds_read_b64_tr_b16 a[152:153], v231 offset:49152
    buffer_load_dwordx4 v[144:147], v11, s[60:63], s44 offen sc1
    buffer_load_dwordx4 v[148:151], v11, s[60:63], s45 offen sc1
    s_add_u32 s44, s44, 1024
    v_exp_f32 v210, v50
    v_add_f32 v218, v208, v209
    v_cvt_pk_bf16_f32 v128, v208, v209
    ds_read_b64_tr_b16 a[154:155], v231 offset:51200
    s_add_u32 s45, s45, 1024
    buffer_load_dwordx4 v[152:155], v11, s[60:63], s44 offen sc1
    buffer_load_dwordx4 v[156:159], v11, s[60:63], s45 offen sc1
    v_exp_f32 v211, v51
    v_add_f32 v218, v218, v210
    v_mfma_f32_32x32x16_bf16 a[0:15], a[144:147], v[112:115], a[0:15]
    v_exp_f32 v212, v52
    v_add_f32 v218, v218, v211
    v_cvt_pk_bf16_f32 v129, v210, v211
    v_mfma_f32_32x32x16_bf16 a[16:31], a[144:147], v[120:123], a[16:31]
    v_exp_f32 v213, v53
    v_add_f32 v218, v218, v212
    v_add_f32 v220, v220, v216
    s_waitcnt lgkmcnt(2)
    ds_read_b64_tr_b16 a[156:157], v231 offset:53248
    s_add_u32 s44, s44, 1024
    s_add_u32 s45, s45, 1024
    buffer_load_dwordx4 v[160:163], v11, s[60:63], s44 offen sc1
    v_exp_f32 v214, v54
    v_add_f32 v218, v218, v213
    v_cvt_pk_bf16_f32 v130, v212, v213
    ds_read_b64_tr_b16 a[158:159], v231 offset:55296
    buffer_load_dwordx4 v[164:167], v11, s[60:63], s45 offen sc1
    s_add_u32 s44, s44, 1024
    s_add_u32 s45, s45, 1024
    v_exp_f32 v215, v55
    v_add_f32 v218, v218, v214
    v_mfma_f32_32x32x16_bf16 a[0:15], a[148:151], v[116:119], a[0:15]
    v_exp_f32 v208, v56
    v_add_f32 v218, v218, v215
    v_cvt_pk_bf16_f32 v131, v214, v215
    v_mfma_f32_32x32x16_bf16 a[16:31], a[148:151], v[124:127], a[16:31]
    v_exp_f32 v209, v57
    v_add_f32 v218, v218, v208
    v_add_f32 v221, v221, v217
    s_waitcnt lgkmcnt(2)
    ds_read_b64_tr_b16 a[144:145], v232 offset:49152
    buffer_load_dwordx4 v[168:171], v11, s[60:63], s44 offen sc1
    buffer_load_dwordx4 v[172:175], v11, s[60:63], s45 offen sc1
    s_add_u32 s44, s44, 1024
    v_exp_f32 v210, v58
    v_add_f32 v218, v218, v209
    v_cvt_pk_bf16_f32 v132, v208, v209
    ds_read_b64_tr_b16 a[146:147], v232 offset:51200
    s_add_u32 s45, s45, 1024
    buffer_load_dwordx4 v[176:179], v11, s[60:63], s44 offen sc1
    buffer_load_dwordx4 v[180:183], v11, s[60:63], s45 offen sc1
    v_exp_f32 v211, v59
    v_add_f32 v218, v218, v210
    v_mfma_f32_32x32x16_bf16 a[32:47], a[152:155], v[112:115], a[32:47]
    v_exp_f32 v212, v60
    v_add_f32 v218, v218, v211
    v_cvt_pk_bf16_f32 v133, v210, v211
    v_mfma_f32_32x32x16_bf16 a[48:63], a[152:155], v[120:123], a[48:63]
    v_exp_f32 v213, v61
    v_add_f32 v218, v218, v212
    s_waitcnt lgkmcnt(2)
    ds_read_b64_tr_b16 a[148:149], v232 offset:53248
    s_add_u32 s44, s44, 1024
    s_add_u32 s45, s45, 1024
    buffer_load_dwordx4 v[184:187], v11, s[60:63], s44 offen sc1
    v_exp_f32 v214, v62
    v_add_f32 v218, v218, v213
    v_cvt_pk_bf16_f32 v134, v212, v213
    ds_read_b64_tr_b16 a[150:151], v232 offset:55296
    buffer_load_dwordx4 v[188:191], v11, s[60:63], s45 offen sc1
    s_add_u32 s44, s44, 1024
    s_add_u32 s45, s45, 1024
    v_exp_f32 v215, v63
    v_add_f32 v218, v218, v214
    v_mfma_f32_32x32x16_bf16 a[32:47], a[156:159], v[116:119], a[32:47]
    v_exp_f32 v208, v64
    v_add_f32 v218, v218, v215
    v_cvt_pk_bf16_f32 v135, v214, v215
    v_mfma_f32_32x32x16_bf16 a[48:63], a[156:159], v[124:127], a[48:63]
    v_exp_f32 v209, v65
    s_waitcnt lgkmcnt(2)
    ds_read_b64_tr_b16 a[152:153], v233 offset:49152
    buffer_load_dwordx4 v[192:195], v11, s[60:63], s44 offen sc1
    buffer_load_dwordx4 v[196:199], v11, s[60:63], s45 offen sc1
    s_add_u32 s44, s44, 1024
    v_exp_f32 v210, v66
    v_add_f32 v219, v208, v209
    v_cvt_pk_bf16_f32 v136, v208, v209
    ds_read_b64_tr_b16 a[154:155], v233 offset:51200
    s_add_u32 s45, s45, 1024
    s_lshr_b32 s3, s42, 1
    s_lshl_b32 s3, s3, 6
    v_exp_f32 v211, v67
    v_add_f32 v219, v219, v210
    v_mfma_f32_32x32x16_bf16 a[64:79], a[144:147], v[112:115], a[64:79]
    v_exp_f32 v212, v68
    v_add_f32 v219, v219, v211
    v_cvt_pk_bf16_f32 v137, v210, v211
    v_mfma_f32_32x32x16_bf16 a[80:95], a[144:147], v[120:123], a[80:95]
    v_exp_f32 v213, v69
    v_add_f32 v219, v219, v212
    s_waitcnt lgkmcnt(2)
    ds_read_b64_tr_b16 a[156:157], v233 offset:53248
    s_lshl_b32 s47, s54, 7
    s_add_u32 s3, s3, s47
    s_mov_b32 s12, s34
    v_exp_f32 v214, v70
    v_add_f32 v219, v219, v213
    v_cvt_pk_bf16_f32 v138, v212, v213
    ds_read_b64_tr_b16 a[158:159], v233 offset:55296
    s_mov_b32 s13, s35
    s_mov_b32 s14, 3584
    s_mov_b32 s15, 0x00020000
    v_exp_f32 v215, v71
    v_add_f32 v219, v219, v214
    v_mfma_f32_32x32x16_bf16 a[64:79], a[148:151], v[116:119], a[64:79]
    v_exp_f32 v208, v72
    v_add_f32 v219, v219, v215
    v_cvt_pk_bf16_f32 v139, v214, v215
    v_mfma_f32_32x32x16_bf16 a[80:95], a[148:151], v[124:127], a[80:95]
    v_exp_f32 v209, v73
    v_add_f32 v219, v219, v208
    s_waitcnt lgkmcnt(2)
    ds_read_b64_tr_b16 a[144:145], v230 offset:57344
    buffer_load_dwordx2 a[176:177], v14, s[12:15], s3 offen offset:0
    buffer_load_dwordx2 a[178:179], v14, s[12:15], s3 offen offset:16
    buffer_load_dwordx2 a[180:181], v14, s[12:15], s3 offen offset:32
    v_exp_f32 v210, v74
    v_add_f32 v219, v219, v209
    v_cvt_pk_bf16_f32 v140, v208, v209
    ds_read_b64_tr_b16 a[146:147], v230 offset:59392
    buffer_load_dwordx2 a[182:183], v14, s[12:15], s3 offen offset:48
    v_exp_f32 v211, v75
    v_add_f32 v219, v219, v210
    v_mfma_f32_32x32x16_bf16 a[96:111], a[152:155], v[112:115], a[96:111]
    v_exp_f32 v212, v76
    v_add_f32 v219, v219, v211
    v_cvt_pk_bf16_f32 v141, v210, v211
    v_mfma_f32_32x32x16_bf16 a[112:127], a[152:155], v[120:123], a[112:127]
    v_exp_f32 v213, v77
    v_add_f32 v219, v219, v212
    s_waitcnt lgkmcnt(2)
    ds_read_b64_tr_b16 a[148:149], v230 offset:61440
    v_exp_f32 v214, v78
    v_add_f32 v219, v219, v213
    v_cvt_pk_bf16_f32 v142, v212, v213
    ds_read_b64_tr_b16 a[150:151], v230 offset:63488
    v_exp_f32 v215, v79
    v_add_f32 v219, v219, v214
    v_mfma_f32_32x32x16_bf16 a[96:111], a[156:159], v[116:119], a[96:111]
    v_add_f32 v219, v219, v215
    v_cvt_pk_bf16_f32 v143, v214, v215
    v_max_f32 v1, v218, v219
    v_cmp_lt_f32 vcc, s49, v1
    v_mfma_f32_32x32x16_bf16 a[112:127], a[156:159], v[124:127], a[112:127]
    s_cbranch_vccnz L_rare_t63
L_back_t63:
    v_add_f32 v220, v220, v218
    v_add_f32 v221, v221, v219
    s_waitcnt lgkmcnt(2)
    v_mfma_f32_32x32x16_bf16 a[0:15], a[144:147], v[128:131], a[0:15]
    ds_read_b64_tr_b16 a[152:153], v231 offset:57344
    ds_read_b64_tr_b16 a[154:155], v231 offset:59392
    v_mfma_f32_32x32x16_bf16 a[16:31], a[144:147], v[136:139], a[16:31]
    s_waitcnt lgkmcnt(2)
    v_mfma_f32_32x32x16_bf16 a[0:15], a[148:151], v[132:135], a[0:15]
    ds_read_b64_tr_b16 a[156:157], v231 offset:61440
    ds_read_b64_tr_b16 a[158:159], v231 offset:63488
    v_mfma_f32_32x32x16_bf16 a[16:31], a[148:151], v[140:143], a[16:31]
    s_waitcnt lgkmcnt(2)
    v_mfma_f32_32x32x16_bf16 a[32:47], a[152:155], v[128:131], a[32:47]
    ds_read_b64_tr_b16 a[144:145], v232 offset:57344
    ds_read_b64_tr_b16 a[146:147], v232 offset:59392
    v_mfma_f32_32x32x16_bf16 a[48:63], a[152:155], v[136:139], a[48:63]
    s_waitcnt lgkmcnt(2)
    v_mfma_f32_32x32x16_bf16 a[32:47], a[156:159], v[132:135], a[32:47]
    ds_read_b64_tr_b16 a[148:149], v232 offset:61440
    ds_read_b64_tr_b16 a[150:151], v232 offset:63488
    v_mfma_f32_32x32x16_bf16 a[48:63], a[156:159], v[140:143], a[48:63]
    s_waitcnt lgkmcnt(2)
    v_mfma_f32_32x32x16_bf16 a[64:79], a[144:147], v[128:131], a[64:79]
    ds_read_b64_tr_b16 a[152:153], v233 offset:57344
    ds_read_b64_tr_b16 a[154:155], v233 offset:59392
    v_mfma_f32_32x32x16_bf16 a[80:95], a[144:147], v[136:139], a[80:95]
    s_waitcnt lgkmcnt(2)
    v_mfma_f32_32x32x16_bf16 a[64:79], a[148:151], v[132:135], a[64:79]
    ds_read_b64_tr_b16 a[156:157], v233 offset:61440
    ds_read_b64_tr_b16 a[158:159], v233 offset:63488
    v_mfma_f32_32x32x16_bf16 a[80:95], a[148:151], v[140:143], a[80:95]
    s_waitcnt lgkmcnt(2)
    v_mfma_f32_32x32x16_bf16 a[96:111], a[152:155], v[128:131], a[96:111]
    v_mfma_f32_32x32x16_bf16 a[112:127], a[152:155], v[136:139], a[112:127]
    s_waitcnt lgkmcnt(0)
    v_mfma_f32_32x32x16_bf16 a[96:111], a[156:159], v[132:135], a[96:111]
    v_mfma_f32_32x32x16_bf16 a[112:127], a[156:159], v[140:143], a[112:127]
    s_waitcnt lgkmcnt(0)
    s_waitcnt lgkmcnt(0)
    s_barrier
    v_mov_b32 v3, v220
    v_mov_b32 v4, v221
    s_nop 1
    v_permlane32_swap_b32 v3, v220
    v_permlane32_swap_b32 v4, v221
    v_add_f32 v220, v220, v3
    v_add_f32 v221, v221, v4
    v_rcp_f32 v60, v220
    v_rcp_f32 v62, v221
    s_lshl_b32 s3, s42, 14
    s_add_u32 s3, s3, 65536
    v_lshlrev_b32 v15, 4, v0
    v_add_u32 v2, s3, v15
    v_add_u32 v244, 65536, v15
    v_mov_b32 v61, v60
    v_mov_b32 v63, v62
    s_cmp_eq_u32 s98, 0
    s_cbranch_scc1 L_no_g1
    s_waitcnt vmcnt(30)
    ds_read_b64_tr_b16 v[128:129], v12 offset:0
    ds_read_b64_tr_b16 v[130:131], v12 offset:512
    ds_read_b64_tr_b16 v[132:133], v13 offset:0
    ds_read_b64_tr_b16 v[134:135], v13 offset:512
    s_waitcnt vmcnt(16) lgkmcnt(0)
    v_mfma_f32_32x32x16_bf16 v[64:79], v[128:131], v[144:147], 0
    ds_read_b64_tr_b16 v[136:137], v12 offset:2048
    ds_read_b64_tr_b16 v[138:139], v12 offset:2560
    v_accvgpr_read_b32 v28, a0
    v_accvgpr_read_b32 v29, a1
    v_accvgpr_read_b32 v30, a2
    v_mfma_f32_32x32x16_bf16 v[80:95], v[128:131], v[148:151], 0
    ds_read_b64_tr_b16 v[140:141], v13 offset:2048
    ds_read_b64_tr_b16 v[142:143], v13 offset:2560
    v_accvgpr_read_b32 v31, a3
    v_accvgpr_read_b32 v32, a4
    v_accvgpr_read_b32 v33, a5
    v_mfma_f32_32x32x16_bf16 v[96:111], v[132:135], v[144:147], 0
    v_accvgpr_read_b32 v34, a6
    v_accvgpr_read_b32 v35, a7
    v_pk_mul_f32 v[28:29], v[28:29], v[60:61]
    v_mfma_f32_32x32x16_bf16 v[112:127], v[132:135], v[148:151], 0
    buffer_load_dwordx4 v[200:203], v11, s[60:63], s44 offen sc1
    buffer_load_dwordx4 v[204:207], v11, s[60:63], s45 offen sc1
    s_add_u32 s44, s44, 1024
    s_add_u32 s45, s45, 1024
    s_add_u32 m0, s46, 14336
    s_add_u32 s47, s43, 27648
    buffer_load_dwordx4 v10, s[56:59], s43 offen lds
    buffer_load_dwordx4 v10, s[56:59], s47 offen offset:1024 lds
    s_add_u32 s43, s43, 57344
    s_waitcnt vmcnt(18) lgkmcnt(0)
    v_mfma_f32_32x32x16_bf16 v[64:79], v[136:139], v[152:155], v[64:79]
    ds_read_b64_tr_b16 v[128:129], v12 offset:4096
    ds_read_b64_tr_b16 v[130:131], v12 offset:4608
    v_pk_mul_f32 v[30:31], v[30:31], v[60:61]
    v_pk_mul_f32 v[32:33], v[32:33], v[60:61]
    v_pk_mul_f32 v[34:35], v[34:35], v[60:61]
    v_mfma_f32_32x32x16_bf16 v[80:95], v[136:139], v[156:159], v[80:95]
    ds_read_b64_tr_b16 v[132:133], v13 offset:4096
    ds_read_b64_tr_b16 v[134:135], v13 offset:4608
    v_cvt_pk_bf16_f32 v36, v28, v29
    v_cvt_pk_bf16_f32 v37, v30, v31
    v_cvt_pk_bf16_f32 v38, v32, v33
    v_mfma_f32_32x32x16_bf16 v[96:111], v[140:143], v[152:155], v[96:111]
    v_cvt_pk_bf16_f32 v39, v34, v35
    ds_write_b128 v2, v[36:39] offset:0
    v_accvgpr_read_b32 v44, a8
    v_mfma_f32_32x32x16_bf16 v[112:127], v[140:143], v[156:159], v[112:127]
    buffer_load_dwordx4 v[144:147], v11, s[60:63], s44 offen sc1
    buffer_load_dwordx4 v[148:151], v11, s[60:63], s45 offen sc1
    s_add_u32 s44, s44, 1024
    s_add_u32 s45, s45, 1024
    s_add_u32 m0, s46, 0
    s_add_u32 s47, s43, 27648
    buffer_load_dwordx4 v10, s[56:59], s43 offen lds
    buffer_load_dwordx4 v10, s[56:59], s47 offen offset:1024 lds
    s_add_u32 s43, s43, 57344
    s_waitcnt vmcnt(20) lgkmcnt(0)
    v_mfma_f32_32x32x16_bf16 v[64:79], v[128:131], v[160:163], v[64:79]
    ds_read_b64_tr_b16 v[136:137], v12 offset:6144
    ds_read_b64_tr_b16 v[138:139], v12 offset:6656
    v_accvgpr_read_b32 v45, a9
    v_accvgpr_read_b32 v46, a10
    v_accvgpr_read_b32 v47, a11
    v_mfma_f32_32x32x16_bf16 v[80:95], v[128:131], v[164:167], v[80:95]
    ds_read_b64_tr_b16 v[140:141], v13 offset:6144
    ds_read_b64_tr_b16 v[142:143], v13 offset:6656
    v_accvgpr_read_b32 v48, a12
    v_accvgpr_read_b32 v49, a13
    v_accvgpr_read_b32 v50, a14
    v_mfma_f32_32x32x16_bf16 v[96:111], v[132:135], v[160:163], v[96:111]
    v_accvgpr_read_b32 v51, a15
    v_pk_mul_f32 v[44:45], v[44:45], v[60:61]
    v_pk_mul_f32 v[46:47], v[46:47], v[60:61]
    v_mfma_f32_32x32x16_bf16 v[112:127], v[132:135], v[164:167], v[112:127]
    buffer_load_dwordx4 v[152:155], v11, s[60:63], s44 offen sc1
    buffer_load_dwordx4 v[156:159], v11, s[60:63], s45 offen sc1
    s_add_u32 s44, s44, 1024
    s_add_u32 s45, s45, 1024
    s_add_u32 m0, s46, 2048
    s_add_u32 s47, s43, 27648
    buffer_load_dwordx4 v10, s[56:59], s43 offen lds
    buffer_load_dwordx4 v10, s[56:59], s47 offen offset:1024 lds
    s_add_u32 s43, s43, 57344
    s_waitcnt vmcnt(22) lgkmcnt(0)
    v_mfma_f32_32x32x16_bf16 v[64:79], v[136:139], v[168:171], v[64:79]
    ds_read_b64_tr_b16 v[128:129], v12 offset:8192
    ds_read_b64_tr_b16 v[130:131], v12 offset:8704
    v_pk_mul_f32 v[48:49], v[48:49], v[60:61]
    v_pk_mul_f32 v[50:51], v[50:51], v[60:61]
    v_cvt_pk_bf16_f32 v52, v44, v45
    v_mfma_f32_32x32x16_bf16 v[80:95], v[136:139], v[172:175], v[80:95]
    ds_read_b64_tr_b16 v[132:133], v13 offset:8192
    ds_read_b64_tr_b16 v[134:135], v13 offset:8704
    v_cvt_pk_bf16_f32 v53, v46, v47
    v_cvt_pk_bf16_f32 v54, v48, v49
    v_cvt_pk_bf16_f32 v55, v50, v51
    v_mfma_f32_32x32x16_bf16 v[96:111], v[140:143], v[168:171], v[96:111]
    ds_write_b128 v2, v[52:55] offset:2048
    v_accvgpr_read_b32 v28, a16
    v_accvgpr_read_b32 v29, a17
    v_mfma_f32_32x32x16_bf16 v[112:127], v[140:143], v[172:175], v[112:127]
    buffer_load_dwordx4 v[160:163], v11, s[60:63], s44 offen sc1
    buffer_load_dwordx4 v[164:167], v11, s[60:63], s45 offen sc1
    s_add_u32 s44, s44, 1024
    s_add_u32 s45, s45, 1024
    s_add_u32 m0, s46, 4096
    s_add_u32 s47, s43, 27648
    buffer_load_dwordx4 v10, s[56:59], s43 offen lds
    buffer_load_dwordx4 v10, s[56:59], s47 offen offset:1024 lds
    s_add_u32 s43, s43, 57344
    s_waitcnt vmcnt(24) lgkmcnt(0)
    v_mfma_f32_32x32x16_bf16 v[64:79], v[128:131], v[176:179], v[64:79]
    ds_read_b64_tr_b16 v[136:137], v12 offset:10240
    ds_read_b64_tr_b16 v[138:139], v12 offset:10752
    v_accvgpr_read_b32 v30, a18
    v_accvgpr_read_b32 v31, a19
    v_accvgpr_read_b32 v32, a20
    v_mfma_f32_32x32x16_bf16 v[80:95], v[128:131], v[180:183], v[80:95]
    ds_read_b64_tr_b16 v[140:141], v13 offset:10240
    ds_read_b64_tr_b16 v[142:143], v13 offset:10752
    v_accvgpr_read_b32 v33, a21
    v_accvgpr_read_b32 v34, a22
    v_accvgpr_read_b32 v35, a23
    v_mfma_f32_32x32x16_bf16 v[96:111], v[132:135], v[176:179], v[96:111]
    v_pk_mul_f32 v[28:29], v[28:29], v[62:63]
    v_pk_mul_f32 v[30:31], v[30:31], v[62:63]
    v_pk_mul_f32 v[32:33], v[32:33], v[62:63]
    v_mfma_f32_32x32x16_bf16 v[112:127], v[132:135], v[180:183], v[112:127]
    buffer_load_dwordx4 v[168:171], v11, s[60:63], s44 offen sc1
    buffer_load_dwordx4 v[172:175], v11, s[60:63], s45 offen sc1
    s_add_u32 s44, s44, 1024
    s_add_u32 s45, s45, 1024
    s_add_u32 m0, s46, 6144
    s_add_u32 s47, s43, 27648
    buffer_load_dwordx4 v10, s[56:59], s43 offen lds
    buffer_load_dwordx4 v10, s[56:59], s47 offen offset:1024 lds
    s_add_u32 s43, s43, 57344
    s_waitcnt vmcnt(26) lgkmcnt(0)
    v_mfma_f32_32x32x16_bf16 v[64:79], v[136:139], v[184:187], v[64:79]
    ds_read_b64_tr_b16 v[128:129], v12 offset:12288
    ds_read_b64_tr_b16 v[130:131], v12 offset:12800
    v_pk_mul_f32 v[34:35], v[34:35], v[62:63]
    v_cvt_pk_bf16_f32 v36, v28, v29
    v_cvt_pk_bf16_f32 v37, v30, v31
    v_mfma_f32_32x32x16_bf16 v[80:95], v[136:139], v[188:191], v[80:95]
    ds_read_b64_tr_b16 v[132:133], v13 offset:12288
    ds_read_b64_tr_b16 v[134:135], v13 offset:12800
    v_cvt_pk_bf16_f32 v38, v32, v33
    v_cvt_pk_bf16_f32 v39, v34, v35
    ds_write_b128 v2, v[36:39] offset:1024
    v_mfma_f32_32x32x16_bf16 v[96:111], v[140:143], v[184:187], v[96:111]
    v_accvgpr_read_b32 v44, a24
    v_accvgpr_read_b32 v45, a25
    v_accvgpr_read_b32 v46, a26
    v_mfma_f32_32x32x16_bf16 v[112:127], v[140:143], v[188:191], v[112:127]
    buffer_load_dwordx4 v[176:179], v11, s[60:63], s44 offen sc1
    buffer_load_dwordx4 v[180:183], v11, s[60:63], s45 offen sc1
    s_add_u32 s44, s44, 1024
    s_add_u32 s45, s45, 1024
    s_add_u32 m0, s46, 8192
    s_add_u32 s47, s43, 27648
    buffer_load_dwordx4 v10, s[56:59], s43 offen lds
    buffer_load_dwordx4 v10, s[56:59], s47 offen offset:1024 lds
    s_add_u32 s43, s43, 57344
    s_waitcnt vmcnt(20) lgkmcnt(0)
    v_mfma_f32_32x32x16_bf16 v[64:79], v[128:131], v[192:195], v[64:79]
    ds_read_b64_tr_b16 v[136:137], v12 offset:14336
    ds_read_b64_tr_b16 v[138:139], v12 offset:14848
    v_accvgpr_read_b32 v47, a27
    v_accvgpr_read_b32 v48, a28
    v_accvgpr_read_b32 v49, a29
    v_mfma_f32_32x32x16_bf16 v[80:95], v[128:131], v[196:199], v[80:95]
    ds_read_b64_tr_b16 v[140:141], v13 offset:14336
    ds_read_b64_tr_b16 v[142:143], v13 offset:14848
    v_accvgpr_read_b32 v50, a30
    v_accvgpr_read_b32 v51, a31
    v_pk_mul_f32 v[44:45], v[44:45], v[62:63]
    v_mfma_f32_32x32x16_bf16 v[96:111], v[132:135], v[192:195], v[96:111]
    v_pk_mul_f32 v[46:47], v[46:47], v[62:63]
    v_pk_mul_f32 v[48:49], v[48:49], v[62:63]
    v_pk_mul_f32 v[50:51], v[50:51], v[62:63]
    v_mfma_f32_32x32x16_bf16 v[112:127], v[132:135], v[196:199], v[112:127]
    buffer_load_dwordx4 v[184:187], v11, s[60:63], s44 offen sc1
    buffer_load_dwordx4 v[188:191], v11, s[60:63], s45 offen sc1
    s_add_u32 s44, s44, 1024
    s_add_u32 s45, s45, 1024
    s_add_u32 m0, s46, 10240
    s_add_u32 s47, s43, 27648
    buffer_load_dwordx4 v10, s[56:59], s43 offen lds
    buffer_load_dwordx4 v10, s[56:59], s47 offen offset:1024 lds
    s_add_u32 s43, s43, 57344
    s_waitcnt vmcnt(20) lgkmcnt(0)
    v_mfma_f32_32x32x16_bf16 v[64:79], v[136:139], v[200:203], v[64:79]
    ds_read_b64_tr_b16 v[128:129], v12 offset:0
    ds_read_b64_tr_b16 v[130:131], v12 offset:512
    v_cvt_pk_bf16_f32 v52, v44, v45
    v_cvt_pk_bf16_f32 v53, v46, v47
    v_cvt_pk_bf16_f32 v54, v48, v49
    v_mfma_f32_32x32x16_bf16 v[80:95], v[136:139], v[204:207], v[80:95]
    ds_read_b64_tr_b16 v[132:133], v13 offset:0
    ds_read_b64_tr_b16 v[134:135], v13 offset:512
    v_cvt_pk_bf16_f32 v55, v50, v51
    ds_write_b128 v2, v[52:55] offset:3072
    v_accvgpr_read_b32 v28, a32
    v_mfma_f32_32x32x16_bf16 v[96:111], v[140:143], v[200:203], v[96:111]
    v_accvgpr_read_b32 v29, a33
    v_accvgpr_read_b32 v30, a34
    v_accvgpr_read_b32 v31, a35
    v_mfma_f32_32x32x16_bf16 v[112:127], v[140:143], v[204:207], v[112:127]
    buffer_load_dwordx4 v[192:195], v11, s[60:63], s44 offen sc1
    buffer_load_dwordx4 v[196:199], v11, s[60:63], s45 offen sc1
    s_add_u32 s44, s44, 1024
    s_add_u32 s45, s45, 1024
    s_add_u32 m0, s46, 12288
    s_add_u32 s47, s43, 27648
    buffer_load_dwordx4 v10, s[56:59], s43 offen lds
    buffer_load_dwordx4 v10, s[56:59], s47 offen offset:1024 lds
    s_add_u32 s43, s43, 57344
    s_waitcnt vmcnt(20) lgkmcnt(0)
    v_mfma_f32_32x32x16_bf16 v[64:79], v[128:131], v[144:147], v[64:79]
    ds_read_b64_tr_b16 v[136:137], v12 offset:2048
    ds_read_b64_tr_b16 v[138:139], v12 offset:2560
    v_accvgpr_read_b32 v32, a36
    v_accvgpr_read_b32 v33, a37
    v_accvgpr_read_b32 v34, a38
    v_mfma_f32_32x32x16_bf16 v[80:95], v[128:131], v[148:151], v[80:95]
    ds_read_b64_tr_b16 v[140:141], v13 offset:2048
    ds_read_b64_tr_b16 v[142:143], v13 offset:2560
    v_accvgpr_read_b32 v35, a39
    v_pk_mul_f32 v[28:29], v[28:29], v[60:61]
    v_pk_mul_f32 v[30:31], v[30:31], v[60:61]
    v_mfma_f32_32x32x16_bf16 v[96:111], v[132:135], v[144:147], v[96:111]
    v_pk_mul_f32 v[32:33], v[32:33], v[60:61]
    v_pk_mul_f32 v[34:35], v[34:35], v[60:61]
    v_cvt_pk_bf16_f32 v36, v28, v29
    v_mfma_f32_32x32x16_bf16 v[112:127], v[132:135], v[148:151], v[112:127]
    buffer_load_dwordx4 v[200:203], v11, s[60:63], s44 offen sc1
    buffer_load_dwordx4 v[204:207], v11, s[60:63], s45 offen sc1
    s_add_u32 s44, s44, 1024
    s_add_u32 s45, s45, 1024
    s_add_u32 m0, s46, 14336
    s_add_u32 s47, s43, 27648
    buffer_load_dwordx4 v10, s[56:59], s43 offen lds
    buffer_load_dwordx4 v10, s[56:59], s47 offen offset:1024 lds
    s_add_u32 s43, s43, 57344
    s_waitcnt vmcnt(20) lgkmcnt(0)
    v_mfma_f32_32x32x16_bf16 v[64:79], v[136:139], v[152:155], v[64:79]
    ds_read_b64_tr_b16 v[128:129], v12 offset:4096
    ds_read_b64_tr_b16 v[130:131], v12 offset:4608
    v_cvt_pk_bf16_f32 v37, v30, v31
    v_cvt_pk_bf16_f32 v38, v32, v33
    v_cvt_pk_bf16_f32 v39, v34, v35
    v_mfma_f32_32x32x16_bf16 v[80:95], v[136:139], v[156:159], v[80:95]
    ds_read_b64_tr_b16 v[132:133], v13 offset:4096
    ds_read_b64_tr_b16 v[134:135], v13 offset:4608
    ds_write_b128 v2, v[36:39] offset:4096
    v_accvgpr_read_b32 v44, a40
    v_accvgpr_read_b32 v45, a41
    v_mfma_f32_32x32x16_bf16 v[96:111], v[140:143], v[152:155], v[96:111]
    v_accvgpr_read_b32 v46, a42
    v_accvgpr_read_b32 v47, a43
    v_accvgpr_read_b32 v48, a44
    v_mfma_f32_32x32x16_bf16 v[112:127], v[140:143], v[156:159], v[112:127]
    buffer_load_dwordx4 v[144:147], v11, s[60:63], s44 offen sc1
    buffer_load_dwordx4 v[148:151], v11, s[60:63], s45 offen sc1
    s_add_u32 s44, s44, 1024
    s_add_u32 s45, s45, 1024
    s_add_u32 m0, s46, 0
    s_add_u32 s47, s43, 27648
    buffer_load_dwordx4 v10, s[56:59], s43 offen lds
    buffer_load_dwordx4 v10, s[56:59], s47 offen offset:1024 lds
    s_add_u32 s43, s43, 57344
    s_waitcnt vmcnt(20) lgkmcnt(0)
    v_mfma_f32_32x32x16_bf16 v[64:79], v[128:131], v[160:163], v[64:79]
    ds_read_b64_tr_b16 v[136:137], v12 offset:6144
    ds_read_b64_tr_b16 v[138:139], v12 offset:6656
    v_accvgpr_read_b32 v49, a45
    v_accvgpr_read_b32 v50, a46
    v_accvgpr_read_b32 v51, a47
    v_mfma_f32_32x32x16_bf16 v[80:95], v[128:131], v[164:167], v[80:95]
    ds_read_b64_tr_b16 v[140:141], v13 offset:6144
    ds_read_b64_tr_b16 v[142:143], v13 offset:6656
    v_pk_mul_f32 v[44:45], v[44:45], v[60:61]
    v_pk_mul_f32 v[46:47], v[46:47], v[60:61]
    v_pk_mul_f32 v[48:49], v[48:49], v[60:61]
    v_mfma_f32_32x32x16_bf16 v[96:111], v[132:135], v[160:163], v[96:111]
    v_pk_mul_f32 v[50:51], v[50:51], v[60:61]
    v_cvt_pk_bf16_f32 v52, v44, v45
    v_cvt_pk_bf16_f32 v53, v46, v47
    v_mfma_f32_32x32x16_bf16 v[112:127], v[132:135], v[164:167], v[112:127]
    buffer_load_dwordx4 v[152:155], v11, s[60:63], s44 offen sc1
    buffer_load_dwordx4 v[156:159], v11, s[60:63], s45 offen sc1
    s_add_u32 s44, s44, 1024
    s_add_u32 s45, s45, 1024
    s_add_u32 m0, s46, 2048
    s_add_u32 s47, s43, 27648
    buffer_load_dwordx4 v10, s[56:59], s43 offen lds
    buffer_load_dwordx4 v10, s[56:59], s47 offen offset:1024 lds
    s_add_u32 s43, s43, 57344
    s_waitcnt vmcnt(20) lgkmcnt(0)
    v_mfma_f32_32x32x16_bf16 v[64:79], v[136:139], v[168:171], v[64:79]
    ds_read_b64_tr_b16 v[128:129], v12 offset:8192
    ds_read_b64_tr_b16 v[130:131], v12 offset:8704
    v_cvt_pk_bf16_f32 v54, v48, v49
    v_cvt_pk_bf16_f32 v55, v50, v51
    ds_write_b128 v2, v[52:55] offset:6144
    v_mfma_f32_32x32x16_bf16 v[80:95], v[136:139], v[172:175], v[80:95]
    ds_read_b64_tr_b16 v[132:133], v13 offset:8192
    ds_read_b64_tr_b16 v[134:135], v13 offset:8704
    v_accvgpr_read_b32 v28, a48
    v_accvgpr_read_b32 v29, a49
    v_accvgpr_read_b32 v30, a50
    v_mfma_f32_32x32x16_bf16 v[96:111], v[140:143], v[168:171], v[96:111]
    v_accvgpr_read_b32 v31, a51
    v_accvgpr_read_b32 v32, a52
    v_accvgpr_read_b32 v33, a53
    v_mfma_f32_32x32x16_bf16 v[112:127], v[140:143], v[172:175], v[112:127]
    buffer_load_dwordx4 v[160:163], v11, s[60:63], s44 offen sc1
    buffer_load_dwordx4 v[164:167], v11, s[60:63], s45 offen sc1
    s_add_u32 s44, s44, 1024
    s_add_u32 s45, s45, 1024
    s_add_u32 m0, s46, 4096
    s_add_u32 s47, s43, 27648
    buffer_load_dwordx4 v10, s[56:59], s43 offen lds
    buffer_load_dwordx4 v10, s[56:59], s47 offen offset:1024 lds
    s_add_u32 s43, s43, 57344
    s_waitcnt vmcnt(20) lgkmcnt(0)
    v_mfma_f32_32x32x16_bf16 v[64:79], v[128:131], v[176:179], v[64:79]
    ds_read_b64_tr_b16 v[136:137], v12 offset:10240
    ds_read_b64_tr_b16 v[138:139], v12 offset:10752
    v_accvgpr_read_b32 v34, a54
    v_accvgpr_read_b32 v35, a55
    v_pk_mul_f32 v[28:29], v[28:29], v[62:63]
    v_mfma_f32_32x32x16_bf16 v[80:95], v[128:131], v[180:183], v[80:95]
    ds_read_b64_tr_b16 v[140:141], v13 offset:10240
    ds_read_b64_tr_b16 v[142:143], v13 offset:10752
    v_pk_mul_f32 v[30:31], v[30:31], v[62:63]
    v_pk_mul_f32 v[32:33], v[32:33], v[62:63]
    v_pk_mul_f32 v[34:35], v[34:35], v[62:63]
    v_mfma_f32_32x32x16_bf16 v[96:111], v[132:135], v[176:179], v[96:111]
    v_cvt_pk_bf16_f32 v36, v28, v29
    v_cvt_pk_bf16_f32 v37, v30, v31
    v_cvt_pk_bf16_f32 v38, v32, v33
    v_mfma_f32_32x32x16_bf16 v[112:127], v[132:135], v[180:183], v[112:127]
    buffer_load_dwordx4 v[168:171], v11, s[60:63], s44 offen sc1
    buffer_load_dwordx4 v[172:175], v11, s[60:63], s45 offen sc1
    s_add_u32 s44, s44, 1024
    s_add_u32 s45, s45, 1024
    s_add_u32 m0, s46, 6144
    s_add_u32 s47, s43, 27648
    buffer_load_dwordx4 v10, s[56:59], s43 offen lds
    buffer_load_dwordx4 v10, s[56:59], s47 offen offset:1024 lds
    s_add_u32 s43, s43, 57344
    s_waitcnt vmcnt(20) lgkmcnt(0)
    v_mfma_f32_32x32x16_bf16 v[64:79], v[136:139], v[184:187], v[64:79]
    ds_read_b64_tr_b16 v[128:129], v12 offset:12288
    ds_read_b64_tr_b16 v[130:131], v12 offset:12800
    v_cvt_pk_bf16_f32 v39, v34, v35
    ds_write_b128 v2, v[36:39] offset:5120
    v_accvgpr_read_b32 v44, a56
    v_mfma_f32_32x32x16_bf16 v[80:95], v[136:139], v[188:191], v[80:95]
    ds_read_b64_tr_b16 v[132:133], v13 offset:12288
    ds_read_b64_tr_b16 v[134:135], v13 offset:12800
    v_accvgpr_read_b32 v45, a57
    v_accvgpr_read_b32 v46, a58
    v_accvgpr_read_b32 v47, a59
    v_mfma_f32_32x32x16_bf16 v[96:111], v[140:143], v[184:187], v[96:111]
    v_accvgpr_read_b32 v48, a60
    v_accvgpr_read_b32 v49, a61
    v_accvgpr_read_b32 v50, a62
    v_mfma_f32_32x32x16_bf16 v[112:127], v[140:143], v[188:191], v[112:127]
    buffer_load_dwordx4 v[176:179], v11, s[60:63], s44 offen sc1
    buffer_load_dwordx4 v[180:183], v11, s[60:63], s45 offen sc1
    s_add_u32 s44, s44, 1024
    s_add_u32 s45, s45, 1024
    s_add_u32 m0, s46, 8192
    s_add_u32 s47, s43, 27648
    buffer_load_dwordx4 v10, s[56:59], s43 offen lds
    buffer_load_dwordx4 v10, s[56:59], s47 offen offset:1024 lds
    s_add_u32 s43, s43, 57344
    s_waitcnt vmcnt(20) lgkmcnt(0)
    v_mfma_f32_32x32x16_bf16 v[64:79], v[128:131], v[192:195], v[64:79]
    ds_read_b64_tr_b16 v[136:137], v12 offset:14336
    ds_read_b64_tr_b16 v[138:139], v12 offset:14848
    v_accvgpr_read_b32 v51, a63
    v_pk_mul_f32 v[44:45], v[44:45], v[62:63]
    v_pk_mul_f32 v[46:47], v[46:47], v[62:63]
    v_mfma_f32_32x32x16_bf16 v[80:95], v[128:131], v[196:199], v[80:95]
    ds_read_b64_tr_b16 v[140:141], v13 offset:14336
    ds_read_b64_tr_b16 v[142:143], v13 offset:14848
    v_pk_mul_f32 v[48:49], v[48:49], v[62:63]
    v_pk_mul_f32 v[50:51], v[50:51], v[62:63]
    v_cvt_pk_bf16_f32 v52, v44, v45
    v_mfma_f32_32x32x16_bf16 v[96:111], v[132:135], v[192:195], v[96:111]
    v_cvt_pk_bf16_f32 v53, v46, v47
    v_cvt_pk_bf16_f32 v54, v48, v49
    v_cvt_pk_bf16_f32 v55, v50, v51
    v_mfma_f32_32x32x16_bf16 v[112:127], v[132:135], v[196:199], v[112:127]
    buffer_load_dwordx4 v[184:187], v11, s[60:63], s44 offen sc1
    buffer_load_dwordx4 v[188:191], v11, s[60:63], s45 offen sc1
    s_add_u32 s44, s44, 1024
    s_add_u32 s45, s45, 1024
    s_add_u32 m0, s46, 10240
    s_add_u32 s47, s43, 27648
    buffer_load_dwordx4 v10, s[56:59], s43 offen lds
    buffer_load_dwordx4 v10, s[56:59], s47 offen offset:1024 lds
    s_add_u32 s43, s43, 57344
    s_waitcnt vmcnt(20) lgkmcnt(0)
    v_mfma_f32_32x32x16_bf16 v[64:79], v[136:139], v[200:203], v[64:79]
    ds_read_b64_tr_b16 v[128:129], v12 offset:0
    ds_read_b64_tr_b16 v[130:131], v12 offset:512
    ds_write_b128 v2, v[52:55] offset:7168
    v_accvgpr_read_b32 v28, a64
    v_accvgpr_read_b32 v29, a65
    v_mfma_f32_32x32x16_bf16 v[80:95], v[136:139], v[204:207], v[80:95]
    ds_read_b64_tr_b16 v[132:133], v13 offset:0
    ds_read_b64_tr_b16 v[134:135], v13 offset:512
    v_accvgpr_read_b32 v30, a66
    v_accvgpr_read_b32 v31, a67
    v_accvgpr_read_b32 v32, a68
    v_mfma_f32_32x32x16_bf16 v[96:111], v[140:143], v[200:203], v[96:111]
    v_accvgpr_read_b32 v33, a69
    v_accvgpr_read_b32 v34, a70
    v_accvgpr_read_b32 v35, a71
    v_mfma_f32_32x32x16_bf16 v[112:127], v[140:143], v[204:207], v[112:127]
    buffer_load_dwordx4 v[192:195], v11, s[60:63], s44 offen sc1
    buffer_load_dwordx4 v[196:199], v11, s[60:63], s45 offen sc1
    s_add_u32 s44, s44, 1024
    s_add_u32 s45, s45, 1024
    s_add_u32 m0, s46, 12288
    s_add_u32 s47, s43, 27648
    buffer_load_dwordx4 v10, s[56:59], s43 offen lds
    buffer_load_dwordx4 v10, s[56:59], s47 offen offset:1024 lds
    s_add_u32 s43, s43, 57344
    s_waitcnt vmcnt(20) lgkmcnt(0)
    v_mfma_f32_32x32x16_bf16 v[64:79], v[128:131], v[144:147], v[64:79]
    ds_read_b64_tr_b16 v[136:137], v12 offset:2048
    ds_read_b64_tr_b16 v[138:139], v12 offset:2560
    v_pk_mul_f32 v[28:29], v[28:29], v[60:61]
    v_pk_mul_f32 v[30:31], v[30:31], v[60:61]
    v_pk_mul_f32 v[32:33], v[32:33], v[60:61]
    v_mfma_f32_32x32x16_bf16 v[80:95], v[128:131], v[148:151], v[80:95]
    ds_read_b64_tr_b16 v[140:141], v13 offset:2048
    ds_read_b64_tr_b16 v[142:143], v13 offset:2560
    v_pk_mul_f32 v[34:35], v[34:35], v[60:61]
    v_cvt_pk_bf16_f32 v36, v28, v29
    v_cvt_pk_bf16_f32 v37, v30, v31
    v_mfma_f32_32x32x16_bf16 v[96:111], v[132:135], v[144:147], v[96:111]
    v_cvt_pk_bf16_f32 v38, v32, v33
    v_cvt_pk_bf16_f32 v39, v34, v35
    ds_write_b128 v2, v[36:39] offset:8192
    v_mfma_f32_32x32x16_bf16 v[112:127], v[132:135], v[148:151], v[112:127]
    buffer_load_dwordx4 v[200:203], v11, s[60:63], s44 offen sc1
    buffer_load_dwordx4 v[204:207], v11, s[60:63], s45 offen sc1
    s_add_u32 s44, s44, 1024
    s_add_u32 s45, s45, 1024
    s_add_u32 m0, s46, 14336
    s_add_u32 s47, s43, 27648
    buffer_load_dwordx4 v10, s[56:59], s43 offen lds
    buffer_load_dwordx4 v10, s[56:59], s47 offen offset:1024 lds
    s_add_u32 s43, s43, 57344
    s_waitcnt vmcnt(20) lgkmcnt(0)
    v_mfma_f32_32x32x16_bf16 v[64:79], v[136:139], v[152:155], v[64:79]
    ds_read_b64_tr_b16 v[128:129], v12 offset:4096
    ds_read_b64_tr_b16 v[130:131], v12 offset:4608
    v_accvgpr_read_b32 v44, a72
    v_accvgpr_read_b32 v45, a73
    v_accvgpr_read_b32 v46, a74
    v_mfma_f32_32x32x16_bf16 v[80:95], v[136:139], v[156:159], v[80:95]
    ds_read_b64_tr_b16 v[132:133], v13 offset:4096
    ds_read_b64_tr_b16 v[134:135], v13 offset:4608
    v_accvgpr_read_b32 v47, a75
    v_accvgpr_read_b32 v48, a76
    v_accvgpr_read_b32 v49, a77
    v_mfma_f32_32x32x16_bf16 v[96:111], v[140:143], v[152:155], v[96:111]
    v_accvgpr_read_b32 v50, a78
    v_accvgpr_read_b32 v51, a79
    v_pk_mul_f32 v[44:45], v[44:45], v[60:61]
    v_mfma_f32_32x32x16_bf16 v[112:127], v[140:143], v[156:159], v[112:127]
    buffer_load_dwordx4 v[144:147], v11, s[60:63], s44 offen sc1
    buffer_load_dwordx4 v[148:151], v11, s[60:63], s45 offen sc1
    s_add_u32 s44, s44, 1024
    s_add_u32 s45, s45, 1024
    s_add_u32 m0, s46, 0
    s_add_u32 s47, s43, 27648
    buffer_load_dwordx4 v10, s[56:59], s43 offen lds
    buffer_load_dwordx4 v10, s[56:59], s47 offen offset:1024 lds
    s_add_u32 s43, s43, 57344
    s_waitcnt vmcnt(20) lgkmcnt(0)
    v_mfma_f32_32x32x16_bf16 v[64:79], v[128:131], v[160:163], v[64:79]
    ds_read_b64_tr_b16 v[136:137], v12 offset:6144
    ds_read_b64_tr_b16 v[138:139], v12 offset:6656
    v_pk_mul_f32 v[46:47], v[46:47], v[60:61]
    v_pk_mul_f32 v[48:49], v[48:49], v[60:61]
    v_pk_mul_f32 v[50:51], v[50:51], v[60:61]
    v_mfma_f32_32x32x16_bf16 v[80:95], v[128:131], v[164:167], v[80:95]
    ds_read_b64_tr_b16 v[140:141], v13 offset:6144
    ds_read_b64_tr_b16 v[142:143], v13 offset:6656
    v_cvt_pk_bf16_f32 v52, v44, v45
    v_cvt_pk_bf16_f32 v53, v46, v47
    v_cvt_pk_bf16_f32 v54, v48, v49
    v_mfma_f32_32x32x16_bf16 v[96:111], v[132:135], v[160:163], v[96:111]
    v_cvt_pk_bf16_f32 v55, v50, v51
    ds_write_b128 v2, v[52:55] offset:10240
    v_accvgpr_read_b32 v28, a80
    v_mfma_f32_32x32x16_bf16 v[112:127], v[132:135], v[164:167], v[112:127]
    buffer_load_dwordx4 v[152:155], v11, s[60:63], s44 offen sc1
    buffer_load_dwordx4 v[156:159], v11, s[60:63], s45 offen sc1
    s_add_u32 s44, s44, 1024
    s_add_u32 s45, s45, 1024
    s_add_u32 m0, s46, 2048
    s_add_u32 s47, s43, 27648
    buffer_load_dwordx4 v10, s[56:59], s43 offen lds
    buffer_load_dwordx4 v10, s[56:59], s47 offen offset:1024 lds
    s_add_u32 s43, s43, 57344
    s_waitcnt vmcnt(20) lgkmcnt(0)
    v_mfma_f32_32x32x16_bf16 v[64:79], v[136:139], v[168:171], v[64:79]
    ds_read_b64_tr_b16 v[128:129], v12 offset:8192
    ds_read_b64_tr_b16 v[130:131], v12 offset:8704
    v_accvgpr_read_b32 v29, a81
    v_accvgpr_read_b32 v30, a82
    v_accvgpr_read_b32 v31, a83
    v_mfma_f32_32x32x16_bf16 v[80:95], v[136:139], v[172:175], v[80:95]
    ds_read_b64_tr_b16 v[132:133], v13 offset:8192
    ds_read_b64_tr_b16 v[134:135], v13 offset:8704
    v_accvgpr_read_b32 v32, a84
    v_accvgpr_read_b32 v33, a85
    v_accvgpr_read_b32 v34, a86
    v_mfma_f32_32x32x16_bf16 v[96:111], v[140:143], v[168:171], v[96:111]
    v_accvgpr_read_b32 v35, a87
    v_pk_mul_f32 v[28:29], v[28:29], v[62:63]
    v_pk_mul_f32 v[30:31], v[30:31], v[62:63]
    v_mfma_f32_32x32x16_bf16 v[112:127], v[140:143], v[172:175], v[112:127]
    buffer_load_dwordx4 v[160:163], v11, s[60:63], s44 offen sc1
    buffer_load_dwordx4 v[164:167], v11, s[60:63], s45 offen sc1
    s_add_u32 s44, s44, 1024
    s_add_u32 s45, s45, 1024
    s_add_u32 m0, s46, 4096
    s_add_u32 s47, s43, 27648
    buffer_load_dwordx4 v10, s[56:59], s43 offen lds
    buffer_load_dwordx4 v10, s[56:59], s47 offen offset:1024 lds
    s_add_u32 s43, s43, 57344
    s_waitcnt vmcnt(20) lgkmcnt(0)
    v_mfma_f32_32x32x16_bf16 v[64:79], v[128:131], v[176:179], v[64:79]
    ds_read_b64_tr_b16 v[136:137], v12 offset:10240
    ds_read_b64_tr_b16 v[138:139], v12 offset:10752
    v_pk_mul_f32 v[32:33], v[32:33], v[62:63]
    v_pk_mul_f32 v[34:35], v[34:35], v[62:63]
    v_cvt_pk_bf16_f32 v36, v28, v29
    v_mfma_f32_32x32x16_bf16 v[80:95], v[128:131], v[180:183], v[80:95]
    ds_read_b64_tr_b16 v[140:141], v13 offset:10240
    ds_read_b64_tr_b16 v[142:143], v13 offset:10752
    v_cvt_pk_bf16_f32 v37, v30, v31
    v_cvt_pk_bf16_f32 v38, v32, v33
    v_cvt_pk_bf16_f32 v39, v34, v35
    v_mfma_f32_32x32x16_bf16 v[96:111], v[132:135], v[176:179], v[96:111]
    ds_write_b128 v2, v[36:39] offset:9216
    v_accvgpr_read_b32 v44, a88
    v_accvgpr_read_b32 v45, a89
    v_mfma_f32_32x32x16_bf16 v[112:127], v[132:135], v[180:183], v[112:127]
    buffer_load_dwordx4 v[168:171], v11, s[60:63], s44 offen sc1
    buffer_load_dwordx4 v[172:175], v11, s[60:63], s45 offen sc1
    s_add_u32 s44, s44, 1024
    s_add_u32 s45, s45, 1024
    s_add_u32 m0, s46, 6144
    s_add_u32 s47, s43, 27648
    buffer_load_dwordx4 v10, s[56:59], s43 offen lds
    buffer_load_dwordx4 v10, s[56:59], s47 offen offset:1024 lds
    s_add_u32 s43, s43, 57344
    s_waitcnt vmcnt(20) lgkmcnt(0)
    v_mfma_f32_32x32x16_bf16 v[64:79], v[136:139], v[184:187], v[64:79]
    ds_read_b64_tr_b16 v[128:129], v12 offset:12288
    ds_read_b64_tr_b16 v[130:131], v12 offset:12800
    v_accvgpr_read_b32 v46, a90
    v_accvgpr_read_b32 v47, a91
    v_accvgpr_read_b32 v48, a92
    v_mfma_f32_32x32x16_bf16 v[80:95], v[136:139], v[188:191], v[80:95]
    ds_read_b64_tr_b16 v[132:133], v13 offset:12288
    ds_read_b64_tr_b16 v[134:135], v13 offset:12800
    v_accvgpr_read_b32 v49, a93
    v_accvgpr_read_b32 v50, a94
    v_accvgpr_read_b32 v51, a95
    v_mfma_f32_32x32x16_bf16 v[96:111], v[140:143], v[184:187], v[96:111]
    v_pk_mul_f32 v[44:45], v[44:45], v[62:63]
    v_pk_mul_f32 v[46:47], v[46:47], v[62:63]
    v_pk_mul_f32 v[48:49], v[48:49], v[62:63]
    v_mfma_f32_32x32x16_bf16 v[112:127], v[140:143], v[188:191], v[112:127]
    buffer_load_dwordx4 v[176:179], v11, s[60:63], s44 offen sc1
    buffer_load_dwordx4 v[180:183], v11, s[60:63], s45 offen sc1
    s_add_u32 s44, s44, 1024
    s_add_u32 s45, s45, 1024
    s_add_u32 m0, s46, 8192
    s_add_u32 s47, s43, 27648
    buffer_load_dwordx4 v10, s[56:59], s43 offen lds
    buffer_load_dwordx4 v10, s[56:59], s47 offen offset:1024 lds
    s_add_u32 s43, s43, 57344
    s_waitcnt vmcnt(20) lgkmcnt(0)
    v_mfma_f32_32x32x16_bf16 v[64:79], v[128:131], v[192:195], v[64:79]
    ds_read_b64_tr_b16 v[136:137], v12 offset:14336
    ds_read_b64_tr_b16 v[138:139], v12 offset:14848
    v_pk_mul_f32 v[50:51], v[50:51], v[62:63]
    v_cvt_pk_bf16_f32 v52, v44, v45
    v_cvt_pk_bf16_f32 v53, v46, v47
    v_mfma_f32_32x32x16_bf16 v[80:95], v[128:131], v[196:199], v[80:95]
    ds_read_b64_tr_b16 v[140:141], v13 offset:14336
    ds_read_b64_tr_b16 v[142:143], v13 offset:14848
    v_cvt_pk_bf16_f32 v54, v48, v49
    v_cvt_pk_bf16_f32 v55, v50, v51
    ds_write_b128 v2, v[52:55] offset:11264
    v_mfma_f32_32x32x16_bf16 v[96:111], v[132:135], v[192:195], v[96:111]
    v_accvgpr_read_b32 v28, a96
    v_accvgpr_read_b32 v29, a97
    v_accvgpr_read_b32 v30, a98
    v_mfma_f32_32x32x16_bf16 v[112:127], v[132:135], v[196:199], v[112:127]
    buffer_load_dwordx4 v[184:187], v11, s[60:63], s44 offen sc1
    buffer_load_dwordx4 v[188:191], v11, s[60:63], s45 offen sc1
    s_add_u32 s44, s44, 1024
    s_add_u32 s45, s45, 1024
    s_add_u32 m0, s46, 10240
    s_add_u32 s47, s43, 27648
    buffer_load_dwordx4 v10, s[56:59], s43 offen lds
    buffer_load_dwordx4 v10, s[56:59], s47 offen offset:1024 lds
    s_add_u32 s43, s43, 57344
    s_waitcnt vmcnt(20) lgkmcnt(0)
    v_mfma_f32_32x32x16_bf16 v[64:79], v[136:139], v[200:203], v[64:79]
    ds_read_b64_tr_b16 v[128:129], v12 offset:0
    ds_read_b64_tr_b16 v[130:131], v12 offset:512
    v_accvgpr_read_b32 v31, a99
    v_accvgpr_read_b32 v32, a100
    v_accvgpr_read_b32 v33, a101
    v_mfma_f32_32x32x16_bf16 v[80:95], v[136:139], v[204:207], v[80:95]
    ds_read_b64_tr_b16 v[132:133], v13 offset:0
    ds_read_b64_tr_b16 v[134:135], v13 offset:512
    v_accvgpr_read_b32 v34, a102
    v_accvgpr_read_b32 v35, a103
    v_pk_mul_f32 v[28:29], v[28:29], v[60:61]
    v_mfma_f32_32x32x16_bf16 v[96:111], v[140:143], v[200:203], v[96:111]
    v_pk_mul_f32 v[30:31], v[30:31], v[60:61]
    v_pk_mul_f32 v[32:33], v[32:33], v[60:61]
    v_pk_mul_f32 v[34:35], v[34:35], v[60:61]
    v_mfma_f32_32x32x16_bf16 v[112:127], v[140:143], v[204:207], v[112:127]
    buffer_load_dwordx4 v[192:195], v11, s[60:63], s44 offen sc1
    buffer_load_dwordx4 v[196:199], v11, s[60:63], s45 offen sc1
    s_add_u32 s44, s44, 1024
    s_add_u32 s45, s45, 1024
    s_add_u32 m0, s46, 12288
    s_add_u32 s47, s43, 27648
    buffer_load_dwordx4 v10, s[56:59], s43 offen lds
    buffer_load_dwordx4 v10, s[56:59], s47 offen offset:1024 lds
    s_add_u32 s43, s43, 57344
    s_waitcnt vmcnt(20) lgkmcnt(0)
    v_mfma_f32_32x32x16_bf16 v[64:79], v[128:131], v[144:147], v[64:79]
    ds_read_b64_tr_b16 v[136:137], v12 offset:2048
    ds_read_b64_tr_b16 v[138:139], v12 offset:2560
    v_cvt_pk_bf16_f32 v36, v28, v29
    v_cvt_pk_bf16_f32 v37, v30, v31
    v_cvt_pk_bf16_f32 v38, v32, v33
    v_mfma_f32_32x32x16_bf16 v[80:95], v[128:131], v[148:151], v[80:95]
    ds_read_b64_tr_b16 v[140:141], v13 offset:2048
    ds_read_b64_tr_b16 v[142:143], v13 offset:2560
    v_cvt_pk_bf16_f32 v39, v34, v35
    ds_write_b128 v2, v[36:39] offset:12288
    v_accvgpr_read_b32 v44, a104
    v_mfma_f32_32x32x16_bf16 v[96:111], v[132:135], v[144:147], v[96:111]
    v_accvgpr_read_b32 v45, a105
    v_accvgpr_read_b32 v46, a106
    v_accvgpr_read_b32 v47, a107
    v_mfma_f32_32x32x16_bf16 v[112:127], v[132:135], v[148:151], v[112:127]
    buffer_load_dwordx4 v[200:203], v11, s[60:63], s44 offen sc1
    buffer_load_dwordx4 v[204:207], v11, s[60:63], s45 offen sc1
    s_add_u32 s44, s44, 1024
    s_add_u32 s45, s45, 1024
    s_add_u32 m0, s46, 14336
    s_add_u32 s47, s43, 27648
    buffer_load_dwordx4 v10, s[56:59], s43 offen lds
    buffer_load_dwordx4 v10, s[56:59], s47 offen offset:1024 lds
    s_add_u32 s43, s43, 57344
    s_waitcnt vmcnt(20) lgkmcnt(0)
    v_mfma_f32_32x32x16_bf16 v[64:79], v[136:139], v[152:155], v[64:79]
    ds_read_b64_tr_b16 v[128:129], v12 offset:4096
    ds_read_b64_tr_b16 v[130:131], v12 offset:4608
    v_accvgpr_read_b32 v48, a108
    v_accvgpr_read_b32 v49, a109
    v_accvgpr_read_b32 v50, a110
    v_mfma_f32_32x32x16_bf16 v[80:95], v[136:139], v[156:159], v[80:95]
    ds_read_b64_tr_b16 v[132:133], v13 offset:4096
    ds_read_b64_tr_b16 v[134:135], v13 offset:4608
    v_accvgpr_read_b32 v51, a111
    v_pk_mul_f32 v[44:45], v[44:45], v[60:61]
    v_pk_mul_f32 v[46:47], v[46:47], v[60:61]
    v_mfma_f32_32x32x16_bf16 v[96:111], v[140:143], v[152:155], v[96:111]
    v_pk_mul_f32 v[48:49], v[48:49], v[60:61]
    v_pk_mul_f32 v[50:51], v[50:51], v[60:61]
    v_cvt_pk_bf16_f32 v52, v44, v45
    v_mfma_f32_32x32x16_bf16 v[112:127], v[140:143], v[156:159], v[112:127]
    s_waitcnt vmcnt(16) lgkmcnt(0)
    v_mfma_f32_32x32x16_bf16 v[64:79], v[128:131], v[160:163], v[64:79]
    ds_read_b64_tr_b16 v[136:137], v12 offset:6144
    ds_read_b64_tr_b16 v[138:139], v12 offset:6656
    v_cvt_pk_bf16_f32 v53, v46, v47
    v_cvt_pk_bf16_f32 v54, v48, v49
    v_cvt_pk_bf16_f32 v55, v50, v51
    v_mfma_f32_32x32x16_bf16 v[80:95], v[128:131], v[164:167], v[80:95]
    ds_read_b64_tr_b16 v[140:141], v13 offset:6144
    ds_read_b64_tr_b16 v[142:143], v13 offset:6656
    ds_write_b128 v2, v[52:55] offset:14336
    v_accvgpr_read_b32 v28, a112
    v_accvgpr_read_b32 v29, a113
    v_mfma_f32_32x32x16_bf16 v[96:111], v[132:135], v[160:163], v[96:111]
    v_accvgpr_read_b32 v30, a114
    v_accvgpr_read_b32 v31, a115
    v_accvgpr_read_b32 v32, a116
    v_mfma_f32_32x32x16_bf16 v[112:127], v[132:135], v[164:167], v[112:127]
    s_waitcnt vmcnt(12) lgkmcnt(0)
    v_mfma_f32_32x32x16_bf16 v[64:79], v[136:139], v[168:171], v[64:79]
    ds_read_b64_tr_b16 v[128:129], v12 offset:8192
    ds_read_b64_tr_b16 v[130:131], v12 offset:8704
    v_accvgpr_read_b32 v33, a117
    v_accvgpr_read_b32 v34, a118
    v_accvgpr_read_b32 v35, a119
    v_mfma_f32_32x32x16_bf16 v[80:95], v[136:139], v[172:175], v[80:95]
    ds_read_b64_tr_b16 v[132:133], v13 offset:8192
    ds_read_b64_tr_b16 v[134:135], v13 offset:8704
    v_pk_mul_f32 v[28:29], v[28:29], v[62:63]
    v_pk_mul_f32 v[30:31], v[30:31], v[62:63]
    v_pk_mul_f32 v[32:33], v[32:33], v[62:63]
    v_mfma_f32_32x32x16_bf16 v[96:111], v[140:143], v[168:171], v[96:111]
    v_pk_mul_f32 v[34:35], v[34:35], v[62:63]
    v_cvt_pk_bf16_f32 v36, v28, v29
    v_cvt_pk_bf16_f32 v37, v30, v31
    v_mfma_f32_32x32x16_bf16 v[112:127], v[140:143], v[172:175], v[112:127]
    s_waitcnt vmcnt(8) lgkmcnt(0)
    v_mfma_f32_32x32x16_bf16 v[64:79], v[128:131], v[176:179], v[64:79]
    ds_read_b64_tr_b16 v[136:137], v12 offset:10240
    ds_read_b64_tr_b16 v[138:139], v12 offset:10752
    v_cvt_pk_bf16_f32 v38, v32, v33
    v_cvt_pk_bf16_f32 v39, v34, v35
    ds_write_b128 v2, v[36:39] offset:13312
    v_mfma_f32_32x32x16_bf16 v[80:95], v[128:131], v[180:183], v[80:95]
    ds_read_b64_tr_b16 v[140:141], v13 offset:10240
    ds_read_b64_tr_b16 v[142:143], v13 offset:10752
    v_accvgpr_read_b32 v44, a120
    v_accvgpr_read_b32 v45, a121
    v_accvgpr_read_b32 v46, a122
    v_mfma_f32_32x32x16_bf16 v[96:111], v[132:135], v[176:179], v[96:111]
    v_accvgpr_read_b32 v47, a123
    v_accvgpr_read_b32 v48, a124
    v_accvgpr_read_b32 v49, a125
    v_mfma_f32_32x32x16_bf16 v[112:127], v[132:135], v[180:183], v[112:127]
    s_waitcnt vmcnt(4) lgkmcnt(0)
    v_mfma_f32_32x32x16_bf16 v[64:79], v[136:139], v[184:187], v[64:79]
    ds_read_b64_tr_b16 v[128:129], v12 offset:12288
    ds_read_b64_tr_b16 v[130:131], v12 offset:12800
    v_accvgpr_read_b32 v50, a126
    v_accvgpr_read_b32 v51, a127
    v_pk_mul_f32 v[44:45], v[44:45], v[62:63]
    v_mfma_f32_32x32x16_bf16 v[80:95], v[136:139], v[188:191], v[80:95]
    ds_read_b64_tr_b16 v[132:133], v13 offset:12288
    ds_read_b64_tr_b16 v[134:135], v13 offset:12800
    v_pk_mul_f32 v[46:47], v[46:47], v[62:63]
    v_pk_mul_f32 v[48:49], v[48:49], v[62:63]
    v_pk_mul_f32 v[50:51], v[50:51], v[62:63]
    v_mfma_f32_32x32x16_bf16 v[96:111], v[140:143], v[184:187], v[96:111]
    v_cvt_pk_bf16_f32 v52, v44, v45
    v_cvt_pk_bf16_f32 v53, v46, v47
    v_cvt_pk_bf16_f32 v54, v48, v49
    v_mfma_f32_32x32x16_bf16 v[112:127], v[140:143], v[188:191], v[112:127]
    s_waitcnt vmcnt(0) lgkmcnt(0)
    v_mfma_f32_32x32x16_bf16 v[64:79], v[128:131], v[192:195], v[64:79]
    ds_read_b64_tr_b16 v[136:137], v12 offset:14336
    ds_read_b64_tr_b16 v[138:139], v12 offset:14848
    v_cvt_pk_bf16_f32 v55, v50, v51
    ds_write_b128 v2, v[52:55] offset:15360
    v_mfma_f32_32x32x16_bf16 v[80:95], v[128:131], v[196:199], v[80:95]
    ds_read_b64_tr_b16 v[140:141], v13 offset:14336
    ds_read_b64_tr_b16 v[142:143], v13 offset:14848
    v_mfma_f32_32x32x16_bf16 v[96:111], v[132:135], v[192:195], v[96:111]
    v_mfma_f32_32x32x16_bf16 v[112:127], v[132:135], v[196:199], v[112:127]
    s_waitcnt lgkmcnt(0)
    v_mfma_f32_32x32x16_bf16 v[64:79], v[136:139], v[200:203], v[64:79]
    v_mfma_f32_32x32x16_bf16 v[80:95], v[136:139], v[204:207], v[80:95]
    v_mfma_f32_32x32x16_bf16 v[96:111], v[140:143], v[200:203], v[96:111]
    v_mfma_f32_32x32x16_bf16 v[112:127], v[140:143], v[204:207], v[112:127]
    s_nop 7
    s_barrier
    s_lshl_b32 s3, s42, 14
    v_add_u32 v3, s3, v11
    s_nop 4
    ds_write_b128 v3, v[64:67] offset:0
    ds_write_b128 v3, v[68:71] offset:1024
    ds_write_b128 v3, v[72:75] offset:2048
    ds_write_b128 v3, v[76:79] offset:3072
    ds_write_b128 v3, v[80:83] offset:4096
    ds_write_b128 v3, v[84:87] offset:5120
    ds_write_b128 v3, v[88:91] offset:6144
    ds_write_b128 v3, v[92:95] offset:7168
    ds_write_b128 v3, v[96:99] offset:8192
    ds_write_b128 v3, v[100:103] offset:9216
    ds_write_b128 v3, v[104:107] offset:10240
    ds_write_b128 v3, v[108:111] offset:11264
    ds_write_b128 v3, v[112:115] offset:12288
    ds_write_b128 v3, v[116:119] offset:13312
    ds_write_b128 v3, v[120:123] offset:14336
    ds_write_b128 v3, v[124:127] offset:15360
    s_lshl_b32 s3, s42, 12
    v_add_u32 v3, s3, v11
    s_waitcnt lgkmcnt(0)
    s_barrier
    ds_read_b128 v[64:67], v3 offset:0
    ds_read_b128 v[68:71], v3 offset:1024
    ds_read_b128 v[72:75], v3 offset:2048
    ds_read_b128 v[76:79], v3 offset:3072
    ds_read_b128 v[80:83], v3 offset:16384
    ds_read_b128 v[84:87], v3 offset:17408
    ds_read_b128 v[88:91], v3 offset:18432
    ds_read_b128 v[92:95], v3 offset:19456
    ds_read_b128 v[96:99], v3 offset:32768
    ds_read_b128 v[100:103], v3 offset:33792
    ds_read_b128 v[104:107], v3 offset:34816
    ds_read_b128 v[108:111], v3 offset:35840
    ds_read_b128 v[112:115], v3 offset:49152
    ds_read_b128 v[116:119], v3 offset:50176
    ds_read_b128 v[120:123], v3 offset:51200
    ds_read_b128 v[124:127], v3 offset:52224
    v_accvgpr_read_b32 v20, a176
    v_accvgpr_read_b32 v21, a177
    v_accvgpr_read_b32 v22, a178
    v_accvgpr_read_b32 v23, a179
    v_accvgpr_read_b32 v24, a180
    v_accvgpr_read_b32 v25, a181
    v_accvgpr_read_b32 v26, a182
    v_accvgpr_read_b32 v27, a183
    v_lshlrev_b32 v32, 16, v20
    v_and_b32 v33, 0xffff0000, v20
    v_lshlrev_b32 v34, 16, v21
    v_and_b32 v35, 0xffff0000, v21
    v_lshlrev_b32 v36, 16, v22
    v_and_b32 v37, 0xffff0000, v22
    v_lshlrev_b32 v38, 16, v23
    v_and_b32 v39, 0xffff0000, v23
    v_lshlrev_b32 v40, 16, v24
    v_and_b32 v41, 0xffff0000, v24
    v_lshlrev_b32 v42, 16, v25
    v_and_b32 v43, 0xffff0000, v25
    v_lshlrev_b32 v44, 16, v26
    v_and_b32 v45, 0xffff0000, v26
    v_lshlrev_b32 v46, 16, v27
    v_and_b32 v47, 0xffff0000, v27
    s_waitcnt lgkmcnt(0)
    s_barrier
    s_lshl_b32 s48, s42, 14
    v_lshrrev_b32 v1, 4, v0
    v_mul_u32_u24 v1, 768, v1
    v_add_u32 v245, v238, v1
    s_lshl_b32 s47, s40, 19
    s_lshl_b32 s14, s42, 8
    s_add_u32 s47, s47, s14
    s_add_u32 m0, s48, 0
    s_nop 0
    buffer_load_dwordx4 v245, s[28:31], s47 offen lds
    s_add_u32 s47, s47, 3072
    buffer_load_dwordx4 v245, s[28:31], s47 offen offset:1024 lds
    s_add_u32 s47, s47, 3072
    buffer_load_dwordx4 v245, s[28:31], s47 offen offset:2048 lds
    s_add_u32 s47, s47, 3072
    buffer_load_dwordx4 v245, s[28:31], s47 offen offset:3072 lds
    s_add_u32 s47, s47, 7168
    s_add_u32 m0, s48, 4096
    s_nop 0
    buffer_load_dwordx4 v245, s[28:31], s47 offen lds
    s_add_u32 s47, s47, 3072
    buffer_load_dwordx4 v245, s[28:31], s47 offen offset:1024 lds
    s_add_u32 s47, s47, 3072
    buffer_load_dwordx4 v245, s[28:31], s47 offen offset:2048 lds
    s_add_u32 s47, s47, 3072
    buffer_load_dwordx4 v245, s[28:31], s47 offen offset:3072 lds
    s_add_u32 s47, s47, 7168
    s_add_u32 m0, s48, 8192
    s_nop 0
    buffer_load_dwordx4 v245, s[28:31], s47 offen lds
    s_add_u32 s47, s47, 3072
    buffer_load_dwordx4 v245, s[28:31], s47 offen offset:1024 lds
    s_add_u32 s47, s47, 3072
    buffer_load_dwordx4 v245, s[28:31], s47 offen offset:2048 lds
    s_add_u32 s47, s47, 3072
    buffer_load_dwordx4 v245, s[28:31], s47 offen offset:3072 lds
    s_add_u32 s47, s47, 7168
    s_add_u32 m0, s48, 12288
    s_nop 0
    buffer_load_dwordx4 v245, s[28:31], s47 offen lds
    s_add_u32 s47, s47, 3072
    buffer_load_dwordx4 v245, s[28:31], s47 offen offset:1024 lds
    s_add_u32 s47, s47, 3072
    buffer_load_dwordx4 v245, s[28:31], s47 offen offset:2048 lds
    s_add_u32 s47, s47, 3072
    buffer_load_dwordx4 v245, s[28:31], s47 offen offset:3072 lds
    s_add_u32 s47, s47, 7168
    s_mov_b32 s12, 0xc0135761
    s_mov_b32 s13, 0xbdd2d3e8
    v_mov_b32 v48, s12
    v_pk_add_f32 v[64:65], v[64:65], v[80:81]
    v_pk_add_f32 v[96:97], v[96:97], v[112:113]
    v_pk_add_f32 v[66:67], v[66:67], v[82:83]
    v_pk_add_f32 v[98:99], v[98:99], v[114:115]
    v_pk_add_f32 v[68:69], v[68:69], v[84:85]
    v_pk_add_f32 v[100:101], v[100:101], v[116:117]
    v_pk_add_f32 v[70:71], v[70:71], v[86:87]
    v_pk_add_f32 v[102:103], v[102:103], v[118:119]
    v_pk_add_f32 v[72:73], v[72:73], v[88:89]
    v_pk_add_f32 v[104:105], v[104:105], v[120:121]
    v_pk_add_f32 v[74:75], v[74:75], v[90:91]
    v_pk_add_f32 v[106:107], v[106:107], v[122:123]
    v_pk_add_f32 v[76:77], v[76:77], v[92:93]
    v_pk_add_f32 v[108:109], v[108:109], v[124:125]
    v_pk_add_f32 v[78:79], v[78:79], v[94:95]
    v_pk_add_f32 v[110:111], v[110:111], v[126:127]
    v_pk_add_f32 v[64:65], v[64:65], v[96:97]
    v_pk_add_f32 v[66:67], v[66:67], v[98:99]
    v_pk_add_f32 v[68:69], v[68:69], v[100:101]
    v_pk_add_f32 v[70:71], v[70:71], v[102:103]
    v_pk_add_f32 v[72:73], v[72:73], v[104:105]
    v_pk_add_f32 v[74:75], v[74:75], v[106:107]
    v_pk_add_f32 v[76:77], v[76:77], v[108:109]
    v_pk_add_f32 v[78:79], v[78:79], v[110:111]
    v_pk_add_f32 v[64:65], v[64:65], v[32:33]
    v_pk_add_f32 v[66:67], v[66:67], v[34:35]
    v_pk_add_f32 v[68:69], v[68:69], v[36:37]
    v_pk_add_f32 v[70:71], v[70:71], v[38:39]
    v_pk_add_f32 v[72:73], v[72:73], v[40:41]
    v_pk_add_f32 v[74:75], v[74:75], v[42:43]
    v_pk_add_f32 v[76:77], v[76:77], v[44:45]
    v_pk_add_f32 v[78:79], v[78:79], v[46:47]
    v_pk_mul_f32 v[80:81], v[64:65], v[64:65]
    v_pk_mul_f32 v[82:83], v[66:67], v[66:67]
    v_pk_mul_f32 v[84:85], v[68:69], v[68:69]
    v_pk_mul_f32 v[86:87], v[70:71], v[70:71]
    v_pk_mul_f32 v[88:89], v[72:73], v[72:73]
    v_pk_mul_f32 v[90:91], v[74:75], v[74:75]
    v_pk_mul_f32 v[92:93], v[76:77], v[76:77]
    v_pk_mul_f32 v[94:95], v[78:79], v[78:79]
    v_fma_f32 v80, v80, s13, v48
    v_fma_f32 v81, v81, s13, v48
    v_fma_f32 v82, v82, s13, v48
    v_fma_f32 v83, v83, s13, v48
    v_fma_f32 v84, v84, s13, v48
    v_fma_f32 v85, v85, s13, v48
    v_fma_f32 v86, v86, s13, v48
    v_fma_f32 v87, v87, s13, v48
    v_fma_f32 v88, v88, s13, v48
    v_fma_f32 v89, v89, s13, v48
    v_fma_f32 v90, v90, s13, v48
    v_fma_f32 v91, v91, s13, v48
    v_fma_f32 v92, v92, s13, v48
    v_fma_f32 v93, v93, s13, v48
    v_fma_f32 v94, v94, s13, v48
    v_fma_f32 v95, v95, s13, v48
    v_pk_mul_f32 v[80:81], v[80:81], v[64:65]
    v_pk_mul_f32 v[82:83], v[82:83], v[66:67]
    v_pk_mul_f32 v[84:85], v[84:85], v[68:69]
    v_pk_mul_f32 v[86:87], v[86:87], v[70:71]
    v_pk_mul_f32 v[88:89], v[88:89], v[72:73]
    v_pk_mul_f32 v[90:91], v[90:91], v[74:75]
    v_pk_mul_f32 v[92:93], v[92:93], v[76:77]
    v_pk_mul_f32 v[94:95], v[94:95], v[78:79]
    v_exp_f32 v80, v80
    v_exp_f32 v81, v81
    v_exp_f32 v82, v82
    v_exp_f32 v83, v83
    v_exp_f32 v84, v84
    v_exp_f32 v85, v85
    v_exp_f32 v86, v86
    v_exp_f32 v87, v87
    v_exp_f32 v88, v88
    v_exp_f32 v89, v89
    v_exp_f32 v90, v90
    v_exp_f32 v91, v91
    v_exp_f32 v92, v92
    v_exp_f32 v93, v93
    v_exp_f32 v94, v94
    v_exp_f32 v95, v95
    v_add_f32 v80, 1.0, v80
    v_add_f32 v81, 1.0, v81
    v_add_f32 v82, 1.0, v82
    v_add_f32 v83, 1.0, v83
    v_add_f32 v84, 1.0, v84
    v_add_f32 v85, 1.0, v85
    v_add_f32 v86, 1.0, v86
    v_add_f32 v87, 1.0, v87
    v_add_f32 v88, 1.0, v88
    v_add_f32 v89, 1.0, v89
    v_add_f32 v90, 1.0, v90
    v_add_f32 v91, 1.0, v91
    v_add_f32 v92, 1.0, v92
    v_add_f32 v93, 1.0, v93
    v_add_f32 v94, 1.0, v94
    v_add_f32 v95, 1.0, v95
    v_rcp_f32 v80, v80
    v_rcp_f32 v81, v81
    v_rcp_f32 v82, v82
    v_rcp_f32 v83, v83
    v_rcp_f32 v84, v84
    v_rcp_f32 v85, v85
    v_rcp_f32 v86, v86
    v_rcp_f32 v87, v87
    v_rcp_f32 v88, v88
    v_rcp_f32 v89, v89
    v_rcp_f32 v90, v90
    v_rcp_f32 v91, v91
    v_rcp_f32 v92, v92
    v_rcp_f32 v93, v93
    v_rcp_f32 v94, v94
    v_rcp_f32 v95, v95
    s_nop 0
    v_pk_mul_f32 v[64:65], v[64:65], v[80:81]
    v_pk_mul_f32 v[66:67], v[66:67], v[82:83]
    v_pk_mul_f32 v[68:69], v[68:69], v[84:85]
    v_pk_mul_f32 v[70:71], v[70:71], v[86:87]
    v_pk_mul_f32 v[72:73], v[72:73], v[88:89]
    v_pk_mul_f32 v[74:75], v[74:75], v[90:91]
    v_pk_mul_f32 v[76:77], v[76:77], v[92:93]
    v_pk_mul_f32 v[78:79], v[78:79], v[94:95]
    v_cvt_pk_bf16_f32 v52, v64, v65
    v_cvt_pk_bf16_f32 v53, v66, v67
    v_cvt_pk_bf16_f32 v54, v68, v69
    v_cvt_pk_bf16_f32 v55, v70, v71
    v_cvt_pk_bf16_f32 v56, v72, v73
    v_cvt_pk_bf16_f32 v57, v74, v75
    v_cvt_pk_bf16_f32 v58, v76, v77
    v_cvt_pk_bf16_f32 v59, v78, v79
    s_and_b32 s12, s42, 1
    s_lshl_b32 s13, s55, 1
    s_add_u32 s12, s12, s13
    s_mul_i32 s12, s12, 112
    s_lshl_b32 s13, s54, 2
    s_add_u32 s12, s12, s13
    s_lshr_b32 s13, s42, 1
    s_lshl_b32 s13, s13, 1
    s_add_u32 s12, s12, s13
    s_lshl_b32 s12, s12, 10
    s_add_u32 s12, s12, 4194304
    buffer_store_dwordx4 v[52:55], v11, s[60:63], s12 offen sc1
    buffer_store_dwordx4 v[56:59], v11, s[60:63], s12 offen offset:1024 sc1
    s_branch L_g1_done
L_no_g1:
    s_waitcnt vmcnt(0)
    s_barrier
    s_lshl_b32 s48, s42, 14
    v_lshrrev_b32 v1, 4, v0
    v_mul_u32_u24 v1, 768, v1
    v_add_u32 v245, v238, v1
    s_lshl_b32 s47, s40, 19
    s_lshl_b32 s14, s42, 8
    s_add_u32 s47, s47, s14
    s_add_u32 m0, s48, 0
    s_nop 0
    buffer_load_dwordx4 v245, s[28:31], s47 offen lds
    s_add_u32 s47, s47, 3072
    buffer_load_dwordx4 v245, s[28:31], s47 offen offset:1024 lds
    s_add_u32 s47, s47, 3072
    buffer_load_dwordx4 v245, s[28:31], s47 offen offset:2048 lds
    s_add_u32 s47, s47, 3072
    buffer_load_dwordx4 v245, s[28:31], s47 offen offset:3072 lds
    s_add_u32 s47, s47, 7168
    s_add_u32 m0, s48, 4096
    s_nop 0
    buffer_load_dwordx4 v245, s[28:31], s47 offen lds
    s_add_u32 s47, s47, 3072
    buffer_load_dwordx4 v245, s[28:31], s47 offen offset:1024 lds
    s_add_u32 s47, s47, 3072
    buffer_load_dwordx4 v245, s[28:31], s47 offen offset:2048 lds
    s_add_u32 s47, s47, 3072
    buffer_load_dwordx4 v245, s[28:31], s47 offen offset:3072 lds
    s_add_u32 s47, s47, 7168
    s_add_u32 m0, s48, 8192
    s_nop 0
    buffer_load_dwordx4 v245, s[28:31], s47 offen lds
    s_add_u32 s47, s47, 3072
    buffer_load_dwordx4 v245, s[28:31], s47 offen offset:1024 lds
    s_add_u32 s47, s47, 3072
    buffer_load_dwordx4 v245, s[28:31], s47 offen offset:2048 lds
    s_add_u32 s47, s47, 3072
    buffer_load_dwordx4 v245, s[28:31], s47 offen offset:3072 lds
    s_add_u32 s47, s47, 7168
    s_add_u32 m0, s48, 12288
    s_nop 0
    buffer_load_dwordx4 v245, s[28:31], s47 offen lds
    s_add_u32 s47, s47, 3072
    buffer_load_dwordx4 v245, s[28:31], s47 offen offset:1024 lds
    s_add_u32 s47, s47, 3072
    buffer_load_dwordx4 v245, s[28:31], s47 offen offset:2048 lds
    s_add_u32 s47, s47, 3072
    buffer_load_dwordx4 v245, s[28:31], s47 offen offset:3072 lds
    s_add_u32 s47, s47, 7168
    v_accvgpr_read_b32 v28, a0
    v_accvgpr_read_b32 v29, a1
    v_accvgpr_read_b32 v30, a2
    v_accvgpr_read_b32 v31, a3
    v_accvgpr_read_b32 v32, a4
    v_accvgpr_read_b32 v33, a5
    v_accvgpr_read_b32 v34, a6
    v_accvgpr_read_b32 v35, a7
    v_pk_mul_f32 v[28:29], v[28:29], v[60:61]
    v_pk_mul_f32 v[30:31], v[30:31], v[60:61]
    v_pk_mul_f32 v[32:33], v[32:33], v[60:61]
    v_pk_mul_f32 v[34:35], v[34:35], v[60:61]
    v_cvt_pk_bf16_f32 v36, v28, v29
    v_cvt_pk_bf16_f32 v37, v30, v31
    v_cvt_pk_bf16_f32 v38, v32, v33
    v_cvt_pk_bf16_f32 v39, v34, v35
    ds_write_b128 v2, v[36:39] offset:0
    v_accvgpr_read_b32 v44, a8
    v_accvgpr_read_b32 v45, a9
    v_accvgpr_read_b32 v46, a10
    v_accvgpr_read_b32 v47, a11
    v_accvgpr_read_b32 v48, a12
    v_accvgpr_read_b32 v49, a13
    v_accvgpr_read_b32 v50, a14
    v_accvgpr_read_b32 v51, a15
    v_pk_mul_f32 v[44:45], v[44:45], v[60:61]
    v_pk_mul_f32 v[46:47], v[46:47], v[60:61]
    v_pk_mul_f32 v[48:49], v[48:49], v[60:61]
    v_pk_mul_f32 v[50:51], v[50:51], v[60:61]
    v_cvt_pk_bf16_f32 v52, v44, v45
    v_cvt_pk_bf16_f32 v53, v46, v47
    v_cvt_pk_bf16_f32 v54, v48, v49
    v_cvt_pk_bf16_f32 v55, v50, v51
    ds_write_b128 v2, v[52:55] offset:2048
    v_accvgpr_read_b32 v28, a16
    v_accvgpr_read_b32 v29, a17
    v_accvgpr_read_b32 v30, a18
    v_accvgpr_read_b32 v31, a19
    v_accvgpr_read_b32 v32, a20
    v_accvgpr_read_b32 v33, a21
    v_accvgpr_read_b32 v34, a22
    v_accvgpr_read_b32 v35, a23
    v_pk_mul_f32 v[28:29], v[28:29], v[62:63]
    v_pk_mul_f32 v[30:31], v[30:31], v[62:63]
    v_pk_mul_f32 v[32:33], v[32:33], v[62:63]
    v_pk_mul_f32 v[34:35], v[34:35], v[62:63]
    v_cvt_pk_bf16_f32 v36, v28, v29
    v_cvt_pk_bf16_f32 v37, v30, v31
    v_cvt_pk_bf16_f32 v38, v32, v33
    v_cvt_pk_bf16_f32 v39, v34, v35
    ds_write_b128 v2, v[36:39] offset:1024
    v_accvgpr_read_b32 v44, a24
    v_accvgpr_read_b32 v45, a25
    v_accvgpr_read_b32 v46, a26
    v_accvgpr_read_b32 v47, a27
    v_accvgpr_read_b32 v48, a28
    v_accvgpr_read_b32 v49, a29
    v_accvgpr_read_b32 v50, a30
    v_accvgpr_read_b32 v51, a31
    v_pk_mul_f32 v[44:45], v[44:45], v[62:63]
    v_pk_mul_f32 v[46:47], v[46:47], v[62:63]
    v_pk_mul_f32 v[48:49], v[48:49], v[62:63]
    v_pk_mul_f32 v[50:51], v[50:51], v[62:63]
    v_cvt_pk_bf16_f32 v52, v44, v45
    v_cvt_pk_bf16_f32 v53, v46, v47
    v_cvt_pk_bf16_f32 v54, v48, v49
    v_cvt_pk_bf16_f32 v55, v50, v51
    ds_write_b128 v2, v[52:55] offset:3072
    v_accvgpr_read_b32 v28, a32
    v_accvgpr_read_b32 v29, a33
    v_accvgpr_read_b32 v30, a34
    v_accvgpr_read_b32 v31, a35
    v_accvgpr_read_b32 v32, a36
    v_accvgpr_read_b32 v33, a37
    v_accvgpr_read_b32 v34, a38
    v_accvgpr_read_b32 v35, a39
    v_pk_mul_f32 v[28:29], v[28:29], v[60:61]
    v_pk_mul_f32 v[30:31], v[30:31], v[60:61]
    v_pk_mul_f32 v[32:33], v[32:33], v[60:61]
    v_pk_mul_f32 v[34:35], v[34:35], v[60:61]
    v_cvt_pk_bf16_f32 v36, v28, v29
    v_cvt_pk_bf16_f32 v37, v30, v31
    v_cvt_pk_bf16_f32 v38, v32, v33
    v_cvt_pk_bf16_f32 v39, v34, v35
    ds_write_b128 v2, v[36:39] offset:4096
    v_accvgpr_read_b32 v44, a40
    v_accvgpr_read_b32 v45, a41
    v_accvgpr_read_b32 v46, a42
    v_accvgpr_read_b32 v47, a43
    v_accvgpr_read_b32 v48, a44
    v_accvgpr_read_b32 v49, a45
    v_accvgpr_read_b32 v50, a46
    v_accvgpr_read_b32 v51, a47
    v_pk_mul_f32 v[44:45], v[44:45], v[60:61]
    v_pk_mul_f32 v[46:47], v[46:47], v[60:61]
    v_pk_mul_f32 v[48:49], v[48:49], v[60:61]
    v_pk_mul_f32 v[50:51], v[50:51], v[60:61]
    v_cvt_pk_bf16_f32 v52, v44, v45
    v_cvt_pk_bf16_f32 v53, v46, v47
    v_cvt_pk_bf16_f32 v54, v48, v49
    v_cvt_pk_bf16_f32 v55, v50, v51
    ds_write_b128 v2, v[52:55] offset:6144
    v_accvgpr_read_b32 v28, a48
    v_accvgpr_read_b32 v29, a49
    v_accvgpr_read_b32 v30, a50
    v_accvgpr_read_b32 v31, a51
    v_accvgpr_read_b32 v32, a52
    v_accvgpr_read_b32 v33, a53
    v_accvgpr_read_b32 v34, a54
    v_accvgpr_read_b32 v35, a55
    v_pk_mul_f32 v[28:29], v[28:29], v[62:63]
    v_pk_mul_f32 v[30:31], v[30:31], v[62:63]
    v_pk_mul_f32 v[32:33], v[32:33], v[62:63]
    v_pk_mul_f32 v[34:35], v[34:35], v[62:63]
    v_cvt_pk_bf16_f32 v36, v28, v29
    v_cvt_pk_bf16_f32 v37, v30, v31
    v_cvt_pk_bf16_f32 v38, v32, v33
    v_cvt_pk_bf16_f32 v39, v34, v35
    ds_write_b128 v2, v[36:39] offset:5120
    v_accvgpr_read_b32 v44, a56
    v_accvgpr_read_b32 v45, a57
    v_accvgpr_read_b32 v46, a58
    v_accvgpr_read_b32 v47, a59
    v_accvgpr_read_b32 v48, a60
    v_accvgpr_read_b32 v49, a61
    v_accvgpr_read_b32 v50, a62
    v_accvgpr_read_b32 v51, a63
    v_pk_mul_f32 v[44:45], v[44:45], v[62:63]
    v_pk_mul_f32 v[46:47], v[46:47], v[62:63]
    v_pk_mul_f32 v[48:49], v[48:49], v[62:63]
    v_pk_mul_f32 v[50:51], v[50:51], v[62:63]
    v_cvt_pk_bf16_f32 v52, v44, v45
    v_cvt_pk_bf16_f32 v53, v46, v47
    v_cvt_pk_bf16_f32 v54, v48, v49
    v_cvt_pk_bf16_f32 v55, v50, v51
    ds_write_b128 v2, v[52:55] offset:7168
    v_accvgpr_read_b32 v28, a64
    v_accvgpr_read_b32 v29, a65
    v_accvgpr_read_b32 v30, a66
    v_accvgpr_read_b32 v31, a67
    v_accvgpr_read_b32 v32, a68
    v_accvgpr_read_b32 v33, a69
    v_accvgpr_read_b32 v34, a70
    v_accvgpr_read_b32 v35, a71
    v_pk_mul_f32 v[28:29], v[28:29], v[60:61]
    v_pk_mul_f32 v[30:31], v[30:31], v[60:61]
    v_pk_mul_f32 v[32:33], v[32:33], v[60:61]
    v_pk_mul_f32 v[34:35], v[34:35], v[60:61]
    v_cvt_pk_bf16_f32 v36, v28, v29
    v_cvt_pk_bf16_f32 v37, v30, v31
    v_cvt_pk_bf16_f32 v38, v32, v33
    v_cvt_pk_bf16_f32 v39, v34, v35
    ds_write_b128 v2, v[36:39] offset:8192
    v_accvgpr_read_b32 v44, a72
    v_accvgpr_read_b32 v45, a73
    v_accvgpr_read_b32 v46, a74
    v_accvgpr_read_b32 v47, a75
    v_accvgpr_read_b32 v48, a76
    v_accvgpr_read_b32 v49, a77
    v_accvgpr_read_b32 v50, a78
    v_accvgpr_read_b32 v51, a79
    v_pk_mul_f32 v[44:45], v[44:45], v[60:61]
    v_pk_mul_f32 v[46:47], v[46:47], v[60:61]
    v_pk_mul_f32 v[48:49], v[48:49], v[60:61]
    v_pk_mul_f32 v[50:51], v[50:51], v[60:61]
    v_cvt_pk_bf16_f32 v52, v44, v45
    v_cvt_pk_bf16_f32 v53, v46, v47
    v_cvt_pk_bf16_f32 v54, v48, v49
    v_cvt_pk_bf16_f32 v55, v50, v51
    ds_write_b128 v2, v[52:55] offset:10240
    v_accvgpr_read_b32 v28, a80
    v_accvgpr_read_b32 v29, a81
    v_accvgpr_read_b32 v30, a82
    v_accvgpr_read_b32 v31, a83
    v_accvgpr_read_b32 v32, a84
    v_accvgpr_read_b32 v33, a85
    v_accvgpr_read_b32 v34, a86
    v_accvgpr_read_b32 v35, a87
    v_pk_mul_f32 v[28:29], v[28:29], v[62:63]
    v_pk_mul_f32 v[30:31], v[30:31], v[62:63]
    v_pk_mul_f32 v[32:33], v[32:33], v[62:63]
    v_pk_mul_f32 v[34:35], v[34:35], v[62:63]
    v_cvt_pk_bf16_f32 v36, v28, v29
    v_cvt_pk_bf16_f32 v37, v30, v31
    v_cvt_pk_bf16_f32 v38, v32, v33
    v_cvt_pk_bf16_f32 v39, v34, v35
    ds_write_b128 v2, v[36:39] offset:9216
    v_accvgpr_read_b32 v44, a88
    v_accvgpr_read_b32 v45, a89
    v_accvgpr_read_b32 v46, a90
    v_accvgpr_read_b32 v47, a91
    v_accvgpr_read_b32 v48, a92
    v_accvgpr_read_b32 v49, a93
    v_accvgpr_read_b32 v50, a94
    v_accvgpr_read_b32 v51, a95
    v_pk_mul_f32 v[44:45], v[44:45], v[62:63]
    v_pk_mul_f32 v[46:47], v[46:47], v[62:63]
    v_pk_mul_f32 v[48:49], v[48:49], v[62:63]
    v_pk_mul_f32 v[50:51], v[50:51], v[62:63]
    v_cvt_pk_bf16_f32 v52, v44, v45
    v_cvt_pk_bf16_f32 v53, v46, v47
    v_cvt_pk_bf16_f32 v54, v48, v49
    v_cvt_pk_bf16_f32 v55, v50, v51
    ds_write_b128 v2, v[52:55] offset:11264
    v_accvgpr_read_b32 v28, a96
    v_accvgpr_read_b32 v29, a97
    v_accvgpr_read_b32 v30, a98
    v_accvgpr_read_b32 v31, a99
    v_accvgpr_read_b32 v32, a100
    v_accvgpr_read_b32 v33, a101
    v_accvgpr_read_b32 v34, a102
    v_accvgpr_read_b32 v35, a103
    v_pk_mul_f32 v[28:29], v[28:29], v[60:61]
    v_pk_mul_f32 v[30:31], v[30:31], v[60:61]
    v_pk_mul_f32 v[32:33], v[32:33], v[60:61]
    v_pk_mul_f32 v[34:35], v[34:35], v[60:61]
    v_cvt_pk_bf16_f32 v36, v28, v29
    v_cvt_pk_bf16_f32 v37, v30, v31
    v_cvt_pk_bf16_f32 v38, v32, v33
    v_cvt_pk_bf16_f32 v39, v34, v35
    ds_write_b128 v2, v[36:39] offset:12288
    v_accvgpr_read_b32 v44, a104
    v_accvgpr_read_b32 v45, a105
    v_accvgpr_read_b32 v46, a106
    v_accvgpr_read_b32 v47, a107
    v_accvgpr_read_b32 v48, a108
    v_accvgpr_read_b32 v49, a109
    v_accvgpr_read_b32 v50, a110
    v_accvgpr_read_b32 v51, a111
    v_pk_mul_f32 v[44:45], v[44:45], v[60:61]
    v_pk_mul_f32 v[46:47], v[46:47], v[60:61]
    v_pk_mul_f32 v[48:49], v[48:49], v[60:61]
    v_pk_mul_f32 v[50:51], v[50:51], v[60:61]
    v_cvt_pk_bf16_f32 v52, v44, v45
    v_cvt_pk_bf16_f32 v53, v46, v47
    v_cvt_pk_bf16_f32 v54, v48, v49
    v_cvt_pk_bf16_f32 v55, v50, v51
    ds_write_b128 v2, v[52:55] offset:14336
    v_accvgpr_read_b32 v28, a112
    v_accvgpr_read_b32 v29, a113
    v_accvgpr_read_b32 v30, a114
    v_accvgpr_read_b32 v31, a115
    v_accvgpr_read_b32 v32, a116
    v_accvgpr_read_b32 v33, a117
    v_accvgpr_read_b32 v34, a118
    v_accvgpr_read_b32 v35, a119
    v_pk_mul_f32 v[28:29], v[28:29], v[62:63]
    v_pk_mul_f32 v[30:31], v[30:31], v[62:63]
    v_pk_mul_f32 v[32:33], v[32:33], v[62:63]
    v_pk_mul_f32 v[34:35], v[34:35], v[62:63]
    v_cvt_pk_bf16_f32 v36, v28, v29
    v_cvt_pk_bf16_f32 v37, v30, v31
    v_cvt_pk_bf16_f32 v38, v32, v33
    v_cvt_pk_bf16_f32 v39, v34, v35
    ds_write_b128 v2, v[36:39] offset:13312
    v_accvgpr_read_b32 v44, a120
    v_accvgpr_read_b32 v45, a121
    v_accvgpr_read_b32 v46, a122
    v_accvgpr_read_b32 v47, a123
    v_accvgpr_read_b32 v48, a124
    v_accvgpr_read_b32 v49, a125
    v_accvgpr_read_b32 v50, a126
    v_accvgpr_read_b32 v51, a127
    v_pk_mul_f32 v[44:45], v[44:45], v[62:63]
    v_pk_mul_f32 v[46:47], v[46:47], v[62:63]
    v_pk_mul_f32 v[48:49], v[48:49], v[62:63]
    v_pk_mul_f32 v[50:51], v[50:51], v[62:63]
    v_cvt_pk_bf16_f32 v52, v44, v45
    v_cvt_pk_bf16_f32 v53, v46, v47
    v_cvt_pk_bf16_f32 v54, v48, v49
    v_cvt_pk_bf16_f32 v55, v50, v51
    ds_write_b128 v2, v[52:55] offset:15360
L_g1_done:
    s_sub_u32 s14, s48, 65536
    v_add_u32 v240, s14, v230
    v_add_u32 v241, s14, v231
    v_add_u32 v242, s14, v232
    v_add_u32 v243, s14, v233
    s_waitcnt vmcnt(0) lgkmcnt(0)
    s_barrier
    s_cmp_eq_u32 s98, 0
    s_cbranch_scc1 L_no_usig
    s_lshl_b32 s14, s55, 8
    s_add_u32 s14, s14, 6299648
    s_mov_b32 s15, s48
    s_cmp_lg_u32 s42, 0
    s_cbranch_scc1 L_sig_u
    v_mov_b32 v1, 0
    v_mov_b32 v4, 1
    v_cmp_eq_u32 vcc, 0, v0
    s_and_saveexec_b64 s[48:49], vcc
    buffer_atomic_add v4, v1, s[60:63], s14 offen
    s_mov_b64 exec, s[48:49]
L_sig_u:
    s_mov_b32 s48, s15
L_no_usig:
    s_waitcnt vmcnt(12)
    ds_read_b128 a[160:163], v244 offset:0
    ds_read_b128 a[164:167], v244 offset:1024
    ds_read_b64_tr_b16 a[128:129], v240 offset:0
    ds_read_b64_tr_b16 a[130:131], v240 offset:2048
    ds_read_b64_tr_b16 a[132:133], v241 offset:0
    ds_read_b64_tr_b16 a[134:135], v241 offset:2048
    ds_read_b64_tr_b16 a[136:137], v242 offset:0
    ds_read_b64_tr_b16 a[138:139], v242 offset:2048
    ds_read_b64_tr_b16 a[140:141], v243 offset:0
    ds_read_b64_tr_b16 a[142:143], v243 offset:2048
    s_waitcnt vmcnt(8) lgkmcnt(0)
    v_mfma_f32_32x32x16_bf16 v[16:31], a[128:131], a[160:163], 0
    ds_read_b128 a[168:171], v244 offset:2048
    ds_read_b128 a[172:175], v244 offset:3072
    v_mfma_f32_32x32x16_bf16 v[32:47], a[128:131], a[164:167], 0
    ds_read_b64_tr_b16 a[144:145], v240 offset:4096
    ds_read_b64_tr_b16 a[146:147], v240 offset:6144
    v_mfma_f32_32x32x16_bf16 v[48:63], a[132:135], a[160:163], 0
    ds_read_b64_tr_b16 a[148:149], v241 offset:4096
    ds_read_b64_tr_b16 a[150:151], v241 offset:6144
    v_mfma_f32_32x32x16_bf16 v[64:79], a[132:135], a[164:167], 0
    ds_read_b64_tr_b16 a[152:153], v242 offset:4096
    ds_read_b64_tr_b16 a[154:155], v242 offset:6144
    s_add_u32 m0, s48, 0
    v_mfma_f32_32x32x16_bf16 v[80:95], a[136:139], a[160:163], 0
    buffer_load_dwordx4 v245, s[28:31], s47 offen lds
    ds_read_b64_tr_b16 a[156:157], v243 offset:4096
    ds_read_b64_tr_b16 a[158:159], v243 offset:6144
    s_add_u32 s47, s47, 3072
    v_mfma_f32_32x32x16_bf16 v[96:111], a[136:139], a[164:167], 0
    buffer_load_dwordx4 v245, s[28:31], s47 offen offset:1024 lds
    s_add_u32 s47, s47, 3072
    v_mfma_f32_32x32x16_bf16 v[112:127], a[140:143], a[160:163], 0
    buffer_load_dwordx4 v245, s[28:31], s47 offen offset:2048 lds
    s_add_u32 s47, s47, 3072
    v_mfma_f32_32x32x16_bf16 v[128:143], a[140:143], a[164:167], 0
    buffer_load_dwordx4 v245, s[28:31], s47 offen offset:3072 lds
    s_add_u32 s47, s47, 7168
    s_waitcnt vmcnt(8) lgkmcnt(0)
    v_mfma_f32_32x32x16_bf16 v[16:31], a[144:147], a[168:171], v[16:31]
    ds_read_b128 a[160:163], v244 offset:4096
    ds_read_b128 a[164:167], v244 offset:5120
    v_mfma_f32_32x32x16_bf16 v[32:47], a[144:147], a[172:175], v[32:47]
    ds_read_b64_tr_b16 a[128:129], v240 offset:8192
    ds_read_b64_tr_b16 a[130:131], v240 offset:10240
    v_mfma_f32_32x32x16_bf16 v[48:63], a[148:151], a[168:171], v[48:63]
    ds_read_b64_tr_b16 a[132:133], v241 offset:8192
    ds_read_b64_tr_b16 a[134:135], v241 offset:10240
    v_mfma_f32_32x32x16_bf16 v[64:79], a[148:151], a[172:175], v[64:79]
    ds_read_b64_tr_b16 a[136:137], v242 offset:8192
    ds_read_b64_tr_b16 a[138:139], v242 offset:10240
    s_add_u32 m0, s48, 4096
    v_mfma_f32_32x32x16_bf16 v[80:95], a[152:155], a[168:171], v[80:95]
    buffer_load_dwordx4 v245, s[28:31], s47 offen lds
    ds_read_b64_tr_b16 a[140:141], v243 offset:8192
    ds_read_b64_tr_b16 a[142:143], v243 offset:10240
    s_add_u32 s47, s47, 3072
    v_mfma_f32_32x32x16_bf16 v[96:111], a[152:155], a[172:175], v[96:111]
    buffer_load_dwordx4 v245, s[28:31], s47 offen offset:1024 lds
    s_add_u32 s47, s47, 3072
    v_mfma_f32_32x32x16_bf16 v[112:127], a[156:159], a[168:171], v[112:127]
    buffer_load_dwordx4 v245, s[28:31], s47 offen offset:2048 lds
    s_add_u32 s47, s47, 3072
    v_mfma_f32_32x32x16_bf16 v[128:143], a[156:159], a[172:175], v[128:143]
    buffer_load_dwordx4 v245, s[28:31], s47 offen offset:3072 lds
    s_add_u32 s47, s47, 7168
    s_waitcnt vmcnt(8) lgkmcnt(0)
    v_mfma_f32_32x32x16_bf16 v[16:31], a[128:131], a[160:163], v[16:31]
    ds_read_b128 a[168:171], v244 offset:6144
    ds_read_b128 a[172:175], v244 offset:7168
    v_mfma_f32_32x32x16_bf16 v[32:47], a[128:131], a[164:167], v[32:47]
    ds_read_b64_tr_b16 a[144:145], v240 offset:12288
    ds_read_b64_tr_b16 a[146:147], v240 offset:14336
    v_mfma_f32_32x32x16_bf16 v[48:63], a[132:135], a[160:163], v[48:63]
    ds_read_b64_tr_b16 a[148:149], v241 offset:12288
    ds_read_b64_tr_b16 a[150:151], v241 offset:14336
    v_mfma_f32_32x32x16_bf16 v[64:79], a[132:135], a[164:167], v[64:79]
    ds_read_b64_tr_b16 a[152:153], v242 offset:12288
    ds_read_b64_tr_b16 a[154:155], v242 offset:14336
    s_add_u32 m0, s48, 8192
    v_mfma_f32_32x32x16_bf16 v[80:95], a[136:139], a[160:163], v[80:95]
    buffer_load_dwordx4 v245, s[28:31], s47 offen lds
    ds_read_b64_tr_b16 a[156:157], v243 offset:12288
    ds_read_b64_tr_b16 a[158:159], v243 offset:14336
    s_add_u32 s47, s47, 3072
    v_mfma_f32_32x32x16_bf16 v[96:111], a[136:139], a[164:167], v[96:111]
    buffer_load_dwordx4 v245, s[28:31], s47 offen offset:1024 lds
    s_add_u32 s47, s47, 3072
    v_mfma_f32_32x32x16_bf16 v[112:127], a[140:143], a[160:163], v[112:127]
    buffer_load_dwordx4 v245, s[28:31], s47 offen offset:2048 lds
    s_add_u32 s47, s47, 3072
    v_mfma_f32_32x32x16_bf16 v[128:143], a[140:143], a[164:167], v[128:143]
    buffer_load_dwordx4 v245, s[28:31], s47 offen offset:3072 lds
    s_add_u32 s47, s47, 7168
    s_waitcnt vmcnt(8) lgkmcnt(0)
    v_mfma_f32_32x32x16_bf16 v[16:31], a[144:147], a[168:171], v[16:31]
    ds_read_b128 a[160:163], v244 offset:8192
    ds_read_b128 a[164:167], v244 offset:9216
    v_mfma_f32_32x32x16_bf16 v[32:47], a[144:147], a[172:175], v[32:47]
    ds_read_b64_tr_b16 a[128:129], v240 offset:0
    ds_read_b64_tr_b16 a[130:131], v240 offset:2048
    v_mfma_f32_32x32x16_bf16 v[48:63], a[148:151], a[168:171], v[48:63]
    ds_read_b64_tr_b16 a[132:133], v241 offset:0
    ds_read_b64_tr_b16 a[134:135], v241 offset:2048
    v_mfma_f32_32x32x16_bf16 v[64:79], a[148:151], a[172:175], v[64:79]
    ds_read_b64_tr_b16 a[136:137], v242 offset:0
    ds_read_b64_tr_b16 a[138:139], v242 offset:2048
    s_add_u32 m0, s48, 12288
    v_mfma_f32_32x32x16_bf16 v[80:95], a[152:155], a[168:171], v[80:95]
    buffer_load_dwordx4 v245, s[28:31], s47 offen lds
    ds_read_b64_tr_b16 a[140:141], v243 offset:0
    ds_read_b64_tr_b16 a[142:143], v243 offset:2048
    s_add_u32 s47, s47, 3072
    v_mfma_f32_32x32x16_bf16 v[96:111], a[152:155], a[172:175], v[96:111]
    buffer_load_dwordx4 v245, s[28:31], s47 offen offset:1024 lds
    s_add_u32 s47, s47, 3072
    v_mfma_f32_32x32x16_bf16 v[112:127], a[156:159], a[168:171], v[112:127]
    buffer_load_dwordx4 v245, s[28:31], s47 offen offset:2048 lds
    s_add_u32 s47, s47, 3072
    v_mfma_f32_32x32x16_bf16 v[128:143], a[156:159], a[172:175], v[128:143]
    buffer_load_dwordx4 v245, s[28:31], s47 offen offset:3072 lds
    s_add_u32 s47, s47, 7168
    v_add_u32 v244, 8192, v244
    s_mov_b32 s50, 6
L_proj_o:
    s_waitcnt vmcnt(8) lgkmcnt(0)
    v_mfma_f32_32x32x16_bf16 v[16:31], a[128:131], a[160:163], v[16:31]
    ds_read_b128 a[168:171], v244 offset:2048
    ds_read_b128 a[172:175], v244 offset:3072
    v_mfma_f32_32x32x16_bf16 v[32:47], a[128:131], a[164:167], v[32:47]
    ds_read_b64_tr_b16 a[144:145], v240 offset:4096
    ds_read_b64_tr_b16 a[146:147], v240 offset:6144
    v_mfma_f32_32x32x16_bf16 v[48:63], a[132:135], a[160:163], v[48:63]
    ds_read_b64_tr_b16 a[148:149], v241 offset:4096
    ds_read_b64_tr_b16 a[150:151], v241 offset:6144
    v_mfma_f32_32x32x16_bf16 v[64:79], a[132:135], a[164:167], v[64:79]
    ds_read_b64_tr_b16 a[152:153], v242 offset:4096
    ds_read_b64_tr_b16 a[154:155], v242 offset:6144
    s_add_u32 m0, s48, 0
    v_mfma_f32_32x32x16_bf16 v[80:95], a[136:139], a[160:163], v[80:95]
    buffer_load_dwordx4 v245, s[28:31], s47 offen lds
    ds_read_b64_tr_b16 a[156:157], v243 offset:4096
    ds_read_b64_tr_b16 a[158:159], v243 offset:6144
    s_add_u32 s47, s47, 3072
    v_mfma_f32_32x32x16_bf16 v[96:111], a[136:139], a[164:167], v[96:111]
    buffer_load_dwordx4 v245, s[28:31], s47 offen offset:1024 lds
    s_add_u32 s47, s47, 3072
    v_mfma_f32_32x32x16_bf16 v[112:127], a[140:143], a[160:163], v[112:127]
    buffer_load_dwordx4 v245, s[28:31], s47 offen offset:2048 lds
    s_add_u32 s47, s47, 3072
    v_mfma_f32_32x32x16_bf16 v[128:143], a[140:143], a[164:167], v[128:143]
    buffer_load_dwordx4 v245, s[28:31], s47 offen offset:3072 lds
    s_add_u32 s47, s47, 7168
    s_waitcnt vmcnt(8) lgkmcnt(0)
    v_mfma_f32_32x32x16_bf16 v[16:31], a[144:147], a[168:171], v[16:31]
    ds_read_b128 a[160:163], v244 offset:4096
    ds_read_b128 a[164:167], v244 offset:5120
    v_mfma_f32_32x32x16_bf16 v[32:47], a[144:147], a[172:175], v[32:47]
    ds_read_b64_tr_b16 a[128:129], v240 offset:8192
    ds_read_b64_tr_b16 a[130:131], v240 offset:10240
    v_mfma_f32_32x32x16_bf16 v[48:63], a[148:151], a[168:171], v[48:63]
    ds_read_b64_tr_b16 a[132:133], v241 offset:8192
    ds_read_b64_tr_b16 a[134:135], v241 offset:10240
    v_mfma_f32_32x32x16_bf16 v[64:79], a[148:151], a[172:175], v[64:79]
    ds_read_b64_tr_b16 a[136:137], v242 offset:8192
    ds_read_b64_tr_b16 a[138:139], v242 offset:10240
    s_add_u32 m0, s48, 4096
    v_mfma_f32_32x32x16_bf16 v[80:95], a[152:155], a[168:171], v[80:95]
    buffer_load_dwordx4 v245, s[28:31], s47 offen lds
    ds_read_b64_tr_b16 a[140:141], v243 offset:8192
    ds_read_b64_tr_b16 a[142:143], v243 offset:10240
    s_add_u32 s47, s47, 3072
    v_mfma_f32_32x32x16_bf16 v[96:111], a[152:155], a[172:175], v[96:111]
    buffer_load_dwordx4 v245, s[28:31], s47 offen offset:1024 lds
    s_add_u32 s47, s47, 3072
    v_mfma_f32_32x32x16_bf16 v[112:127], a[156:159], a[168:171], v[112:127]
    buffer_load_dwordx4 v245, s[28:31], s47 offen offset:2048 lds
    s_add_u32 s47, s47, 3072
    v_mfma_f32_32x32x16_bf16 v[128:143], a[156:159], a[172:175], v[128:143]
    buffer_load_dwordx4 v245, s[28:31], s47 offen offset:3072 lds
    s_add_u32 s47, s47, 7168
    s_waitcnt vmcnt(8) lgkmcnt(0)
    v_mfma_f32_32x32x16_bf16 v[16:31], a[128:131], a[160:163], v[16:31]
    ds_read_b128 a[168:171], v244 offset:6144
    ds_read_b128 a[172:175], v244 offset:7168
    v_mfma_f32_32x32x16_bf16 v[32:47], a[128:131], a[164:167], v[32:47]
    ds_read_b64_tr_b16 a[144:145], v240 offset:12288
    ds_read_b64_tr_b16 a[146:147], v240 offset:14336
    v_mfma_f32_32x32x16_bf16 v[48:63], a[132:135], a[160:163], v[48:63]
    ds_read_b64_tr_b16 a[148:149], v241 offset:12288
    ds_read_b64_tr_b16 a[150:151], v241 offset:14336
    v_mfma_f32_32x32x16_bf16 v[64:79], a[132:135], a[164:167], v[64:79]
    ds_read_b64_tr_b16 a[152:153], v242 offset:12288
    ds_read_b64_tr_b16 a[154:155], v242 offset:14336
    s_add_u32 m0, s48, 8192
    v_mfma_f32_32x32x16_bf16 v[80:95], a[136:139], a[160:163], v[80:95]
    buffer_load_dwordx4 v245, s[28:31], s47 offen lds
    ds_read_b64_tr_b16 a[156:157], v243 offset:12288
    ds_read_b64_tr_b16 a[158:159], v243 offset:14336
    s_add_u32 s47, s47, 3072
    v_mfma_f32_32x32x16_bf16 v[96:111], a[136:139], a[164:167], v[96:111]
    buffer_load_dwordx4 v245, s[28:31], s47 offen offset:1024 lds
    s_add_u32 s47, s47, 3072
    v_mfma_f32_32x32x16_bf16 v[112:127], a[140:143], a[160:163], v[112:127]
    buffer_load_dwordx4 v245, s[28:31], s47 offen offset:2048 lds
    s_add_u32 s47, s47, 3072
    v_mfma_f32_32x32x16_bf16 v[128:143], a[140:143], a[164:167], v[128:143]
    buffer_load_dwordx4 v245, s[28:31], s47 offen offset:3072 lds
    s_add_u32 s47, s47, 7168
    s_waitcnt vmcnt(8) lgkmcnt(0)
    v_mfma_f32_32x32x16_bf16 v[16:31], a[144:147], a[168:171], v[16:31]
    ds_read_b128 a[160:163], v244 offset:8192
    ds_read_b128 a[164:167], v244 offset:9216
    v_mfma_f32_32x32x16_bf16 v[32:47], a[144:147], a[172:175], v[32:47]
    ds_read_b64_tr_b16 a[128:129], v240 offset:0
    ds_read_b64_tr_b16 a[130:131], v240 offset:2048
    v_mfma_f32_32x32x16_bf16 v[48:63], a[148:151], a[168:171], v[48:63]
    ds_read_b64_tr_b16 a[132:133], v241 offset:0
    ds_read_b64_tr_b16 a[134:135], v241 offset:2048
    v_mfma_f32_32x32x16_bf16 v[64:79], a[148:151], a[172:175], v[64:79]
    ds_read_b64_tr_b16 a[136:137], v242 offset:0
    ds_read_b64_tr_b16 a[138:139], v242 offset:2048
    s_add_u32 m0, s48, 12288
    v_mfma_f32_32x32x16_bf16 v[80:95], a[152:155], a[168:171], v[80:95]
    buffer_load_dwordx4 v245, s[28:31], s47 offen lds
    ds_read_b64_tr_b16 a[140:141], v243 offset:0
    ds_read_b64_tr_b16 a[142:143], v243 offset:2048
    s_add_u32 s47, s47, 3072
    v_mfma_f32_32x32x16_bf16 v[96:111], a[152:155], a[172:175], v[96:111]
    buffer_load_dwordx4 v245, s[28:31], s47 offen offset:1024 lds
    s_add_u32 s47, s47, 3072
    v_mfma_f32_32x32x16_bf16 v[112:127], a[156:159], a[168:171], v[112:127]
    buffer_load_dwordx4 v245, s[28:31], s47 offen offset:2048 lds
    s_add_u32 s47, s47, 3072
    v_mfma_f32_32x32x16_bf16 v[128:143], a[156:159], a[172:175], v[128:143]
    buffer_load_dwordx4 v245, s[28:31], s47 offen offset:3072 lds
    s_add_u32 s47, s47, 7168
    v_add_u32 v244, 8192, v244
    s_sub_u32 s50, s50, 1
    s_cmp_lg_u32 s50, 0
    s_cbranch_scc1 L_proj_o
    s_lshl_b32 s14, s11, 8
    s_add_u32 s14, s14, 6299648
    v_mov_b32 v252, 0
    buffer_load_dword v252, v252, s[60:63], s14 offen sc1
    s_and_b32 s14, s32, 3
    s_mul_i32 s14, s14, 1835008
    s_lshl_b32 s15, s10, 7
    s_add_u32 s14, s14, s15
    s_add_u32 s14, s14, 0
    buffer_load_dword v246, v253, s[24:27], s14 offen
    s_and_b32 s14, s32, 3
    s_mul_i32 s14, s14, 1835008
    s_lshl_b32 s15, s10, 7
    s_add_u32 s14, s14, s15
    s_add_u32 s14, s14, 524288
    buffer_load_dword v247, v253, s[24:27], s14 offen
    s_and_b32 s14, s32, 3
    s_mul_i32 s14, s14, 1835008
    s_lshl_b32 s15, s10, 7
    s_add_u32 s14, s14, s15
    s_add_u32 s14, s14, 1048576
    buffer_load_dword v246, v253, s[24:27], s14 offen
    s_and_b32 s14, s32, 3
    s_mul_i32 s14, s14, 1835008
    s_lshl_b32 s15, s10, 7
    s_add_u32 s14, s14, s15
    s_add_u32 s14, s14, 1572864
    buffer_load_dword v247, v253, s[24:27], s14 offen
    s_waitcnt vmcnt(13) lgkmcnt(0)
    v_mfma_f32_32x32x16_bf16 v[16:31], a[128:131], a[160:163], v[16:31]
    ds_read_b128 a[168:171], v244 offset:2048
    ds_read_b128 a[172:175], v244 offset:3072
    v_mfma_f32_32x32x16_bf16 v[32:47], a[128:131], a[164:167], v[32:47]
    ds_read_b64_tr_b16 a[144:145], v240 offset:4096
    ds_read_b64_tr_b16 a[146:147], v240 offset:6144
    v_mfma_f32_32x32x16_bf16 v[48:63], a[132:135], a[160:163], v[48:63]
    ds_read_b64_tr_b16 a[148:149], v241 offset:4096
    ds_read_b64_tr_b16 a[150:151], v241 offset:6144
    v_mfma_f32_32x32x16_bf16 v[64:79], a[132:135], a[164:167], v[64:79]
    ds_read_b64_tr_b16 a[152:153], v242 offset:4096
    ds_read_b64_tr_b16 a[154:155], v242 offset:6144
    v_mfma_f32_32x32x16_bf16 v[80:95], a[136:139], a[160:163], v[80:95]
    ds_read_b64_tr_b16 a[156:157], v243 offset:4096
    ds_read_b64_tr_b16 a[158:159], v243 offset:6144
    v_mfma_f32_32x32x16_bf16 v[96:111], a[136:139], a[164:167], v[96:111]
    v_mfma_f32_32x32x16_bf16 v[112:127], a[140:143], a[160:163], v[112:127]
    v_mfma_f32_32x32x16_bf16 v[128:143], a[140:143], a[164:167], v[128:143]
    s_waitcnt vmcnt(9) lgkmcnt(0)
    v_mfma_f32_32x32x16_bf16 v[16:31], a[144:147], a[168:171], v[16:31]
    ds_read_b128 a[160:163], v244 offset:4096
    ds_read_b128 a[164:167], v244 offset:5120
    v_mfma_f32_32x32x16_bf16 v[32:47], a[144:147], a[172:175], v[32:47]
    ds_read_b64_tr_b16 a[128:129], v240 offset:8192
    ds_read_b64_tr_b16 a[130:131], v240 offset:10240
    v_mfma_f32_32x32x16_bf16 v[48:63], a[148:151], a[168:171], v[48:63]
    ds_read_b64_tr_b16 a[132:133], v241 offset:8192
    ds_read_b64_tr_b16 a[134:135], v241 offset:10240
    v_mfma_f32_32x32x16_bf16 v[64:79], a[148:151], a[172:175], v[64:79]
    ds_read_b64_tr_b16 a[136:137], v242 offset:8192
    ds_read_b64_tr_b16 a[138:139], v242 offset:10240
    v_mfma_f32_32x32x16_bf16 v[80:95], a[152:155], a[168:171], v[80:95]
    ds_read_b64_tr_b16 a[140:141], v243 offset:8192
    ds_read_b64_tr_b16 a[142:143], v243 offset:10240
    v_mfma_f32_32x32x16_bf16 v[96:111], a[152:155], a[172:175], v[96:111]
    v_mfma_f32_32x32x16_bf16 v[112:127], a[156:159], a[168:171], v[112:127]
    v_mfma_f32_32x32x16_bf16 v[128:143], a[156:159], a[172:175], v[128:143]
    s_waitcnt vmcnt(5) lgkmcnt(0)
    v_mfma_f32_32x32x16_bf16 v[16:31], a[128:131], a[160:163], v[16:31]
    ds_read_b128 a[168:171], v244 offset:6144
    ds_read_b128 a[172:175], v244 offset:7168
    v_mfma_f32_32x32x16_bf16 v[32:47], a[128:131], a[164:167], v[32:47]
    ds_read_b64_tr_b16 a[144:145], v240 offset:12288
    ds_read_b64_tr_b16 a[146:147], v240 offset:14336
    v_mfma_f32_32x32x16_bf16 v[48:63], a[132:135], a[160:163], v[48:63]
    ds_read_b64_tr_b16 a[148:149], v241 offset:12288
    ds_read_b64_tr_b16 a[150:151], v241 offset:14336
    v_mfma_f32_32x32x16_bf16 v[64:79], a[132:135], a[164:167], v[64:79]
    ds_read_b64_tr_b16 a[152:153], v242 offset:12288
    ds_read_b64_tr_b16 a[154:155], v242 offset:14336
    v_mfma_f32_32x32x16_bf16 v[80:95], a[136:139], a[160:163], v[80:95]
    ds_read_b64_tr_b16 a[156:157], v243 offset:12288
    ds_read_b64_tr_b16 a[158:159], v243 offset:14336
    v_mfma_f32_32x32x16_bf16 v[96:111], a[136:139], a[164:167], v[96:111]
    v_mfma_f32_32x32x16_bf16 v[112:127], a[140:143], a[160:163], v[112:127]
    v_mfma_f32_32x32x16_bf16 v[128:143], a[140:143], a[164:167], v[128:143]
    s_waitcnt vmcnt(5) lgkmcnt(0)
    v_mfma_f32_32x32x16_bf16 v[16:31], a[144:147], a[168:171], v[16:31]
    v_mfma_f32_32x32x16_bf16 v[32:47], a[144:147], a[172:175], v[32:47]
    v_mfma_f32_32x32x16_bf16 v[48:63], a[148:151], a[168:171], v[48:63]
    v_mfma_f32_32x32x16_bf16 v[64:79], a[148:151], a[172:175], v[64:79]
    v_mfma_f32_32x32x16_bf16 v[80:95], a[152:155], a[168:171], v[80:95]
    v_mfma_f32_32x32x16_bf16 v[96:111], a[152:155], a[172:175], v[96:111]
    v_mfma_f32_32x32x16_bf16 v[112:127], a[156:159], a[168:171], v[112:127]
    v_mfma_f32_32x32x16_bf16 v[128:143], a[156:159], a[172:175], v[128:143]
    s_waitcnt vmcnt(4) lgkmcnt(0)
    v_readfirstlane_b32 s14, v252
    s_cmp_ge_u32 s14, 28
    s_cbranch_scc1 L_u_nopoll
    s_cmp_lg_u32 s42, 0
    s_cbranch_scc1 L_u_nopoll
    s_lshl_b32 s14, s11, 8
    s_add_u32 s14, s14, 6299648
    s_mov_b32 s51, 1048576
    v_mov_b32 v1, 0
L_poll_u:
    buffer_load_dword v4, v1, s[60:63], s14 offen sc1
    s_waitcnt vmcnt(0)
    v_readfirstlane_b32 s3, v4
    s_cmp_ge_u32 s3, 28
    s_cbranch_scc1 L_polld_u
    s_sleep 16
    s_sub_u32 s51, s51, 1
    s_cmp_lg_u32 s51, 0
    s_cbranch_scc1 L_poll_u
L_polld_u:
L_u_nopoll:
    s_barrier
    s_load_dwordx2 s[8:9], s[0:1], 72
    s_load_dwordx2 s[12:13], s[0:1], 0
    s_load_dwordx2 s[14:15], s[0:1], 80
    s_load_dwordx2 s[48:49], s[0:1], 96
    v_lshrrev_b32 v3, 3, v0
    v_and_b32 v4, 7, v0
    v_lshrrev_b32 v5, 1, v3
    v_and_b32 v5, 1, v5
    v_lshlrev_b32 v5, 2, v5
    v_xor_b32 v4, v4, v5
    v_lshlrev_b32 v3, 12, v3
    v_lshl_add_u32 v10, v4, 4, v3
    v_lshlrev_b32 v11, 4, v0
    v_lshrrev_b32 v3, 5, v0
    v_bfe_u32 v4, v0, 4, 1
    v_bfe_u32 v5, v0, 2, 2
    v_and_b32 v6, 3, v0
    v_lshlrev_b32 v7, 2, v3
    v_add_u32 v7, v7, v5
    v_lshlrev_b32 v7, 7, v7
    v_lshl_add_u32 v7, v4, 5, v7
    v_lshl_add_u32 v7, v6, 3, v7
    s_mul_i32 s46, s42, 24576
    v_add_u32 v7, s46, v7
    v_lshrrev_b32 v8, 1, v5
    v_lshlrev_b32 v9, 6, v8
    v_add_u32 v12, v7, v9
    v_xor_b32 v9, 64, v9
    v_add_u32 v13, v7, v9
    s_mul_i32 s43, s42, 1835008
    s_lshl_b32 s47, s10, 7
    s_add_u32 s43, s43, s47
    s_add_u32 s47, s43, 31744
    s_lshl_b32 s44, s11, 1
    s_mul_i32 s44, s44, 112
    s_mul_i32 s45, s42, 28
    s_add_u32 s44, s44, s45
    s_lshl_b32 s44, s44, 10
    s_add_u32 s44, s44, 4194304
    s_add_u32 s45, s44, 114688
    v_and_b32 v14, 31, v0
    s_lshr_b32 s54, s42, 1
    s_lshl_b32 s54, s54, 5
    v_add_u32 v14, s54, v14
    v_lshlrev_b32 v15, 1, v14
    v_lshlrev_b32 v2, 10, v14
    v_lshl_add_u32 v2, v3, 4, v2
    s_and_b32 s54, s42, 1
    s_lshl_b32 s54, s54, 5
    v_add_u32 v2, s54, v2
    s_add_u32 m0, s46, 0
    buffer_load_dwordx4 v[144:147], v11, s[60:63], s44 offen sc1
    buffer_load_dwordx4 v10, s[24:27], s43 offen lds
    buffer_load_dwordx4 v10, s[24:27], s47 offen offset:1024 lds
    buffer_load_dwordx4 v[148:151], v11, s[60:63], s45 offen sc1
    s_add_u32 s43, s43, 65536
    s_add_u32 s47, s47, 65536
    s_add_u32 s44, s44, 1024
    s_add_u32 s45, s45, 1024
    s_add_u32 m0, s46, 2048
    buffer_load_dwordx4 v[152:155], v11, s[60:63], s44 offen sc1
    buffer_load_dwordx4 v10, s[24:27], s43 offen lds
    buffer_load_dwordx4 v10, s[24:27], s47 offen offset:1024 lds
    buffer_load_dwordx4 v[156:159], v11, s[60:63], s45 offen sc1
    s_add_u32 s43, s43, 65536
    s_add_u32 s47, s47, 65536
    s_add_u32 s44, s44, 1024
    s_add_u32 s45, s45, 1024
    s_add_u32 m0, s46, 4096
    buffer_load_dwordx4 v[160:163], v11, s[60:63], s44 offen sc1
    buffer_load_dwordx4 v10, s[24:27], s43 offen lds
    buffer_load_dwordx4 v10, s[24:27], s47 offen offset:1024 lds
    buffer_load_dwordx4 v[164:167], v11, s[60:63], s45 offen sc1
    s_add_u32 s43, s43, 65536
    s_add_u32 s47, s47, 65536
    s_add_u32 s44, s44, 1024
    s_add_u32 s45, s45, 1024
    s_add_u32 m0, s46, 6144
    buffer_load_dwordx4 v[168:171], v11, s[60:63], s44 offen sc1
    buffer_load_dwordx4 v10, s[24:27], s43 offen lds
    buffer_load_dwordx4 v10, s[24:27], s47 offen offset:1024 lds
    buffer_load_dwordx4 v[172:175], v11, s[60:63], s45 offen sc1
    s_add_u32 s43, s43, 65536
    s_add_u32 s47, s47, 65536
    s_add_u32 s44, s44, 1024
    s_add_u32 s45, s45, 1024
    s_add_u32 m0, s46, 8192
    buffer_load_dwordx4 v[176:179], v11, s[60:63], s44 offen sc1
    buffer_load_dwordx4 v10, s[24:27], s43 offen lds
    buffer_load_dwordx4 v10, s[24:27], s47 offen offset:1024 lds
    buffer_load_dwordx4 v[180:183], v11, s[60:63], s45 offen sc1
    s_add_u32 s43, s43, 65536
    s_add_u32 s47, s47, 65536
    s_add_u32 s44, s44, 1024
    s_add_u32 s45, s45, 1024
    s_add_u32 m0, s46, 10240
    buffer_load_dwordx4 v[184:187], v11, s[60:63], s44 offen sc1
    buffer_load_dwordx4 v10, s[24:27], s43 offen lds
    buffer_load_dwordx4 v10, s[24:27], s47 offen offset:1024 lds
    buffer_load_dwordx4 v[188:191], v11, s[60:63], s45 offen sc1
    s_add_u32 s43, s43, 65536
    s_add_u32 s47, s47, 65536
    s_add_u32 s44, s44, 1024
    s_add_u32 s45, s45, 1024
    s_add_u32 m0, s46, 12288
    buffer_load_dwordx4 v[192:195], v11, s[60:63], s44 offen sc1
    buffer_load_dwordx4 v10, s[24:27], s43 offen lds
    buffer_load_dwordx4 v10, s[24:27], s47 offen offset:1024 lds
    buffer_load_dwordx4 v[196:199], v11, s[60:63], s45 offen sc1
    s_add_u32 s43, s43, 65536
    s_add_u32 s47, s47, 65536
    s_add_u32 s44, s44, 1024
    s_add_u32 s45, s45, 1024
    s_add_u32 m0, s46, 14336
    buffer_load_dwordx4 v[200:203], v11, s[60:63], s44 offen sc1
    buffer_load_dwordx4 v10, s[24:27], s43 offen lds
    buffer_load_dwordx4 v10, s[24:27], s47 offen offset:1024 lds
    buffer_load_dwordx4 v[204:207], v11, s[60:63], s45 offen sc1
    s_add_u32 s43, s43, 65536
    s_add_u32 s47, s47, 65536
    s_add_u32 s44, s44, 1024
    s_add_u32 s45, s45, 1024
    s_add_u32 m0, s46, 16384
    buffer_load_dwordx4 v[208:211], v11, s[60:63], s44 offen sc1
    buffer_load_dwordx4 v10, s[24:27], s43 offen lds
    buffer_load_dwordx4 v10, s[24:27], s47 offen offset:1024 lds
    buffer_load_dwordx4 v[212:215], v11, s[60:63], s45 offen sc1
    s_add_u32 s43, s43, 65536
    s_add_u32 s47, s47, 65536
    s_add_u32 s44, s44, 1024
    s_add_u32 s45, s45, 1024
    s_add_u32 m0, s46, 18432
    buffer_load_dwordx4 v[216:219], v11, s[60:63], s44 offen sc1
    buffer_load_dwordx4 v10, s[24:27], s43 offen lds
    buffer_load_dwordx4 v10, s[24:27], s47 offen offset:1024 lds
    buffer_load_dwordx4 v[220:223], v11, s[60:63], s45 offen sc1
    s_add_u32 s43, s43, 65536
    s_add_u32 s47, s47, 65536
    s_add_u32 s44, s44, 1024
    s_add_u32 s45, s45, 1024
    s_waitcnt lgkmcnt(0)
    s_mov_b32 s16, s8
    s_mov_b32 s17, s9
    s_mov_b32 s18, 4096
    s_mov_b32 s19, 0x00020000
    s_mov_b32 s20, s12
    s_mov_b32 s21, s13
    s_mov_b32 s22, 2097152
    s_mov_b32 s23, 0x00020000
    s_mov_b32 s28, s14
    s_mov_b32 s29, s15
    s_mov_b32 s30, 2097152
    s_mov_b32 s31, 0x00020000
    s_add_u32 s56, s48, 8388608
    s_addc_u32 s57, s49, 0
    s_mov_b32 s58, 16777216
    s_mov_b32 s59, 0x00020000
    s_lshl_b32 s54, s10, 16
    s_lshl_b32 s55, s11, 7
    s_add_u32 s54, s54, s55
    s_lshl_b32 s55, s10, 7
    s_lshl_b32 s53, s10, 16
    s_lshr_b32 s52, s11, 1
    s_lshl_b32 s52, s52, 14
    s_add_u32 s53, s53, s52
    s_and_b32 s52, s11, 1
    s_lshl_b32 s52, s52, 13
    s_add_u32 s53, s53, s52
    s_lshl_b32 s52, s42, 10
    s_add_u32 s53, s53, s52
    buffer_load_ushort v9, v15, s[16:19], s55 offen
    buffer_load_dwordx4 v[248:251], v2, s[20:23], s54 offen
    buffer_load_dwordx4 v[252:255], v2, s[20:23], s54 offen offset:64
    v_lshlrev_b32 v1, 4, v0
    s_lshl_b32 s14, s41, 16
    s_lshl_b32 s15, s42, 14
    s_add_u32 s14, s14, s15
    v_cvt_pk_bf16_f32 v16, v16, v17
    v_cvt_pk_bf16_f32 v17, v18, v19
    v_cvt_pk_bf16_f32 v18, v20, v21
    v_cvt_pk_bf16_f32 v19, v22, v23
    v_cvt_pk_bf16_f32 v20, v24, v25
    v_cvt_pk_bf16_f32 v21, v26, v27
    v_cvt_pk_bf16_f32 v22, v28, v29
    v_cvt_pk_bf16_f32 v23, v30, v31
    s_nop 1
    v_permlane32_swap_b32 v16, v18
    v_permlane32_swap_b32 v17, v19
    v_permlane32_swap_b32 v20, v22
    v_permlane32_swap_b32 v21, v23
    buffer_store_dwordx4 v[16:19], v1, s[36:39], s14 offen offset:0 sc1
    buffer_store_dwordx4 v[20:23], v1, s[36:39], s14 offen offset:1024 sc1
    v_cvt_pk_bf16_f32 v32, v32, v33
    v_cvt_pk_bf16_f32 v33, v34, v35
    v_cvt_pk_bf16_f32 v34, v36, v37
    v_cvt_pk_bf16_f32 v35, v38, v39
    v_cvt_pk_bf16_f32 v36, v40, v41
    v_cvt_pk_bf16_f32 v37, v42, v43
    v_cvt_pk_bf16_f32 v38, v44, v45
    v_cvt_pk_bf16_f32 v39, v46, v47
    s_nop 1
    v_permlane32_swap_b32 v32, v34
    v_permlane32_swap_b32 v33, v35
    v_permlane32_swap_b32 v36, v38
    v_permlane32_swap_b32 v37, v39
    buffer_store_dwordx4 v[32:35], v1, s[36:39], s14 offen offset:2048 sc1
    buffer_store_dwordx4 v[36:39], v1, s[36:39], s14 offen offset:3072 sc1
    s_add_u32 s14, s14, 4096
    v_cvt_pk_bf16_f32 v48, v48, v49
    v_cvt_pk_bf16_f32 v49, v50, v51
    v_cvt_pk_bf16_f32 v50, v52, v53
    v_cvt_pk_bf16_f32 v51, v54, v55
    v_cvt_pk_bf16_f32 v52, v56, v57
    v_cvt_pk_bf16_f32 v53, v58, v59
    v_cvt_pk_bf16_f32 v54, v60, v61
    v_cvt_pk_bf16_f32 v55, v62, v63
    s_nop 1
    v_permlane32_swap_b32 v48, v50
    v_permlane32_swap_b32 v49, v51
    v_permlane32_swap_b32 v52, v54
    v_permlane32_swap_b32 v53, v55
    buffer_store_dwordx4 v[48:51], v1, s[36:39], s14 offen offset:0 sc1
    buffer_store_dwordx4 v[52:55], v1, s[36:39], s14 offen offset:1024 sc1
    v_cvt_pk_bf16_f32 v64, v64, v65
    v_cvt_pk_bf16_f32 v65, v66, v67
    v_cvt_pk_bf16_f32 v66, v68, v69
    v_cvt_pk_bf16_f32 v67, v70, v71
    v_cvt_pk_bf16_f32 v68, v72, v73
    v_cvt_pk_bf16_f32 v69, v74, v75
    v_cvt_pk_bf16_f32 v70, v76, v77
    v_cvt_pk_bf16_f32 v71, v78, v79
    s_nop 1
    v_permlane32_swap_b32 v64, v66
    v_permlane32_swap_b32 v65, v67
    v_permlane32_swap_b32 v68, v70
    v_permlane32_swap_b32 v69, v71
    buffer_store_dwordx4 v[64:67], v1, s[36:39], s14 offen offset:2048 sc1
    buffer_store_dwordx4 v[68:71], v1, s[36:39], s14 offen offset:3072 sc1
    s_add_u32 s14, s14, 4096
    v_cvt_pk_bf16_f32 v80, v80, v81
    v_cvt_pk_bf16_f32 v81, v82, v83
    v_cvt_pk_bf16_f32 v82, v84, v85
    v_cvt_pk_bf16_f32 v83, v86, v87
    v_cvt_pk_bf16_f32 v84, v88, v89
    v_cvt_pk_bf16_f32 v85, v90, v91
    v_cvt_pk_bf16_f32 v86, v92, v93
    v_cvt_pk_bf16_f32 v87, v94, v95
    s_nop 1
    v_permlane32_swap_b32 v80, v82
    v_permlane32_swap_b32 v81, v83
    v_permlane32_swap_b32 v84, v86
    v_permlane32_swap_b32 v85, v87
    buffer_store_dwordx4 v[80:83], v1, s[36:39], s14 offen offset:0 sc1
    buffer_store_dwordx4 v[84:87], v1, s[36:39], s14 offen offset:1024 sc1
    v_cvt_pk_bf16_f32 v96, v96, v97
    v_cvt_pk_bf16_f32 v97, v98, v99
    v_cvt_pk_bf16_f32 v98, v100, v101
    v_cvt_pk_bf16_f32 v99, v102, v103
    v_cvt_pk_bf16_f32 v100, v104, v105
    v_cvt_pk_bf16_f32 v101, v106, v107
    v_cvt_pk_bf16_f32 v102, v108, v109
    v_cvt_pk_bf16_f32 v103, v110, v111
    s_nop 1
    v_permlane32_swap_b32 v96, v98
    v_permlane32_swap_b32 v97, v99
    v_permlane32_swap_b32 v100, v102
    v_permlane32_swap_b32 v101, v103
    buffer_store_dwordx4 v[96:99], v1, s[36:39], s14 offen offset:2048 sc1
    buffer_store_dwordx4 v[100:103], v1, s[36:39], s14 offen offset:3072 sc1
    s_add_u32 s14, s14, 4096
    v_cvt_pk_bf16_f32 v112, v112, v113
    v_cvt_pk_bf16_f32 v113, v114, v115
    v_cvt_pk_bf16_f32 v114, v116, v117
    v_cvt_pk_bf16_f32 v115, v118, v119
    v_cvt_pk_bf16_f32 v116, v120, v121
    v_cvt_pk_bf16_f32 v117, v122, v123
    v_cvt_pk_bf16_f32 v118, v124, v125
    v_cvt_pk_bf16_f32 v119, v126, v127
    s_nop 1
    v_permlane32_swap_b32 v112, v114
    v_permlane32_swap_b32 v113, v115
    v_permlane32_swap_b32 v116, v118
    v_permlane32_swap_b32 v117, v119
    buffer_store_dwordx4 v[112:115], v1, s[36:39], s14 offen offset:0 sc1
    buffer_store_dwordx4 v[116:119], v1, s[36:39], s14 offen offset:1024 sc1
    v_cvt_pk_bf16_f32 v128, v128, v129
    v_cvt_pk_bf16_f32 v129, v130, v131
    v_cvt_pk_bf16_f32 v130, v132, v133
    v_cvt_pk_bf16_f32 v131, v134, v135
    v_cvt_pk_bf16_f32 v132, v136, v137
    v_cvt_pk_bf16_f32 v133, v138, v139
    v_cvt_pk_bf16_f32 v134, v140, v141
    v_cvt_pk_bf16_f32 v135, v142, v143
    s_nop 1
    v_permlane32_swap_b32 v128, v130
    v_permlane32_swap_b32 v129, v131
    v_permlane32_swap_b32 v132, v134
    v_permlane32_swap_b32 v133, v135
    buffer_store_dwordx4 v[128:131], v1, s[36:39], s14 offen offset:2048 sc1
    buffer_store_dwordx4 v[132:135], v1, s[36:39], s14 offen offset:3072 sc1
    s_add_u32 s14, s14, 4096
    s_waitcnt vmcnt(56)
    ds_read_b64_tr_b16 v[128:129], v12 offset:0
    ds_read_b64_tr_b16 v[130:131], v12 offset:1024
    ds_read_b64_tr_b16 v[132:133], v13 offset:0
    ds_read_b64_tr_b16 v[134:135], v13 offset:1024
    s_waitcnt vmcnt(52) lgkmcnt(0)
    v_mfma_f32_32x32x16_bf16 v[64:79], v[144:147], v[128:131], 0
    ds_read_b64_tr_b16 v[136:137], v12 offset:2048
    ds_read_b64_tr_b16 v[138:139], v12 offset:3072
    v_mfma_f32_32x32x16_bf16 v[80:95], v[148:151], v[128:131], 0
    ds_read_b64_tr_b16 v[140:141], v13 offset:2048
    ds_read_b64_tr_b16 v[142:143], v13 offset:3072
    v_mfma_f32_32x32x16_bf16 v[96:111], v[144:147], v[132:135], 0
    s_add_u32 m0, s46, 20480
    buffer_load_dwordx4 v[224:227], v11, s[60:63], s44 offen sc1
    buffer_load_dwordx4 v10, s[24:27], s43 offen lds
    buffer_load_dwordx4 v10, s[24:27], s47 offen offset:1024 lds
    buffer_load_dwordx4 v[228:231], v11, s[60:63], s45 offen sc1
    s_add_u32 s43, s43, 65536
    s_add_u32 s47, s47, 65536
    s_add_u32 s44, s44, 1024
    s_add_u32 s45, s45, 1024
    v_mfma_f32_32x32x16_bf16 v[112:127], v[148:151], v[132:135], 0
    s_waitcnt vmcnt(52) lgkmcnt(0)
    v_mfma_f32_32x32x16_bf16 v[64:79], v[152:155], v[136:139], v[64:79]
    ds_read_b64_tr_b16 v[128:129], v12 offset:4096
    ds_read_b64_tr_b16 v[130:131], v12 offset:5120
    v_mfma_f32_32x32x16_bf16 v[80:95], v[156:159], v[136:139], v[80:95]
    ds_read_b64_tr_b16 v[132:133], v13 offset:4096
    ds_read_b64_tr_b16 v[134:135], v13 offset:5120
    v_mfma_f32_32x32x16_bf16 v[96:111], v[152:155], v[140:143], v[96:111]
    s_add_u32 m0, s46, 22528
    buffer_load_dwordx4 v[144:147], v11, s[60:63], s44 offen sc1
    buffer_load_dwordx4 v10, s[24:27], s43 offen lds
    buffer_load_dwordx4 v10, s[24:27], s47 offen offset:1024 lds
    buffer_load_dwordx4 v[148:151], v11, s[60:63], s45 offen sc1
    s_add_u32 s43, s43, 65536
    s_add_u32 s47, s47, 65536
    s_add_u32 s44, s44, 1024
    s_add_u32 s45, s45, 1024
    v_mfma_f32_32x32x16_bf16 v[112:127], v[156:159], v[140:143], v[112:127]
    s_waitcnt vmcnt(52) lgkmcnt(0)
    v_mfma_f32_32x32x16_bf16 v[64:79], v[160:163], v[128:131], v[64:79]
    ds_read_b64_tr_b16 v[136:137], v12 offset:6144
    ds_read_b64_tr_b16 v[138:139], v12 offset:7168
    v_mfma_f32_32x32x16_bf16 v[80:95], v[164:167], v[128:131], v[80:95]
    ds_read_b64_tr_b16 v[140:141], v13 offset:6144
    ds_read_b64_tr_b16 v[142:143], v13 offset:7168
    v_mfma_f32_32x32x16_bf16 v[96:111], v[160:163], v[132:135], v[96:111]
    s_add_u32 m0, s46, 0
    buffer_load_dwordx4 v[152:155], v11, s[60:63], s44 offen sc1
    buffer_load_dwordx4 v10, s[24:27], s43 offen lds
    buffer_load_dwordx4 v10, s[24:27], s47 offen offset:1024 lds
    buffer_load_dwordx4 v[156:159], v11, s[60:63], s45 offen sc1
    s_add_u32 s43, s43, 65536
    s_add_u32 s47, s47, 65536
    s_add_u32 s44, s44, 1024
    s_add_u32 s45, s45, 1024
    v_mfma_f32_32x32x16_bf16 v[112:127], v[164:167], v[132:135], v[112:127]
    s_waitcnt vmcnt(52) lgkmcnt(0)
    v_mfma_f32_32x32x16_bf16 v[64:79], v[168:171], v[136:139], v[64:79]
    ds_read_b64_tr_b16 v[128:129], v12 offset:8192
    ds_read_b64_tr_b16 v[130:131], v12 offset:9216
    v_mfma_f32_32x32x16_bf16 v[80:95], v[172:175], v[136:139], v[80:95]
    ds_read_b64_tr_b16 v[132:133], v13 offset:8192
    ds_read_b64_tr_b16 v[134:135], v13 offset:9216
    v_mfma_f32_32x32x16_bf16 v[96:111], v[168:171], v[140:143], v[96:111]
    s_add_u32 m0, s46, 2048
    buffer_load_dwordx4 v[160:163], v11, s[60:63], s44 offen sc1
    buffer_load_dwordx4 v10, s[24:27], s43 offen lds
    buffer_load_dwordx4 v10, s[24:27], s47 offen offset:1024 lds
    buffer_load_dwordx4 v[164:167], v11, s[60:63], s45 offen sc1
    s_add_u32 s43, s43, 65536
    s_add_u32 s47, s47, 65536
    s_add_u32 s44, s44, 1024
    s_add_u32 s45, s45, 1024
    v_mfma_f32_32x32x16_bf16 v[112:127], v[172:175], v[140:143], v[112:127]
    s_waitcnt vmcnt(52) lgkmcnt(0)
    v_mfma_f32_32x32x16_bf16 v[64:79], v[176:179], v[128:131], v[64:79]
    ds_read_b64_tr_b16 v[136:137], v12 offset:10240
    ds_read_b64_tr_b16 v[138:139], v12 offset:11264
    v_mfma_f32_32x32x16_bf16 v[80:95], v[180:183], v[128:131], v[80:95]
    ds_read_b64_tr_b16 v[140:141], v13 offset:10240
    ds_read_b64_tr_b16 v[142:143], v13 offset:11264
    v_mfma_f32_32x32x16_bf16 v[96:111], v[176:179], v[132:135], v[96:111]
    s_add_u32 m0, s46, 4096
    buffer_load_dwordx4 v[168:171], v11, s[60:63], s44 offen sc1
    buffer_load_dwordx4 v10, s[24:27], s43 offen lds
    buffer_load_dwordx4 v10, s[24:27], s47 offen offset:1024 lds
    buffer_load_dwordx4 v[172:175], v11, s[60:63], s45 offen sc1
    s_add_u32 s43, s43, 65536
    s_add_u32 s47, s47, 65536
    s_add_u32 s44, s44, 1024
    s_add_u32 s45, s45, 1024
    v_mfma_f32_32x32x16_bf16 v[112:127], v[180:183], v[132:135], v[112:127]
    s_waitcnt vmcnt(52) lgkmcnt(0)
    v_mfma_f32_32x32x16_bf16 v[64:79], v[184:187], v[136:139], v[64:79]
    ds_read_b64_tr_b16 v[128:129], v12 offset:12288
    ds_read_b64_tr_b16 v[130:131], v12 offset:13312
    v_mfma_f32_32x32x16_bf16 v[80:95], v[188:191], v[136:139], v[80:95]
    ds_read_b64_tr_b16 v[132:133], v13 offset:12288
    ds_read_b64_tr_b16 v[134:135], v13 offset:13312
    v_mfma_f32_32x32x16_bf16 v[96:111], v[184:187], v[140:143], v[96:111]
    s_add_u32 m0, s46, 6144
    buffer_load_dwordx4 v[176:179], v11, s[60:63], s44 offen sc1
    buffer_load_dwordx4 v10, s[24:27], s43 offen lds
    buffer_load_dwordx4 v10, s[24:27], s47 offen offset:1024 lds
    buffer_load_dwordx4 v[180:183], v11, s[60:63], s45 offen sc1
    s_add_u32 s43, s43, 65536
    s_add_u32 s47, s47, 65536
    s_add_u32 s44, s44, 1024
    s_add_u32 s45, s45, 1024
    v_mfma_f32_32x32x16_bf16 v[112:127], v[188:191], v[140:143], v[112:127]
    s_waitcnt vmcnt(52) lgkmcnt(0)
    v_mfma_f32_32x32x16_bf16 v[64:79], v[192:195], v[128:131], v[64:79]
    ds_read_b64_tr_b16 v[136:137], v12 offset:14336
    ds_read_b64_tr_b16 v[138:139], v12 offset:15360
    v_mfma_f32_32x32x16_bf16 v[80:95], v[196:199], v[128:131], v[80:95]
    ds_read_b64_tr_b16 v[140:141], v13 offset:14336
    ds_read_b64_tr_b16 v[142:143], v13 offset:15360
    v_mfma_f32_32x32x16_bf16 v[96:111], v[192:195], v[132:135], v[96:111]
    s_add_u32 m0, s46, 8192
    buffer_load_dwordx4 v[184:187], v11, s[60:63], s44 offen sc1
    buffer_load_dwordx4 v10, s[24:27], s43 offen lds
    buffer_load_dwordx4 v10, s[24:27], s47 offen offset:1024 lds
    buffer_load_dwordx4 v[188:191], v11, s[60:63], s45 offen sc1
    s_add_u32 s43, s43, 65536
    s_add_u32 s47, s47, 65536
    s_add_u32 s44, s44, 1024
    s_add_u32 s45, s45, 1024
    v_mfma_f32_32x32x16_bf16 v[112:127], v[196:199], v[132:135], v[112:127]
    s_waitcnt vmcnt(52) lgkmcnt(0)
    v_mfma_f32_32x32x16_bf16 v[64:79], v[200:203], v[136:139], v[64:79]
    ds_read_b64_tr_b16 v[128:129], v12 offset:16384
    ds_read_b64_tr_b16 v[130:131], v12 offset:17408
    v_mfma_f32_32x32x16_bf16 v[80:95], v[204:207], v[136:139], v[80:95]
    ds_read_b64_tr_b16 v[132:133], v13 offset:16384
    ds_read_b64_tr_b16 v[134:135], v13 offset:17408
    v_mfma_f32_32x32x16_bf16 v[96:111], v[200:203], v[140:143], v[96:111]
    s_add_u32 m0, s46, 10240
    buffer_load_dwordx4 v[192:195], v11, s[60:63], s44 offen sc1
    buffer_load_dwordx4 v10, s[24:27], s43 offen lds
    buffer_load_dwordx4 v10, s[24:27], s47 offen offset:1024 lds
    buffer_load_dwordx4 v[196:199], v11, s[60:63], s45 offen sc1
    s_add_u32 s43, s43, 65536
    s_add_u32 s47, s47, 65536
    s_add_u32 s44, s44, 1024
    s_add_u32 s45, s45, 1024
    s_waitcnt vmcnt(32)
    s_barrier
    s_lshl_b32 s52, s41, 8
    s_add_u32 s52, s52, 6291456
    s_cmp_lg_u32 s42, 0
    s_cbranch_scc1 L_sig_slab
    v_mov_b32 v1, 0
    v_mov_b32 v4, 1
    v_cmp_eq_u32 vcc, 0, v0
    s_and_saveexec_b64 s[48:49], vcc
    buffer_atomic_add v4, v1, s[60:63], s52 offen
    s_mov_b64 exec, s[48:49]
L_sig_slab:
    v_mfma_f32_32x32x16_bf16 v[112:127], v[204:207], v[140:143], v[112:127]
    s_waitcnt lgkmcnt(0)
    v_mfma_f32_32x32x16_bf16 v[64:79], v[208:211], v[128:131], v[64:79]
    ds_read_b64_tr_b16 v[136:137], v12 offset:18432
    ds_read_b64_tr_b16 v[138:139], v12 offset:19456
    v_mfma_f32_32x32x16_bf16 v[80:95], v[212:215], v[128:131], v[80:95]
    ds_read_b64_tr_b16 v[140:141], v13 offset:18432
    ds_read_b64_tr_b16 v[142:143], v13 offset:19456
    v_mfma_f32_32x32x16_bf16 v[96:111], v[208:211], v[132:135], v[96:111]
    s_add_u32 m0, s46, 12288
    buffer_load_dwordx4 v[200:203], v11, s[60:63], s44 offen sc1
    buffer_load_dwordx4 v10, s[24:27], s43 offen lds
    buffer_load_dwordx4 v10, s[24:27], s47 offen offset:1024 lds
    buffer_load_dwordx4 v[204:207], v11, s[60:63], s45 offen sc1
    s_add_u32 s43, s43, 65536
    s_add_u32 s47, s47, 65536
    s_add_u32 s44, s44, 1024
    s_add_u32 s45, s45, 1024
    v_mfma_f32_32x32x16_bf16 v[112:127], v[212:215], v[132:135], v[112:127]
    s_waitcnt vmcnt(33) lgkmcnt(0)
    v_mfma_f32_32x32x16_bf16 v[64:79], v[216:219], v[136:139], v[64:79]
    ds_read_b64_tr_b16 v[128:129], v12 offset:20480
    ds_read_b64_tr_b16 v[130:131], v12 offset:21504
    v_mfma_f32_32x32x16_bf16 v[80:95], v[220:223], v[136:139], v[80:95]
    ds_read_b64_tr_b16 v[132:133], v13 offset:20480
    ds_read_b64_tr_b16 v[134:135], v13 offset:21504
    v_mfma_f32_32x32x16_bf16 v[96:111], v[216:219], v[140:143], v[96:111]
    s_add_u32 m0, s46, 14336
    buffer_load_dwordx4 v[208:211], v11, s[60:63], s44 offen sc1
    buffer_load_dwordx4 v10, s[24:27], s43 offen lds
    buffer_load_dwordx4 v10, s[24:27], s47 offen offset:1024 lds
    buffer_load_dwordx4 v[212:215], v11, s[60:63], s45 offen sc1
    s_add_u32 s43, s43, 65536
    s_add_u32 s47, s47, 65536
    s_add_u32 s44, s44, 1024
    s_add_u32 s45, s45, 1024
    v_mfma_f32_32x32x16_bf16 v[112:127], v[220:223], v[140:143], v[112:127]
    s_waitcnt vmcnt(33) lgkmcnt(0)
    v_mfma_f32_32x32x16_bf16 v[64:79], v[224:227], v[128:131], v[64:79]
    ds_read_b64_tr_b16 v[136:137], v12 offset:22528
    ds_read_b64_tr_b16 v[138:139], v12 offset:23552
    v_mfma_f32_32x32x16_bf16 v[80:95], v[228:231], v[128:131], v[80:95]
    ds_read_b64_tr_b16 v[140:141], v13 offset:22528
    ds_read_b64_tr_b16 v[142:143], v13 offset:23552
    v_mfma_f32_32x32x16_bf16 v[96:111], v[224:227], v[132:135], v[96:111]
    s_add_u32 m0, s46, 16384
    buffer_load_dwordx4 v[216:219], v11, s[60:63], s44 offen sc1
    buffer_load_dwordx4 v10, s[24:27], s43 offen lds
    buffer_load_dwordx4 v10, s[24:27], s47 offen offset:1024 lds
    buffer_load_dwordx4 v[220:223], v11, s[60:63], s45 offen sc1
    s_add_u32 s43, s43, 65536
    s_add_u32 s47, s47, 65536
    s_add_u32 s44, s44, 1024
    s_add_u32 s45, s45, 1024
    v_mfma_f32_32x32x16_bf16 v[112:127], v[228:231], v[132:135], v[112:127]
    s_waitcnt vmcnt(33) lgkmcnt(0)
    v_mfma_f32_32x32x16_bf16 v[64:79], v[144:147], v[136:139], v[64:79]
    ds_read_b64_tr_b16 v[128:129], v12 offset:0
    ds_read_b64_tr_b16 v[130:131], v12 offset:1024
    v_mfma_f32_32x32x16_bf16 v[80:95], v[148:151], v[136:139], v[80:95]
    ds_read_b64_tr_b16 v[132:133], v13 offset:0
    ds_read_b64_tr_b16 v[134:135], v13 offset:1024
    v_mfma_f32_32x32x16_bf16 v[96:111], v[144:147], v[140:143], v[96:111]
    s_add_u32 m0, s46, 18432
    buffer_load_dwordx4 v[224:227], v11, s[60:63], s44 offen sc1
    buffer_load_dwordx4 v10, s[24:27], s43 offen lds
    buffer_load_dwordx4 v10, s[24:27], s47 offen offset:1024 lds
    buffer_load_dwordx4 v[228:231], v11, s[60:63], s45 offen sc1
    s_add_u32 s43, s43, 65536
    s_add_u32 s47, s47, 65536
    s_add_u32 s44, s44, 1024
    s_add_u32 s45, s45, 1024
    s_lshl_b32 s52, s10, 8
    s_add_u32 s52, s52, 6291456
    s_cmp_lg_u32 s42, 0
    s_cbranch_scc1 L_slab_nopoll
    s_mov_b32 s51, 1048576
    v_mov_b32 v1, 0
L_poll_slab:
    buffer_load_dword v4, v1, s[60:63], s52 offen sc1
    s_waitcnt vmcnt(0)
    v_readfirstlane_b32 s3, v4
    s_cmp_ge_u32 s3, 8
    s_cbranch_scc1 L_polld_slab
    s_sleep 16
    s_sub_u32 s51, s51, 1
    s_cmp_lg_u32 s51, 0
    s_cbranch_scc1 L_poll_slab
L_polld_slab:
L_slab_nopoll:
    s_barrier
    s_add_u32 s52, s53, 0
    buffer_load_dwordx4 v[16:19], v11, s[56:59], s52 offen sc1
    v_mfma_f32_32x32x16_bf16 v[112:127], v[148:151], v[140:143], v[112:127]
    s_waitcnt vmcnt(34) lgkmcnt(0)
    v_mfma_f32_32x32x16_bf16 v[64:79], v[152:155], v[128:131], v[64:79]
    ds_read_b64_tr_b16 v[136:137], v12 offset:2048
    ds_read_b64_tr_b16 v[138:139], v12 offset:3072
    v_mfma_f32_32x32x16_bf16 v[80:95], v[156:159], v[128:131], v[80:95]
    ds_read_b64_tr_b16 v[140:141], v13 offset:2048
    ds_read_b64_tr_b16 v[142:143], v13 offset:3072
    v_mfma_f32_32x32x16_bf16 v[96:111], v[152:155], v[132:135], v[96:111]
    s_add_u32 m0, s46, 20480
    buffer_load_dwordx4 v[144:147], v11, s[60:63], s44 offen sc1
    buffer_load_dwordx4 v10, s[24:27], s43 offen lds
    buffer_load_dwordx4 v10, s[24:27], s47 offen offset:1024 lds
    buffer_load_dwordx4 v[148:151], v11, s[60:63], s45 offen sc1
    s_add_u32 s43, s43, 65536
    s_add_u32 s47, s47, 65536
    s_add_u32 s44, s44, 1024
    s_add_u32 s45, s45, 1024
    s_add_u32 s52, s53, 4096
    buffer_load_dwordx4 v[20:23], v11, s[56:59], s52 offen sc1
    v_mfma_f32_32x32x16_bf16 v[112:127], v[156:159], v[132:135], v[112:127]
    s_waitcnt vmcnt(35) lgkmcnt(0)
    v_mfma_f32_32x32x16_bf16 v[64:79], v[160:163], v[136:139], v[64:79]
    ds_read_b64_tr_b16 v[128:129], v12 offset:4096
    ds_read_b64_tr_b16 v[130:131], v12 offset:5120
    v_mfma_f32_32x32x16_bf16 v[80:95], v[164:167], v[136:139], v[80:95]
    ds_read_b64_tr_b16 v[132:133], v13 offset:4096
    ds_read_b64_tr_b16 v[134:135], v13 offset:5120
    v_mfma_f32_32x32x16_bf16 v[96:111], v[160:163], v[140:143], v[96:111]
    s_add_u32 m0, s46, 22528
    buffer_load_dwordx4 v[152:155], v11, s[60:63], s44 offen sc1
    buffer_load_dwordx4 v10, s[24:27], s43 offen lds
    buffer_load_dwordx4 v10, s[24:27], s47 offen offset:1024 lds
    buffer_load_dwordx4 v[156:159], v11, s[60:63], s45 offen sc1
    s_add_u32 s43, s43, 65536
    s_add_u32 s47, s47, 65536
    s_add_u32 s44, s44, 1024
    s_add_u32 s45, s45, 1024
    s_add_u32 s52, s53, 2097152
    buffer_load_dwordx4 v[24:27], v11, s[56:59], s52 offen sc1
    v_mfma_f32_32x32x16_bf16 v[112:127], v[164:167], v[140:143], v[112:127]
    s_waitcnt vmcnt(36) lgkmcnt(0)
    v_mfma_f32_32x32x16_bf16 v[64:79], v[168:171], v[128:131], v[64:79]
    ds_read_b64_tr_b16 v[136:137], v12 offset:6144
    ds_read_b64_tr_b16 v[138:139], v12 offset:7168
    v_mfma_f32_32x32x16_bf16 v[80:95], v[172:175], v[128:131], v[80:95]
    ds_read_b64_tr_b16 v[140:141], v13 offset:6144
    ds_read_b64_tr_b16 v[142:143], v13 offset:7168
    v_mfma_f32_32x32x16_bf16 v[96:111], v[168:171], v[132:135], v[96:111]
    s_add_u32 m0, s46, 0
    buffer_load_dwordx4 v[160:163], v11, s[60:63], s44 offen sc1
    buffer_load_dwordx4 v10, s[24:27], s43 offen lds
    buffer_load_dwordx4 v10, s[24:27], s47 offen offset:1024 lds
    buffer_load_dwordx4 v[164:167], v11, s[60:63], s45 offen sc1
    s_add_u32 s43, s43, 65536
    s_add_u32 s47, s47, 65536
    s_add_u32 s44, s44, 1024
    s_add_u32 s45, s45, 1024
    s_add_u32 s52, s53, 2101248
    buffer_load_dwordx4 v[28:31], v11, s[56:59], s52 offen sc1
    v_mfma_f32_32x32x16_bf16 v[112:127], v[172:175], v[132:135], v[112:127]
    s_waitcnt vmcnt(37) lgkmcnt(0)
    v_mfma_f32_32x32x16_bf16 v[64:79], v[176:179], v[136:139], v[64:79]
    ds_read_b64_tr_b16 v[128:129], v12 offset:8192
    ds_read_b64_tr_b16 v[130:131], v12 offset:9216
    v_mfma_f32_32x32x16_bf16 v[80:95], v[180:183], v[136:139], v[80:95]
    ds_read_b64_tr_b16 v[132:133], v13 offset:8192
    ds_read_b64_tr_b16 v[134:135], v13 offset:9216
    v_mfma_f32_32x32x16_bf16 v[96:111], v[176:179], v[140:143], v[96:111]
    s_add_u32 m0, s46, 2048
    buffer_load_dwordx4 v[168:171], v11, s[60:63], s44 offen sc1
    buffer_load_dwordx4 v10, s[24:27], s43 offen lds
    buffer_load_dwordx4 v10, s[24:27], s47 offen offset:1024 lds
    buffer_load_dwordx4 v[172:175], v11, s[60:63], s45 offen sc1
    s_add_u32 s43, s43, 65536
    s_add_u32 s47, s47, 65536
    s_add_u32 s44, s44, 1024
    s_add_u32 s45, s45, 1024
    s_add_u32 s52, s53, 4194304
    buffer_load_dwordx4 v[32:35], v11, s[56:59], s52 offen sc1
    v_mfma_f32_32x32x16_bf16 v[112:127], v[180:183], v[140:143], v[112:127]
    s_waitcnt vmcnt(38) lgkmcnt(0)
    v_mfma_f32_32x32x16_bf16 v[64:79], v[184:187], v[128:131], v[64:79]
    ds_read_b64_tr_b16 v[136:137], v12 offset:10240
    ds_read_b64_tr_b16 v[138:139], v12 offset:11264
    v_mfma_f32_32x32x16_bf16 v[80:95], v[188:191], v[128:131], v[80:95]
    ds_read_b64_tr_b16 v[140:141], v13 offset:10240
    ds_read_b64_tr_b16 v[142:143], v13 offset:11264
    v_mfma_f32_32x32x16_bf16 v[96:111], v[184:187], v[132:135], v[96:111]
    s_add_u32 m0, s46, 4096
    buffer_load_dwordx4 v[176:179], v11, s[60:63], s44 offen sc1
    buffer_load_dwordx4 v10, s[24:27], s43 offen lds
    buffer_load_dwordx4 v10, s[24:27], s47 offen offset:1024 lds
    buffer_load_dwordx4 v[180:183], v11, s[60:63], s45 offen sc1
    s_add_u32 s43, s43, 65536
    s_add_u32 s47, s47, 65536
    s_add_u32 s44, s44, 1024
    s_add_u32 s45, s45, 1024
    s_add_u32 s52, s53, 4198400
    buffer_load_dwordx4 v[36:39], v11, s[56:59], s52 offen sc1
    v_mfma_f32_32x32x16_bf16 v[112:127], v[188:191], v[132:135], v[112:127]
    s_waitcnt vmcnt(39) lgkmcnt(0)
    v_mfma_f32_32x32x16_bf16 v[64:79], v[192:195], v[136:139], v[64:79]
    ds_read_b64_tr_b16 v[128:129], v12 offset:12288
    ds_read_b64_tr_b16 v[130:131], v12 offset:13312
    v_mfma_f32_32x32x16_bf16 v[80:95], v[196:199], v[136:139], v[80:95]
    ds_read_b64_tr_b16 v[132:133], v13 offset:12288
    ds_read_b64_tr_b16 v[134:135], v13 offset:13312
    v_mfma_f32_32x32x16_bf16 v[96:111], v[192:195], v[140:143], v[96:111]
    s_add_u32 m0, s46, 6144
    buffer_load_dwordx4 v[184:187], v11, s[60:63], s44 offen sc1
    buffer_load_dwordx4 v10, s[24:27], s43 offen lds
    buffer_load_dwordx4 v10, s[24:27], s47 offen offset:1024 lds
    buffer_load_dwordx4 v[188:191], v11, s[60:63], s45 offen sc1
    s_add_u32 s43, s43, 65536
    s_add_u32 s47, s47, 65536
    s_add_u32 s44, s44, 1024
    s_add_u32 s45, s45, 1024
    s_add_u32 s52, s53, 6291456
    buffer_load_dwordx4 v[40:43], v11, s[56:59], s52 offen sc1
    v_mfma_f32_32x32x16_bf16 v[112:127], v[196:199], v[140:143], v[112:127]
    s_waitcnt vmcnt(40) lgkmcnt(0)
    v_mfma_f32_32x32x16_bf16 v[64:79], v[200:203], v[128:131], v[64:79]
    ds_read_b64_tr_b16 v[136:137], v12 offset:14336
    ds_read_b64_tr_b16 v[138:139], v12 offset:15360
    v_mfma_f32_32x32x16_bf16 v[80:95], v[204:207], v[128:131], v[80:95]
    ds_read_b64_tr_b16 v[140:141], v13 offset:14336
    ds_read_b64_tr_b16 v[142:143], v13 offset:15360
    v_mfma_f32_32x32x16_bf16 v[96:111], v[200:203], v[132:135], v[96:111]
    s_add_u32 s52, s53, 6295552
    buffer_load_dwordx4 v[44:47], v11, s[56:59], s52 offen sc1
    s_waitcnt vmcnt(31)
    v_lshlrev_b32 v232, 16, v16
    v_and_b32 v233, 0xffff0000, v16
    v_lshlrev_b32 v234, 16, v17
    v_and_b32 v235, 0xffff0000, v17
    v_lshlrev_b32 v236, 16, v18
    v_and_b32 v237, 0xffff0000, v18
    v_lshlrev_b32 v238, 16, v19
    v_and_b32 v239, 0xffff0000, v19
    v_mfma_f32_32x32x16_bf16 v[112:127], v[204:207], v[132:135], v[112:127]
    s_waitcnt lgkmcnt(0)
    v_mfma_f32_32x32x16_bf16 v[64:79], v[208:211], v[136:139], v[64:79]
    ds_read_b64_tr_b16 v[128:129], v12 offset:16384
    ds_read_b64_tr_b16 v[130:131], v12 offset:17408
    v_mfma_f32_32x32x16_bf16 v[80:95], v[212:215], v[136:139], v[80:95]
    ds_read_b64_tr_b16 v[132:133], v13 offset:16384
    ds_read_b64_tr_b16 v[134:135], v13 offset:17408
    v_mfma_f32_32x32x16_bf16 v[96:111], v[208:211], v[140:143], v[96:111]
    s_add_u32 s52, s53, 8388608
    buffer_load_dwordx4 v[48:51], v11, s[56:59], s52 offen sc1
    s_waitcnt vmcnt(27)
    v_lshlrev_b32 v240, 16, v20
    v_and_b32 v241, 0xffff0000, v20
    v_lshlrev_b32 v242, 16, v21
    v_and_b32 v243, 0xffff0000, v21
    v_lshlrev_b32 v244, 16, v22
    v_and_b32 v245, 0xffff0000, v22
    v_lshlrev_b32 v246, 16, v23
    v_and_b32 v247, 0xffff0000, v23
    v_mfma_f32_32x32x16_bf16 v[112:127], v[212:215], v[140:143], v[112:127]
    s_waitcnt lgkmcnt(0)
    v_mfma_f32_32x32x16_bf16 v[64:79], v[216:219], v[128:131], v[64:79]
    ds_read_b64_tr_b16 v[136:137], v12 offset:18432
    ds_read_b64_tr_b16 v[138:139], v12 offset:19456
    v_mfma_f32_32x32x16_bf16 v[80:95], v[220:223], v[128:131], v[80:95]
    ds_read_b64_tr_b16 v[140:141], v13 offset:18432
    ds_read_b64_tr_b16 v[142:143], v13 offset:19456
    v_mfma_f32_32x32x16_bf16 v[96:111], v[216:219], v[132:135], v[96:111]
    s_add_u32 s52, s53, 8392704
    buffer_load_dwordx4 v[52:55], v11, s[56:59], s52 offen sc1
    s_waitcnt vmcnt(23)
    v_lshlrev_b32 v4, 16, v24
    v_and_b32 v5, 0xffff0000, v24
    v_pk_add_f32 v[232:233], v[232:233], v[4:5]
    v_lshlrev_b32 v6, 16, v25
    v_and_b32 v7, 0xffff0000, v25
    v_pk_add_f32 v[234:235], v[234:235], v[6:7]
    v_lshlrev_b32 v4, 16, v26
    v_and_b32 v5, 0xffff0000, v26
    v_pk_add_f32 v[236:237], v[236:237], v[4:5]
    v_lshlrev_b32 v6, 16, v27
    v_and_b32 v7, 0xffff0000, v27
    v_pk_add_f32 v[238:239], v[238:239], v[6:7]
    v_mfma_f32_32x32x16_bf16 v[112:127], v[220:223], v[132:135], v[112:127]
    s_waitcnt lgkmcnt(0)
    v_mfma_f32_32x32x16_bf16 v[64:79], v[224:227], v[136:139], v[64:79]
    ds_read_b64_tr_b16 v[128:129], v12 offset:20480
    ds_read_b64_tr_b16 v[130:131], v12 offset:21504
    v_mfma_f32_32x32x16_bf16 v[80:95], v[228:231], v[136:139], v[80:95]
    ds_read_b64_tr_b16 v[132:133], v13 offset:20480
    ds_read_b64_tr_b16 v[134:135], v13 offset:21504
    v_mfma_f32_32x32x16_bf16 v[96:111], v[224:227], v[140:143], v[96:111]
    s_add_u32 s52, s53, 10485760
    buffer_load_dwordx4 v[56:59], v11, s[56:59], s52 offen sc1
    s_waitcnt vmcnt(19)
    v_lshlrev_b32 v4, 16, v28
    v_and_b32 v5, 0xffff0000, v28
    v_pk_add_f32 v[240:241], v[240:241], v[4:5]
    v_lshlrev_b32 v6, 16, v29
    v_and_b32 v7, 0xffff0000, v29
    v_pk_add_f32 v[242:243], v[242:243], v[6:7]
    v_lshlrev_b32 v4, 16, v30
    v_and_b32 v5, 0xffff0000, v30
    v_pk_add_f32 v[244:245], v[244:245], v[4:5]
    v_lshlrev_b32 v6, 16, v31
    v_and_b32 v7, 0xffff0000, v31
    v_pk_add_f32 v[246:247], v[246:247], v[6:7]
    v_mfma_f32_32x32x16_bf16 v[112:127], v[228:231], v[140:143], v[112:127]
    s_waitcnt lgkmcnt(0)
    v_mfma_f32_32x32x16_bf16 v[64:79], v[144:147], v[128:131], v[64:79]
    ds_read_b64_tr_b16 v[136:137], v12 offset:22528
    ds_read_b64_tr_b16 v[138:139], v12 offset:23552
    v_mfma_f32_32x32x16_bf16 v[80:95], v[148:151], v[128:131], v[80:95]
    ds_read_b64_tr_b16 v[140:141], v13 offset:22528
    ds_read_b64_tr_b16 v[142:143], v13 offset:23552
    v_mfma_f32_32x32x16_bf16 v[96:111], v[144:147], v[132:135], v[96:111]
    s_add_u32 s52, s53, 10489856
    buffer_load_dwordx4 v[60:63], v11, s[56:59], s52 offen sc1
    s_waitcnt vmcnt(15)
    v_lshlrev_b32 v4, 16, v32
    v_and_b32 v5, 0xffff0000, v32
    v_pk_add_f32 v[232:233], v[232:233], v[4:5]
    v_lshlrev_b32 v6, 16, v33
    v_and_b32 v7, 0xffff0000, v33
    v_pk_add_f32 v[234:235], v[234:235], v[6:7]
    v_lshlrev_b32 v4, 16, v34
    v_and_b32 v5, 0xffff0000, v34
    v_pk_add_f32 v[236:237], v[236:237], v[4:5]
    v_lshlrev_b32 v6, 16, v35
    v_and_b32 v7, 0xffff0000, v35
    v_pk_add_f32 v[238:239], v[238:239], v[6:7]
    v_mfma_f32_32x32x16_bf16 v[112:127], v[148:151], v[132:135], v[112:127]
    s_waitcnt lgkmcnt(0)
    v_mfma_f32_32x32x16_bf16 v[64:79], v[152:155], v[136:139], v[64:79]
    ds_read_b64_tr_b16 v[128:129], v12 offset:0
    ds_read_b64_tr_b16 v[130:131], v12 offset:1024
    v_mfma_f32_32x32x16_bf16 v[80:95], v[156:159], v[136:139], v[80:95]
    ds_read_b64_tr_b16 v[132:133], v13 offset:0
    ds_read_b64_tr_b16 v[134:135], v13 offset:1024
    v_mfma_f32_32x32x16_bf16 v[96:111], v[152:155], v[140:143], v[96:111]
    s_add_u32 s52, s53, 12582912
    buffer_load_dwordx4 v[16:19], v11, s[56:59], s52 offen sc1
    s_waitcnt vmcnt(11)
    v_lshlrev_b32 v4, 16, v36
    v_and_b32 v5, 0xffff0000, v36
    v_pk_add_f32 v[240:241], v[240:241], v[4:5]
    v_lshlrev_b32 v6, 16, v37
    v_and_b32 v7, 0xffff0000, v37
    v_pk_add_f32 v[242:243], v[242:243], v[6:7]
    v_lshlrev_b32 v4, 16, v38
    v_and_b32 v5, 0xffff0000, v38
    v_pk_add_f32 v[244:245], v[244:245], v[4:5]
    v_lshlrev_b32 v6, 16, v39
    v_and_b32 v7, 0xffff0000, v39
    v_pk_add_f32 v[246:247], v[246:247], v[6:7]
    v_mfma_f32_32x32x16_bf16 v[112:127], v[156:159], v[140:143], v[112:127]
    s_waitcnt lgkmcnt(0)
    v_mfma_f32_32x32x16_bf16 v[64:79], v[160:163], v[128:131], v[64:79]
    ds_read_b64_tr_b16 v[136:137], v12 offset:2048
    ds_read_b64_tr_b16 v[138:139], v12 offset:3072
    v_mfma_f32_32x32x16_bf16 v[80:95], v[164:167], v[128:131], v[80:95]
    ds_read_b64_tr_b16 v[140:141], v13 offset:2048
    ds_read_b64_tr_b16 v[142:143], v13 offset:3072
    v_mfma_f32_32x32x16_bf16 v[96:111], v[160:163], v[132:135], v[96:111]
    s_add_u32 s52, s53, 12587008
    buffer_load_dwordx4 v[20:23], v11, s[56:59], s52 offen sc1
    s_waitcnt vmcnt(7)
    v_lshlrev_b32 v4, 16, v40
    v_and_b32 v5, 0xffff0000, v40
    v_pk_add_f32 v[232:233], v[232:233], v[4:5]
    v_lshlrev_b32 v6, 16, v41
    v_and_b32 v7, 0xffff0000, v41
    v_pk_add_f32 v[234:235], v[234:235], v[6:7]
    v_lshlrev_b32 v4, 16, v42
    v_and_b32 v5, 0xffff0000, v42
    v_pk_add_f32 v[236:237], v[236:237], v[4:5]
    v_lshlrev_b32 v6, 16, v43
    v_and_b32 v7, 0xffff0000, v43
    v_pk_add_f32 v[238:239], v[238:239], v[6:7]
    v_mfma_f32_32x32x16_bf16 v[112:127], v[164:167], v[132:135], v[112:127]
    s_waitcnt lgkmcnt(0)
    v_mfma_f32_32x32x16_bf16 v[64:79], v[168:171], v[136:139], v[64:79]
    ds_read_b64_tr_b16 v[128:129], v12 offset:4096
    ds_read_b64_tr_b16 v[130:131], v12 offset:5120
    v_mfma_f32_32x32x16_bf16 v[80:95], v[172:175], v[136:139], v[80:95]
    ds_read_b64_tr_b16 v[132:133], v13 offset:4096
    ds_read_b64_tr_b16 v[134:135], v13 offset:5120
    v_mfma_f32_32x32x16_bf16 v[96:111], v[168:171], v[140:143], v[96:111]
    s_add_u32 s52, s53, 14680064
    buffer_load_dwordx4 v[24:27], v11, s[56:59], s52 offen sc1
    s_waitcnt vmcnt(7)
    v_lshlrev_b32 v4, 16, v44
    v_and_b32 v5, 0xffff0000, v44
    v_pk_add_f32 v[240:241], v[240:241], v[4:5]
    v_lshlrev_b32 v6, 16, v45
    v_and_b32 v7, 0xffff0000, v45
    v_pk_add_f32 v[242:243], v[242:243], v[6:7]
    v_lshlrev_b32 v4, 16, v46
    v_and_b32 v5, 0xffff0000, v46
    v_pk_add_f32 v[244:245], v[244:245], v[4:5]
    v_lshlrev_b32 v6, 16, v47
    v_and_b32 v7, 0xffff0000, v47
    v_pk_add_f32 v[246:247], v[246:247], v[6:7]
    v_mfma_f32_32x32x16_bf16 v[112:127], v[172:175], v[140:143], v[112:127]
    s_waitcnt lgkmcnt(0)
    v_mfma_f32_32x32x16_bf16 v[64:79], v[176:179], v[128:131], v[64:79]
    ds_read_b64_tr_b16 v[136:137], v12 offset:6144
    ds_read_b64_tr_b16 v[138:139], v12 offset:7168
    v_mfma_f32_32x32x16_bf16 v[80:95], v[180:183], v[128:131], v[80:95]
    ds_read_b64_tr_b16 v[140:141], v13 offset:6144
    ds_read_b64_tr_b16 v[142:143], v13 offset:7168
    v_mfma_f32_32x32x16_bf16 v[96:111], v[176:179], v[132:135], v[96:111]
    s_add_u32 s52, s53, 14684160
    buffer_load_dwordx4 v[28:31], v11, s[56:59], s52 offen sc1
    s_waitcnt vmcnt(7)
    v_lshlrev_b32 v4, 16, v48
    v_and_b32 v5, 0xffff0000, v48
    v_pk_add_f32 v[232:233], v[232:233], v[4:5]
    v_lshlrev_b32 v6, 16, v49
    v_and_b32 v7, 0xffff0000, v49
    v_pk_add_f32 v[234:235], v[234:235], v[6:7]
    v_lshlrev_b32 v4, 16, v50
    v_and_b32 v5, 0xffff0000, v50
    v_pk_add_f32 v[236:237], v[236:237], v[4:5]
    v_lshlrev_b32 v6, 16, v51
    v_and_b32 v7, 0xffff0000, v51
    v_pk_add_f32 v[238:239], v[238:239], v[6:7]
    v_mfma_f32_32x32x16_bf16 v[112:127], v[180:183], v[132:135], v[112:127]
    s_waitcnt lgkmcnt(0)
    v_mfma_f32_32x32x16_bf16 v[64:79], v[184:187], v[136:139], v[64:79]
    v_mfma_f32_32x32x16_bf16 v[80:95], v[188:191], v[136:139], v[80:95]
    v_mfma_f32_32x32x16_bf16 v[96:111], v[184:187], v[140:143], v[96:111]
    s_waitcnt vmcnt(6)
    v_lshlrev_b32 v4, 16, v52
    v_and_b32 v5, 0xffff0000, v52
    v_pk_add_f32 v[240:241], v[240:241], v[4:5]
    v_lshlrev_b32 v6, 16, v53
    v_and_b32 v7, 0xffff0000, v53
    v_pk_add_f32 v[242:243], v[242:243], v[6:7]
    v_lshlrev_b32 v4, 16, v54
    v_and_b32 v5, 0xffff0000, v54
    v_pk_add_f32 v[244:245], v[244:245], v[4:5]
    v_lshlrev_b32 v6, 16, v55
    v_and_b32 v7, 0xffff0000, v55
    v_pk_add_f32 v[246:247], v[246:247], v[6:7]
    v_mfma_f32_32x32x16_bf16 v[112:127], v[188:191], v[140:143], v[112:127]
    v_and_b32 v3, 31, v0
    s_movk_i32 s52, 272
    v_mul_lo_u32 v3, v3, s52
    v_lshrrev_b32 v4, 5, v0
    v_lshl_add_u32 v3, v4, 4, v3
    s_mul_i32 s55, s42, 17408
    v_add_u32 v3, s55, v3
    v_mul_lo_u32 v8, v14, s52
    v_lshl_add_u32 v8, v4, 5, v8
    s_and_b32 s52, s42, 1
    s_lshl_b32 s52, s52, 6
    v_add_u32 v8, s52, v8
    s_barrier
    ds_write_b128 v3, v[64:67] offset:0
    ds_write_b128 v3, v[68:71] offset:32
    ds_write_b128 v3, v[72:75] offset:64
    ds_write_b128 v3, v[76:79] offset:96
    ds_write_b128 v3, v[80:83] offset:128
    ds_write_b128 v3, v[84:87] offset:160
    ds_write_b128 v3, v[88:91] offset:192
    ds_write_b128 v3, v[92:95] offset:224
    ds_write_b128 v3, v[96:99] offset:8704
    ds_write_b128 v3, v[100:103] offset:8736
    ds_write_b128 v3, v[104:107] offset:8768
    ds_write_b128 v3, v[108:111] offset:8800
    ds_write_b128 v3, v[112:115] offset:8832
    ds_write_b128 v3, v[116:119] offset:8864
    ds_write_b128 v3, v[120:123] offset:8896
    ds_write_b128 v3, v[124:127] offset:8928
    s_waitcnt lgkmcnt(0)
    s_barrier
    ds_read_b128 v[64:67], v8 offset:0
    ds_read_b128 v[68:71], v8 offset:16
    ds_read_b128 v[72:75], v8 offset:17408
    ds_read_b128 v[76:79], v8 offset:17424
    ds_read_b128 v[80:83], v8 offset:34816
    ds_read_b128 v[84:87], v8 offset:34832
    ds_read_b128 v[88:91], v8 offset:52224
    ds_read_b128 v[92:95], v8 offset:52240
    ds_read_b128 v[96:99], v8 offset:128
    ds_read_b128 v[100:103], v8 offset:144
    ds_read_b128 v[104:107], v8 offset:17536
    ds_read_b128 v[108:111], v8 offset:17552
    ds_read_b128 v[112:115], v8 offset:34944
    ds_read_b128 v[116:119], v8 offset:34960
    ds_read_b128 v[120:123], v8 offset:52352
    ds_read_b128 v[124:127], v8 offset:52368
    s_waitcnt vmcnt(5)
    v_lshlrev_b32 v4, 16, v56
    v_and_b32 v5, 0xffff0000, v56
    v_pk_add_f32 v[232:233], v[232:233], v[4:5]
    v_lshlrev_b32 v6, 16, v57
    v_and_b32 v7, 0xffff0000, v57
    v_pk_add_f32 v[234:235], v[234:235], v[6:7]
    v_lshlrev_b32 v4, 16, v58
    v_and_b32 v5, 0xffff0000, v58
    v_pk_add_f32 v[236:237], v[236:237], v[4:5]
    v_lshlrev_b32 v6, 16, v59
    v_and_b32 v7, 0xffff0000, v59
    v_pk_add_f32 v[238:239], v[238:239], v[6:7]
    s_waitcnt vmcnt(4)
    v_lshlrev_b32 v4, 16, v60
    v_and_b32 v5, 0xffff0000, v60
    v_pk_add_f32 v[240:241], v[240:241], v[4:5]
    v_lshlrev_b32 v6, 16, v61
    v_and_b32 v7, 0xffff0000, v61
    v_pk_add_f32 v[242:243], v[242:243], v[6:7]
    v_lshlrev_b32 v4, 16, v62
    v_and_b32 v5, 0xffff0000, v62
    v_pk_add_f32 v[244:245], v[244:245], v[4:5]
    v_lshlrev_b32 v6, 16, v63
    v_and_b32 v7, 0xffff0000, v63
    v_pk_add_f32 v[246:247], v[246:247], v[6:7]
    s_waitcnt vmcnt(3)
    v_lshlrev_b32 v4, 16, v16
    v_and_b32 v5, 0xffff0000, v16
    v_pk_add_f32 v[232:233], v[232:233], v[4:5]
    v_lshlrev_b32 v6, 16, v17
    v_and_b32 v7, 0xffff0000, v17
    v_pk_add_f32 v[234:235], v[234:235], v[6:7]
    v_lshlrev_b32 v4, 16, v18
    v_and_b32 v5, 0xffff0000, v18
    v_pk_add_f32 v[236:237], v[236:237], v[4:5]
    v_lshlrev_b32 v6, 16, v19
    v_and_b32 v7, 0xffff0000, v19
    v_pk_add_f32 v[238:239], v[238:239], v[6:7]
    s_waitcnt vmcnt(2)
    v_lshlrev_b32 v4, 16, v20
    v_and_b32 v5, 0xffff0000, v20
    v_pk_add_f32 v[240:241], v[240:241], v[4:5]
    v_lshlrev_b32 v6, 16, v21
    v_and_b32 v7, 0xffff0000, v21
    v_pk_add_f32 v[242:243], v[242:243], v[6:7]
    v_lshlrev_b32 v4, 16, v22
    v_and_b32 v5, 0xffff0000, v22
    v_pk_add_f32 v[244:245], v[244:245], v[4:5]
    v_lshlrev_b32 v6, 16, v23
    v_and_b32 v7, 0xffff0000, v23
    v_pk_add_f32 v[246:247], v[246:247], v[6:7]
    s_waitcnt vmcnt(1)
    v_lshlrev_b32 v4, 16, v24
    v_and_b32 v5, 0xffff0000, v24
    v_pk_add_f32 v[232:233], v[232:233], v[4:5]
    v_lshlrev_b32 v6, 16, v25
    v_and_b32 v7, 0xffff0000, v25
    v_pk_add_f32 v[234:235], v[234:235], v[6:7]
    v_lshlrev_b32 v4, 16, v26
    v_and_b32 v5, 0xffff0000, v26
    v_pk_add_f32 v[236:237], v[236:237], v[4:5]
    v_lshlrev_b32 v6, 16, v27
    v_and_b32 v7, 0xffff0000, v27
    v_pk_add_f32 v[238:239], v[238:239], v[6:7]
    s_waitcnt vmcnt(0)
    v_lshlrev_b32 v4, 16, v28
    v_and_b32 v5, 0xffff0000, v28
    v_pk_add_f32 v[240:241], v[240:241], v[4:5]
    v_lshlrev_b32 v6, 16, v29
    v_and_b32 v7, 0xffff0000, v29
    v_pk_add_f32 v[242:243], v[242:243], v[6:7]
    v_lshlrev_b32 v4, 16, v30
    v_and_b32 v5, 0xffff0000, v30
    v_pk_add_f32 v[244:245], v[244:245], v[4:5]
    v_lshlrev_b32 v6, 16, v31
    v_and_b32 v7, 0xffff0000, v31
    v_pk_add_f32 v[246:247], v[246:247], v[6:7]
    v_lshlrev_b32 v128, 16, v248
    v_and_b32 v129, 0xffff0000, v248
    v_lshlrev_b32 v130, 16, v249
    v_and_b32 v131, 0xffff0000, v249
    v_lshlrev_b32 v132, 16, v250
    v_and_b32 v133, 0xffff0000, v250
    v_lshlrev_b32 v134, 16, v251
    v_and_b32 v135, 0xffff0000, v251
    v_lshlrev_b32 v136, 16, v252
    v_and_b32 v137, 0xffff0000, v252
    v_lshlrev_b32 v138, 16, v253
    v_and_b32 v139, 0xffff0000, v253
    v_lshlrev_b32 v140, 16, v254
    v_and_b32 v141, 0xffff0000, v254
    v_lshlrev_b32 v142, 16, v255
    v_and_b32 v143, 0xffff0000, v255
    v_lshlrev_b32 v18, 16, v9
    v_mov_b32 v19, v18
    s_mov_b32 s48, 0xbfb8aa3b
    s_mov_b32 s49, 0xbfb8aa3b
    s_waitcnt lgkmcnt(0)
    v_pk_add_f32 v[64:65], v[64:65], v[72:73]
    v_pk_add_f32 v[80:81], v[80:81], v[88:89]
    v_pk_add_f32 v[66:67], v[66:67], v[74:75]
    v_pk_add_f32 v[82:83], v[82:83], v[90:91]
    v_pk_add_f32 v[68:69], v[68:69], v[76:77]
    v_pk_add_f32 v[84:85], v[84:85], v[92:93]
    v_pk_add_f32 v[70:71], v[70:71], v[78:79]
    v_pk_add_f32 v[86:87], v[86:87], v[94:95]
    v_pk_add_f32 v[64:65], v[64:65], v[80:81]
    v_pk_add_f32 v[66:67], v[66:67], v[82:83]
    v_pk_add_f32 v[68:69], v[68:69], v[84:85]
    v_pk_add_f32 v[70:71], v[70:71], v[86:87]
    v_pk_add_f32 v[64:65], v[64:65], v[18:19]
    v_pk_add_f32 v[66:67], v[66:67], v[18:19]
    v_pk_add_f32 v[68:69], v[68:69], v[18:19]
    v_pk_add_f32 v[70:71], v[70:71], v[18:19]
    v_pk_add_f32 v[96:97], v[96:97], v[104:105]
    v_pk_add_f32 v[112:113], v[112:113], v[120:121]
    v_pk_add_f32 v[98:99], v[98:99], v[106:107]
    v_pk_add_f32 v[114:115], v[114:115], v[122:123]
    v_pk_add_f32 v[100:101], v[100:101], v[108:109]
    v_pk_add_f32 v[116:117], v[116:117], v[124:125]
    v_pk_add_f32 v[102:103], v[102:103], v[110:111]
    v_pk_add_f32 v[118:119], v[118:119], v[126:127]
    v_pk_add_f32 v[96:97], v[96:97], v[112:113]
    v_pk_add_f32 v[98:99], v[98:99], v[114:115]
    v_pk_add_f32 v[100:101], v[100:101], v[116:117]
    v_pk_add_f32 v[102:103], v[102:103], v[118:119]
    v_pk_add_f32 v[96:97], v[96:97], v[18:19]
    v_pk_add_f32 v[98:99], v[98:99], v[18:19]
    v_pk_add_f32 v[100:101], v[100:101], v[18:19]
    v_pk_add_f32 v[102:103], v[102:103], v[18:19]
    v_pk_mul_f32 v[72:73], v[64:65], s[48:49]
    v_pk_mul_f32 v[74:75], v[66:67], s[48:49]
    v_pk_mul_f32 v[76:77], v[68:69], s[48:49]
    v_pk_mul_f32 v[78:79], v[70:71], s[48:49]
    v_pk_mul_f32 v[104:105], v[96:97], s[48:49]
    v_pk_mul_f32 v[106:107], v[98:99], s[48:49]
    v_pk_mul_f32 v[108:109], v[100:101], s[48:49]
    v_pk_mul_f32 v[110:111], v[102:103], s[48:49]
    v_exp_f32 v72, v72
    v_exp_f32 v73, v73
    v_exp_f32 v74, v74
    v_exp_f32 v75, v75
    v_exp_f32 v76, v76
    v_exp_f32 v77, v77
    v_exp_f32 v78, v78
    v_exp_f32 v79, v79
    v_exp_f32 v104, v104
    v_exp_f32 v105, v105
    v_exp_f32 v106, v106
    v_exp_f32 v107, v107
    v_exp_f32 v108, v108
    v_exp_f32 v109, v109
    v_exp_f32 v110, v110
    v_exp_f32 v111, v111
    v_add_f32 v72, 1.0, v72
    v_add_f32 v73, 1.0, v73
    v_add_f32 v74, 1.0, v74
    v_add_f32 v75, 1.0, v75
    v_add_f32 v76, 1.0, v76
    v_add_f32 v77, 1.0, v77
    v_add_f32 v78, 1.0, v78
    v_add_f32 v79, 1.0, v79
    v_add_f32 v104, 1.0, v104
    v_add_f32 v105, 1.0, v105
    v_add_f32 v106, 1.0, v106
    v_add_f32 v107, 1.0, v107
    v_add_f32 v108, 1.0, v108
    v_add_f32 v109, 1.0, v109
    v_add_f32 v110, 1.0, v110
    v_add_f32 v111, 1.0, v111
    v_rcp_f32 v72, v72
    v_rcp_f32 v73, v73
    v_rcp_f32 v74, v74
    v_rcp_f32 v75, v75
    v_rcp_f32 v76, v76
    v_rcp_f32 v77, v77
    v_rcp_f32 v78, v78
    v_rcp_f32 v79, v79
    v_rcp_f32 v104, v104
    v_rcp_f32 v105, v105
    v_rcp_f32 v106, v106
    v_rcp_f32 v107, v107
    v_rcp_f32 v108, v108
    v_rcp_f32 v109, v109
    v_rcp_f32 v110, v110
    v_rcp_f32 v111, v111
    s_nop 0
    v_pk_mul_f32 v[64:65], v[64:65], v[72:73]
    v_pk_mul_f32 v[66:67], v[66:67], v[74:75]
    v_pk_mul_f32 v[68:69], v[68:69], v[76:77]
    v_pk_mul_f32 v[70:71], v[70:71], v[78:79]
    v_pk_mul_f32 v[96:97], v[96:97], v[104:105]
    v_pk_mul_f32 v[98:99], v[98:99], v[106:107]
    v_pk_mul_f32 v[100:101], v[100:101], v[108:109]
    v_pk_mul_f32 v[102:103], v[102:103], v[110:111]
    v_pk_fma_f32 v[64:65], v[64:65], v[232:233], v[128:129]
    v_pk_fma_f32 v[66:67], v[66:67], v[234:235], v[130:131]
    v_pk_fma_f32 v[68:69], v[68:69], v[236:237], v[132:133]
    v_pk_fma_f32 v[70:71], v[70:71], v[238:239], v[134:135]
    v_pk_fma_f32 v[96:97], v[96:97], v[240:241], v[136:137]
    v_pk_fma_f32 v[98:99], v[98:99], v[242:243], v[138:139]
    v_pk_fma_f32 v[100:101], v[100:101], v[244:245], v[140:141]
    v_pk_fma_f32 v[102:103], v[102:103], v[246:247], v[142:143]
    v_cvt_pk_bf16_f32 v40, v64, v65
    v_cvt_pk_bf16_f32 v41, v66, v67
    v_cvt_pk_bf16_f32 v42, v68, v69
    v_cvt_pk_bf16_f32 v43, v70, v71
    buffer_store_dwordx4 v[40:43], v2, s[28:31], s54 offen offset:0
    v_cvt_pk_bf16_f32 v44, v96, v97
    v_cvt_pk_bf16_f32 v45, v98, v99
    v_cvt_pk_bf16_f32 v46, v100, v101
    v_cvt_pk_bf16_f32 v47, v102, v103
    buffer_store_dwordx4 v[44:47], v2, s[28:31], s54 offen offset:64
L_at_done:
    s_endpgm
L_rare_s0:
    s_call_b64 s[52:53], L_raresub_0
    s_branch L_back_s0
L_rare_m1:
    s_call_b64 s[52:53], L_raresub_1
    s_branch L_back_m1
L_rare_m2:
    s_call_b64 s[52:53], L_raresub_0
    s_branch L_back_m2
L_rare_m3:
    s_call_b64 s[52:53], L_raresub_1
    s_branch L_back_m3
L_rare_m4:
    s_call_b64 s[52:53], L_raresub_0
    s_branch L_back_m4
L_rare_m5:
    s_call_b64 s[52:53], L_raresub_1
    s_branch L_back_m5
L_rare_m6:
    s_call_b64 s[52:53], L_raresub_0
    s_branch L_back_m6
L_rare_m7:
    s_call_b64 s[52:53], L_raresub_1
    s_branch L_back_m7
L_rare_m8:
    s_call_b64 s[52:53], L_raresub_0
    s_branch L_back_m8
L_rare_t57:
    s_call_b64 s[52:53], L_raresub_1
    s_branch L_back_t57
L_rare_t58:
    s_call_b64 s[52:53], L_raresub_0
    s_branch L_back_t58
L_rare_t59:
    s_call_b64 s[52:53], L_raresub_1
    s_branch L_back_t59
L_rare_t60:
    s_call_b64 s[52:53], L_raresub_0
    s_branch L_back_t60
L_rare_t61:
    s_call_b64 s[52:53], L_raresub_1
    s_branch L_back_t61
L_rare_t62:
    s_call_b64 s[52:53], L_raresub_0
    s_branch L_back_t62
L_rare_t63:
    s_call_b64 s[52:53], L_raresub_1
    s_branch L_back_t63
L_raresub_0:
    s_nop 15
    s_nop 7
    v_max3_f32 v1, v16, v17, v18
    v_max3_f32 v1, v1, v19, v20
    v_max3_f32 v1, v1, v21, v22
    v_max3_f32 v1, v1, v23, v24
    v_max3_f32 v1, v1, v25, v26
    v_max3_f32 v1, v1, v27, v28
    v_max3_f32 v1, v1, v29, v30
    v_max_f32 v1, v1, v31
    v_mov_b32 v2, v1
    s_nop 1
    v_permlane32_swap_b32 v2, v1
    v_max_f32 v1, v1, v2
    v_add_f32 v1, 0x42d00000, v1
    v_max_f32 v1, 0, v1
    v_exp_f32 v3, -v1
    s_nop 0
    v_mul_f32 v220, v220, v3
    v_accvgpr_read_b32 v4, a0
    v_mul_f32 v4, v4, v3
    v_accvgpr_write_b32 a0, v4
    v_accvgpr_read_b32 v5, a1
    v_mul_f32 v5, v5, v3
    v_accvgpr_write_b32 a1, v5
    v_accvgpr_read_b32 v6, a2
    v_mul_f32 v6, v6, v3
    v_accvgpr_write_b32 a2, v6
    v_accvgpr_read_b32 v7, a3
    v_mul_f32 v7, v7, v3
    v_accvgpr_write_b32 a3, v7
    v_accvgpr_read_b32 v4, a4
    v_mul_f32 v4, v4, v3
    v_accvgpr_write_b32 a4, v4
    v_accvgpr_read_b32 v5, a5
    v_mul_f32 v5, v5, v3
    v_accvgpr_write_b32 a5, v5
    v_accvgpr_read_b32 v6, a6
    v_mul_f32 v6, v6, v3
    v_accvgpr_write_b32 a6, v6
    v_accvgpr_read_b32 v7, a7
    v_mul_f32 v7, v7, v3
    v_accvgpr_write_b32 a7, v7
    v_accvgpr_read_b32 v4, a8
    v_mul_f32 v4, v4, v3
    v_accvgpr_write_b32 a8, v4
    v_accvgpr_read_b32 v5, a9
    v_mul_f32 v5, v5, v3
    v_accvgpr_write_b32 a9, v5
    v_accvgpr_read_b32 v6, a10
    v_mul_f32 v6, v6, v3
    v_accvgpr_write_b32 a10, v6
    v_accvgpr_read_b32 v7, a11
    v_mul_f32 v7, v7, v3
    v_accvgpr_write_b32 a11, v7
    v_accvgpr_read_b32 v4, a12
    v_mul_f32 v4, v4, v3
    v_accvgpr_write_b32 a12, v4
    v_accvgpr_read_b32 v5, a13
    v_mul_f32 v5, v5, v3
    v_accvgpr_write_b32 a13, v5
    v_accvgpr_read_b32 v6, a14
    v_mul_f32 v6, v6, v3
    v_accvgpr_write_b32 a14, v6
    v_accvgpr_read_b32 v7, a15
    v_mul_f32 v7, v7, v3
    v_accvgpr_write_b32 a15, v7
    v_accvgpr_read_b32 v4, a32
    v_mul_f32 v4, v4, v3
    v_accvgpr_write_b32 a32, v4
    v_accvgpr_read_b32 v5, a33
    v_mul_f32 v5, v5, v3
    v_accvgpr_write_b32 a33, v5
    v_accvgpr_read_b32 v6, a34
    v_mul_f32 v6, v6, v3
    v_accvgpr_write_b32 a34, v6
    v_accvgpr_read_b32 v7, a35
    v_mul_f32 v7, v7, v3
    v_accvgpr_write_b32 a35, v7
    v_accvgpr_read_b32 v4, a36
    v_mul_f32 v4, v4, v3
    v_accvgpr_write_b32 a36, v4
    v_accvgpr_read_b32 v5, a37
    v_mul_f32 v5, v5, v3
    v_accvgpr_write_b32 a37, v5
    v_accvgpr_read_b32 v6, a38
    v_mul_f32 v6, v6, v3
    v_accvgpr_write_b32 a38, v6
    v_accvgpr_read_b32 v7, a39
    v_mul_f32 v7, v7, v3
    v_accvgpr_write_b32 a39, v7
    v_accvgpr_read_b32 v4, a40
    v_mul_f32 v4, v4, v3
    v_accvgpr_write_b32 a40, v4
    v_accvgpr_read_b32 v5, a41
    v_mul_f32 v5, v5, v3
    v_accvgpr_write_b32 a41, v5
    v_accvgpr_read_b32 v6, a42
    v_mul_f32 v6, v6, v3
    v_accvgpr_write_b32 a42, v6
    v_accvgpr_read_b32 v7, a43
    v_mul_f32 v7, v7, v3
    v_accvgpr_write_b32 a43, v7
    v_accvgpr_read_b32 v4, a44
    v_mul_f32 v4, v4, v3
    v_accvgpr_write_b32 a44, v4
    v_accvgpr_read_b32 v5, a45
    v_mul_f32 v5, v5, v3
    v_accvgpr_write_b32 a45, v5
    v_accvgpr_read_b32 v6, a46
    v_mul_f32 v6, v6, v3
    v_accvgpr_write_b32 a46, v6
    v_accvgpr_read_b32 v7, a47
    v_mul_f32 v7, v7, v3
    v_accvgpr_write_b32 a47, v7
    v_accvgpr_read_b32 v4, a64
    v_mul_f32 v4, v4, v3
    v_accvgpr_write_b32 a64, v4
    v_accvgpr_read_b32 v5, a65
    v_mul_f32 v5, v5, v3
    v_accvgpr_write_b32 a65, v5
    v_accvgpr_read_b32 v6, a66
    v_mul_f32 v6, v6, v3
    v_accvgpr_write_b32 a66, v6
    v_accvgpr_read_b32 v7, a67
    v_mul_f32 v7, v7, v3
    v_accvgpr_write_b32 a67, v7
    v_accvgpr_read_b32 v4, a68
    v_mul_f32 v4, v4, v3
    v_accvgpr_write_b32 a68, v4
    v_accvgpr_read_b32 v5, a69
    v_mul_f32 v5, v5, v3
    v_accvgpr_write_b32 a69, v5
    v_accvgpr_read_b32 v6, a70
    v_mul_f32 v6, v6, v3
    v_accvgpr_write_b32 a70, v6
    v_accvgpr_read_b32 v7, a71
    v_mul_f32 v7, v7, v3
    v_accvgpr_write_b32 a71, v7
    v_accvgpr_read_b32 v4, a72
    v_mul_f32 v4, v4, v3
    v_accvgpr_write_b32 a72, v4
    v_accvgpr_read_b32 v5, a73
    v_mul_f32 v5, v5, v3
    v_accvgpr_write_b32 a73, v5
    v_accvgpr_read_b32 v6, a74
    v_mul_f32 v6, v6, v3
    v_accvgpr_write_b32 a74, v6
    v_accvgpr_read_b32 v7, a75
    v_mul_f32 v7, v7, v3
    v_accvgpr_write_b32 a75, v7
    v_accvgpr_read_b32 v4, a76
    v_mul_f32 v4, v4, v3
    v_accvgpr_write_b32 a76, v4
    v_accvgpr_read_b32 v5, a77
    v_mul_f32 v5, v5, v3
    v_accvgpr_write_b32 a77, v5
    v_accvgpr_read_b32 v6, a78
    v_mul_f32 v6, v6, v3
    v_accvgpr_write_b32 a78, v6
    v_accvgpr_read_b32 v7, a79
    v_mul_f32 v7, v7, v3
    v_accvgpr_write_b32 a79, v7
    v_accvgpr_read_b32 v4, a96
    v_mul_f32 v4, v4, v3
    v_accvgpr_write_b32 a96, v4
    v_accvgpr_read_b32 v5, a97
    v_mul_f32 v5, v5, v3
    v_accvgpr_write_b32 a97, v5
    v_accvgpr_read_b32 v6, a98
    v_mul_f32 v6, v6, v3
    v_accvgpr_write_b32 a98, v6
    v_accvgpr_read_b32 v7, a99
    v_mul_f32 v7, v7, v3
    v_accvgpr_write_b32 a99, v7
    v_accvgpr_read_b32 v4, a100
    v_mul_f32 v4, v4, v3
    v_accvgpr_write_b32 a100, v4
    v_accvgpr_read_b32 v5, a101
    v_mul_f32 v5, v5, v3
    v_accvgpr_write_b32 a101, v5
    v_accvgpr_read_b32 v6, a102
    v_mul_f32 v6, v6, v3
    v_accvgpr_write_b32 a102, v6
    v_accvgpr_read_b32 v7, a103
    v_mul_f32 v7, v7, v3
    v_accvgpr_write_b32 a103, v7
    v_accvgpr_read_b32 v4, a104
    v_mul_f32 v4, v4, v3
    v_accvgpr_write_b32 a104, v4
    v_accvgpr_read_b32 v5, a105
    v_mul_f32 v5, v5, v3
    v_accvgpr_write_b32 a105, v5
    v_accvgpr_read_b32 v6, a106
    v_mul_f32 v6, v6, v3
    v_accvgpr_write_b32 a106, v6
    v_accvgpr_read_b32 v7, a107
    v_mul_f32 v7, v7, v3
    v_accvgpr_write_b32 a107, v7
    v_accvgpr_read_b32 v4, a108
    v_mul_f32 v4, v4, v3
    v_accvgpr_write_b32 a108, v4
    v_accvgpr_read_b32 v5, a109
    v_mul_f32 v5, v5, v3
    v_accvgpr_write_b32 a109, v5
    v_accvgpr_read_b32 v6, a110
    v_mul_f32 v6, v6, v3
    v_accvgpr_write_b32 a110, v6
    v_accvgpr_read_b32 v7, a111
    v_mul_f32 v7, v7, v3
    v_accvgpr_write_b32 a111, v7
    v_sub_f32 v80, v80, v1
    v_sub_f32 v48, v48, v1
    v_sub_f32 v16, v16, v1
    v_sub_f32 v81, v81, v1
    v_sub_f32 v49, v49, v1
    v_sub_f32 v17, v17, v1
    v_sub_f32 v82, v82, v1
    v_sub_f32 v50, v50, v1
    v_sub_f32 v18, v18, v1
    v_sub_f32 v83, v83, v1
    v_sub_f32 v51, v51, v1
    v_sub_f32 v19, v19, v1
    v_sub_f32 v84, v84, v1
    v_sub_f32 v52, v52, v1
    v_sub_f32 v20, v20, v1
    v_sub_f32 v85, v85, v1
    v_sub_f32 v53, v53, v1
    v_sub_f32 v21, v21, v1
    v_sub_f32 v86, v86, v1
    v_sub_f32 v54, v54, v1
    v_sub_f32 v22, v22, v1
    v_sub_f32 v87, v87, v1
    v_sub_f32 v55, v55, v1
    v_sub_f32 v23, v23, v1
    v_sub_f32 v88, v88, v1
    v_sub_f32 v56, v56, v1
    v_sub_f32 v24, v24, v1
    v_sub_f32 v89, v89, v1
    v_sub_f32 v57, v57, v1
    v_sub_f32 v25, v25, v1
    v_sub_f32 v90, v90, v1
    v_sub_f32 v58, v58, v1
    v_sub_f32 v26, v26, v1
    v_sub_f32 v91, v91, v1
    v_sub_f32 v59, v59, v1
    v_sub_f32 v27, v27, v1
    v_sub_f32 v92, v92, v1
    v_sub_f32 v60, v60, v1
    v_sub_f32 v28, v28, v1
    v_sub_f32 v93, v93, v1
    v_sub_f32 v61, v61, v1
    v_sub_f32 v29, v29, v1
    v_sub_f32 v94, v94, v1
    v_sub_f32 v62, v62, v1
    v_sub_f32 v30, v30, v1
    v_sub_f32 v95, v95, v1
    v_sub_f32 v63, v63, v1
    v_sub_f32 v31, v31, v1
    v_exp_f32 v208, v16
    v_exp_f32 v209, v17
    s_nop 0
    v_add_f32 v216, v208, v209
    v_cvt_pk_bf16_f32 v112, v208, v209
    v_exp_f32 v208, v18
    v_exp_f32 v209, v19
    s_nop 0
    v_add_f32 v216, v216, v208
    v_add_f32 v216, v216, v209
    v_cvt_pk_bf16_f32 v113, v208, v209
    v_exp_f32 v208, v20
    v_exp_f32 v209, v21
    s_nop 0
    v_add_f32 v216, v216, v208
    v_add_f32 v216, v216, v209
    v_cvt_pk_bf16_f32 v114, v208, v209
    v_exp_f32 v208, v22
    v_exp_f32 v209, v23
    s_nop 0
    v_add_f32 v216, v216, v208
    v_add_f32 v216, v216, v209
    v_cvt_pk_bf16_f32 v115, v208, v209
    v_exp_f32 v208, v24
    v_exp_f32 v209, v25
    s_nop 0
    v_add_f32 v216, v216, v208
    v_add_f32 v216, v216, v209
    v_cvt_pk_bf16_f32 v116, v208, v209
    v_exp_f32 v208, v26
    v_exp_f32 v209, v27
    s_nop 0
    v_add_f32 v216, v216, v208
    v_add_f32 v216, v216, v209
    v_cvt_pk_bf16_f32 v117, v208, v209
    v_exp_f32 v208, v28
    v_exp_f32 v209, v29
    s_nop 0
    v_add_f32 v216, v216, v208
    v_add_f32 v216, v216, v209
    v_cvt_pk_bf16_f32 v118, v208, v209
    v_exp_f32 v208, v30
    v_exp_f32 v209, v31
    s_nop 0
    v_add_f32 v216, v216, v208
    v_add_f32 v216, v216, v209
    v_cvt_pk_bf16_f32 v119, v208, v209
    v_max3_f32 v1, v32, v33, v34
    v_max3_f32 v1, v1, v35, v36
    v_max3_f32 v1, v1, v37, v38
    v_max3_f32 v1, v1, v39, v40
    v_max3_f32 v1, v1, v41, v42
    v_max3_f32 v1, v1, v43, v44
    v_max3_f32 v1, v1, v45, v46
    v_max_f32 v1, v1, v47
    v_mov_b32 v2, v1
    s_nop 1
    v_permlane32_swap_b32 v2, v1
    v_max_f32 v1, v1, v2
    v_add_f32 v1, 0x42d00000, v1
    v_max_f32 v1, 0, v1
    v_exp_f32 v3, -v1
    s_nop 0
    v_mul_f32 v221, v221, v3
    v_accvgpr_read_b32 v4, a16
    v_mul_f32 v4, v4, v3
    v_accvgpr_write_b32 a16, v4
    v_accvgpr_read_b32 v5, a17
    v_mul_f32 v5, v5, v3
    v_accvgpr_write_b32 a17, v5
    v_accvgpr_read_b32 v6, a18
    v_mul_f32 v6, v6, v3
    v_accvgpr_write_b32 a18, v6
    v_accvgpr_read_b32 v7, a19
    v_mul_f32 v7, v7, v3
    v_accvgpr_write_b32 a19, v7
    v_accvgpr_read_b32 v4, a20
    v_mul_f32 v4, v4, v3
    v_accvgpr_write_b32 a20, v4
    v_accvgpr_read_b32 v5, a21
    v_mul_f32 v5, v5, v3
    v_accvgpr_write_b32 a21, v5
    v_accvgpr_read_b32 v6, a22
    v_mul_f32 v6, v6, v3
    v_accvgpr_write_b32 a22, v6
    v_accvgpr_read_b32 v7, a23
    v_mul_f32 v7, v7, v3
    v_accvgpr_write_b32 a23, v7
    v_accvgpr_read_b32 v4, a24
    v_mul_f32 v4, v4, v3
    v_accvgpr_write_b32 a24, v4
    v_accvgpr_read_b32 v5, a25
    v_mul_f32 v5, v5, v3
    v_accvgpr_write_b32 a25, v5
    v_accvgpr_read_b32 v6, a26
    v_mul_f32 v6, v6, v3
    v_accvgpr_write_b32 a26, v6
    v_accvgpr_read_b32 v7, a27
    v_mul_f32 v7, v7, v3
    v_accvgpr_write_b32 a27, v7
    v_accvgpr_read_b32 v4, a28
    v_mul_f32 v4, v4, v3
    v_accvgpr_write_b32 a28, v4
    v_accvgpr_read_b32 v5, a29
    v_mul_f32 v5, v5, v3
    v_accvgpr_write_b32 a29, v5
    v_accvgpr_read_b32 v6, a30
    v_mul_f32 v6, v6, v3
    v_accvgpr_write_b32 a30, v6
    v_accvgpr_read_b32 v7, a31
    v_mul_f32 v7, v7, v3
    v_accvgpr_write_b32 a31, v7
    v_accvgpr_read_b32 v4, a48
    v_mul_f32 v4, v4, v3
    v_accvgpr_write_b32 a48, v4
    v_accvgpr_read_b32 v5, a49
    v_mul_f32 v5, v5, v3
    v_accvgpr_write_b32 a49, v5
    v_accvgpr_read_b32 v6, a50
    v_mul_f32 v6, v6, v3
    v_accvgpr_write_b32 a50, v6
    v_accvgpr_read_b32 v7, a51
    v_mul_f32 v7, v7, v3
    v_accvgpr_write_b32 a51, v7
    v_accvgpr_read_b32 v4, a52
    v_mul_f32 v4, v4, v3
    v_accvgpr_write_b32 a52, v4
    v_accvgpr_read_b32 v5, a53
    v_mul_f32 v5, v5, v3
    v_accvgpr_write_b32 a53, v5
    v_accvgpr_read_b32 v6, a54
    v_mul_f32 v6, v6, v3
    v_accvgpr_write_b32 a54, v6
    v_accvgpr_read_b32 v7, a55
    v_mul_f32 v7, v7, v3
    v_accvgpr_write_b32 a55, v7
    v_accvgpr_read_b32 v4, a56
    v_mul_f32 v4, v4, v3
    v_accvgpr_write_b32 a56, v4
    v_accvgpr_read_b32 v5, a57
    v_mul_f32 v5, v5, v3
    v_accvgpr_write_b32 a57, v5
    v_accvgpr_read_b32 v6, a58
    v_mul_f32 v6, v6, v3
    v_accvgpr_write_b32 a58, v6
    v_accvgpr_read_b32 v7, a59
    v_mul_f32 v7, v7, v3
    v_accvgpr_write_b32 a59, v7
    v_accvgpr_read_b32 v4, a60
    v_mul_f32 v4, v4, v3
    v_accvgpr_write_b32 a60, v4
    v_accvgpr_read_b32 v5, a61
    v_mul_f32 v5, v5, v3
    v_accvgpr_write_b32 a61, v5
    v_accvgpr_read_b32 v6, a62
    v_mul_f32 v6, v6, v3
    v_accvgpr_write_b32 a62, v6
    v_accvgpr_read_b32 v7, a63
    v_mul_f32 v7, v7, v3
    v_accvgpr_write_b32 a63, v7
    v_accvgpr_read_b32 v4, a80
    v_mul_f32 v4, v4, v3
    v_accvgpr_write_b32 a80, v4
    v_accvgpr_read_b32 v5, a81
    v_mul_f32 v5, v5, v3
    v_accvgpr_write_b32 a81, v5
    v_accvgpr_read_b32 v6, a82
    v_mul_f32 v6, v6, v3
    v_accvgpr_write_b32 a82, v6
    v_accvgpr_read_b32 v7, a83
    v_mul_f32 v7, v7, v3
    v_accvgpr_write_b32 a83, v7
    v_accvgpr_read_b32 v4, a84
    v_mul_f32 v4, v4, v3
    v_accvgpr_write_b32 a84, v4
    v_accvgpr_read_b32 v5, a85
    v_mul_f32 v5, v5, v3
    v_accvgpr_write_b32 a85, v5
    v_accvgpr_read_b32 v6, a86
    v_mul_f32 v6, v6, v3
    v_accvgpr_write_b32 a86, v6
    v_accvgpr_read_b32 v7, a87
    v_mul_f32 v7, v7, v3
    v_accvgpr_write_b32 a87, v7
    v_accvgpr_read_b32 v4, a88
    v_mul_f32 v4, v4, v3
    v_accvgpr_write_b32 a88, v4
    v_accvgpr_read_b32 v5, a89
    v_mul_f32 v5, v5, v3
    v_accvgpr_write_b32 a89, v5
    v_accvgpr_read_b32 v6, a90
    v_mul_f32 v6, v6, v3
    v_accvgpr_write_b32 a90, v6
    v_accvgpr_read_b32 v7, a91
    v_mul_f32 v7, v7, v3
    v_accvgpr_write_b32 a91, v7
    v_accvgpr_read_b32 v4, a92
    v_mul_f32 v4, v4, v3
    v_accvgpr_write_b32 a92, v4
    v_accvgpr_read_b32 v5, a93
    v_mul_f32 v5, v5, v3
    v_accvgpr_write_b32 a93, v5
    v_accvgpr_read_b32 v6, a94
    v_mul_f32 v6, v6, v3
    v_accvgpr_write_b32 a94, v6
    v_accvgpr_read_b32 v7, a95
    v_mul_f32 v7, v7, v3
    v_accvgpr_write_b32 a95, v7
    v_accvgpr_read_b32 v4, a112
    v_mul_f32 v4, v4, v3
    v_accvgpr_write_b32 a112, v4
    v_accvgpr_read_b32 v5, a113
    v_mul_f32 v5, v5, v3
    v_accvgpr_write_b32 a113, v5
    v_accvgpr_read_b32 v6, a114
    v_mul_f32 v6, v6, v3
    v_accvgpr_write_b32 a114, v6
    v_accvgpr_read_b32 v7, a115
    v_mul_f32 v7, v7, v3
    v_accvgpr_write_b32 a115, v7
    v_accvgpr_read_b32 v4, a116
    v_mul_f32 v4, v4, v3
    v_accvgpr_write_b32 a116, v4
    v_accvgpr_read_b32 v5, a117
    v_mul_f32 v5, v5, v3
    v_accvgpr_write_b32 a117, v5
    v_accvgpr_read_b32 v6, a118
    v_mul_f32 v6, v6, v3
    v_accvgpr_write_b32 a118, v6
    v_accvgpr_read_b32 v7, a119
    v_mul_f32 v7, v7, v3
    v_accvgpr_write_b32 a119, v7
    v_accvgpr_read_b32 v4, a120
    v_mul_f32 v4, v4, v3
    v_accvgpr_write_b32 a120, v4
    v_accvgpr_read_b32 v5, a121
    v_mul_f32 v5, v5, v3
    v_accvgpr_write_b32 a121, v5
    v_accvgpr_read_b32 v6, a122
    v_mul_f32 v6, v6, v3
    v_accvgpr_write_b32 a122, v6
    v_accvgpr_read_b32 v7, a123
    v_mul_f32 v7, v7, v3
    v_accvgpr_write_b32 a123, v7
    v_accvgpr_read_b32 v4, a124
    v_mul_f32 v4, v4, v3
    v_accvgpr_write_b32 a124, v4
    v_accvgpr_read_b32 v5, a125
    v_mul_f32 v5, v5, v3
    v_accvgpr_write_b32 a125, v5
    v_accvgpr_read_b32 v6, a126
    v_mul_f32 v6, v6, v3
    v_accvgpr_write_b32 a126, v6
    v_accvgpr_read_b32 v7, a127
    v_mul_f32 v7, v7, v3
    v_accvgpr_write_b32 a127, v7
    v_sub_f32 v96, v96, v1
    v_sub_f32 v64, v64, v1
    v_sub_f32 v32, v32, v1
    v_sub_f32 v97, v97, v1
    v_sub_f32 v65, v65, v1
    v_sub_f32 v33, v33, v1
    v_sub_f32 v98, v98, v1
    v_sub_f32 v66, v66, v1
    v_sub_f32 v34, v34, v1
    v_sub_f32 v99, v99, v1
    v_sub_f32 v67, v67, v1
    v_sub_f32 v35, v35, v1
    v_sub_f32 v100, v100, v1
    v_sub_f32 v68, v68, v1
    v_sub_f32 v36, v36, v1
    v_sub_f32 v101, v101, v1
    v_sub_f32 v69, v69, v1
    v_sub_f32 v37, v37, v1
    v_sub_f32 v102, v102, v1
    v_sub_f32 v70, v70, v1
    v_sub_f32 v38, v38, v1
    v_sub_f32 v103, v103, v1
    v_sub_f32 v71, v71, v1
    v_sub_f32 v39, v39, v1
    v_sub_f32 v104, v104, v1
    v_sub_f32 v72, v72, v1
    v_sub_f32 v40, v40, v1
    v_sub_f32 v105, v105, v1
    v_sub_f32 v73, v73, v1
    v_sub_f32 v41, v41, v1
    v_sub_f32 v106, v106, v1
    v_sub_f32 v74, v74, v1
    v_sub_f32 v42, v42, v1
    v_sub_f32 v107, v107, v1
    v_sub_f32 v75, v75, v1
    v_sub_f32 v43, v43, v1
    v_sub_f32 v108, v108, v1
    v_sub_f32 v76, v76, v1
    v_sub_f32 v44, v44, v1
    v_sub_f32 v109, v109, v1
    v_sub_f32 v77, v77, v1
    v_sub_f32 v45, v45, v1
    v_sub_f32 v110, v110, v1
    v_sub_f32 v78, v78, v1
    v_sub_f32 v46, v46, v1
    v_sub_f32 v111, v111, v1
    v_sub_f32 v79, v79, v1
    v_sub_f32 v47, v47, v1
    v_exp_f32 v208, v32
    v_exp_f32 v209, v33
    s_nop 0
    v_add_f32 v217, v208, v209
    v_cvt_pk_bf16_f32 v120, v208, v209
    v_exp_f32 v208, v34
    v_exp_f32 v209, v35
    s_nop 0
    v_add_f32 v217, v217, v208
    v_add_f32 v217, v217, v209
    v_cvt_pk_bf16_f32 v121, v208, v209
    v_exp_f32 v208, v36
    v_exp_f32 v209, v37
    s_nop 0
    v_add_f32 v217, v217, v208
    v_add_f32 v217, v217, v209
    v_cvt_pk_bf16_f32 v122, v208, v209
    v_exp_f32 v208, v38
    v_exp_f32 v209, v39
    s_nop 0
    v_add_f32 v217, v217, v208
    v_add_f32 v217, v217, v209
    v_cvt_pk_bf16_f32 v123, v208, v209
    v_exp_f32 v208, v40
    v_exp_f32 v209, v41
    s_nop 0
    v_add_f32 v217, v217, v208
    v_add_f32 v217, v217, v209
    v_cvt_pk_bf16_f32 v124, v208, v209
    v_exp_f32 v208, v42
    v_exp_f32 v209, v43
    s_nop 0
    v_add_f32 v217, v217, v208
    v_add_f32 v217, v217, v209
    v_cvt_pk_bf16_f32 v125, v208, v209
    v_exp_f32 v208, v44
    v_exp_f32 v209, v45
    s_nop 0
    v_add_f32 v217, v217, v208
    v_add_f32 v217, v217, v209
    v_cvt_pk_bf16_f32 v126, v208, v209
    v_exp_f32 v208, v46
    v_exp_f32 v209, v47
    s_nop 0
    v_add_f32 v217, v217, v208
    v_add_f32 v217, v217, v209
    v_cvt_pk_bf16_f32 v127, v208, v209
    v_exp_f32 v208, v48
    v_exp_f32 v209, v49
    s_nop 1
    s_setpc_b64 s[52:53]
L_raresub_1:
    s_nop 15
    s_nop 7
    v_max3_f32 v1, v48, v49, v50
    v_max3_f32 v1, v1, v51, v52
    v_max3_f32 v1, v1, v53, v54
    v_max3_f32 v1, v1, v55, v56
    v_max3_f32 v1, v1, v57, v58
    v_max3_f32 v1, v1, v59, v60
    v_max3_f32 v1, v1, v61, v62
    v_max_f32 v1, v1, v63
    v_mov_b32 v2, v1
    s_nop 1
    v_permlane32_swap_b32 v2, v1
    v_max_f32 v1, v1, v2
    v_add_f32 v1, 0x42d00000, v1
    v_max_f32 v1, 0, v1
    v_exp_f32 v3, -v1
    s_nop 0
    v_mul_f32 v220, v220, v3
    v_accvgpr_read_b32 v4, a0
    v_mul_f32 v4, v4, v3
    v_accvgpr_write_b32 a0, v4
    v_accvgpr_read_b32 v5, a1
    v_mul_f32 v5, v5, v3
    v_accvgpr_write_b32 a1, v5
    v_accvgpr_read_b32 v6, a2
    v_mul_f32 v6, v6, v3
    v_accvgpr_write_b32 a2, v6
    v_accvgpr_read_b32 v7, a3
    v_mul_f32 v7, v7, v3
    v_accvgpr_write_b32 a3, v7
    v_accvgpr_read_b32 v4, a4
    v_mul_f32 v4, v4, v3
    v_accvgpr_write_b32 a4, v4
    v_accvgpr_read_b32 v5, a5
    v_mul_f32 v5, v5, v3
    v_accvgpr_write_b32 a5, v5
    v_accvgpr_read_b32 v6, a6
    v_mul_f32 v6, v6, v3
    v_accvgpr_write_b32 a6, v6
    v_accvgpr_read_b32 v7, a7
    v_mul_f32 v7, v7, v3
    v_accvgpr_write_b32 a7, v7
    v_accvgpr_read_b32 v4, a8
    v_mul_f32 v4, v4, v3
    v_accvgpr_write_b32 a8, v4
    v_accvgpr_read_b32 v5, a9
    v_mul_f32 v5, v5, v3
    v_accvgpr_write_b32 a9, v5
    v_accvgpr_read_b32 v6, a10
    v_mul_f32 v6, v6, v3
    v_accvgpr_write_b32 a10, v6
    v_accvgpr_read_b32 v7, a11
    v_mul_f32 v7, v7, v3
    v_accvgpr_write_b32 a11, v7
    v_accvgpr_read_b32 v4, a12
    v_mul_f32 v4, v4, v3
    v_accvgpr_write_b32 a12, v4
    v_accvgpr_read_b32 v5, a13
    v_mul_f32 v5, v5, v3
    v_accvgpr_write_b32 a13, v5
    v_accvgpr_read_b32 v6, a14
    v_mul_f32 v6, v6, v3
    v_accvgpr_write_b32 a14, v6
    v_accvgpr_read_b32 v7, a15
    v_mul_f32 v7, v7, v3
    v_accvgpr_write_b32 a15, v7
    v_accvgpr_read_b32 v4, a32
    v_mul_f32 v4, v4, v3
    v_accvgpr_write_b32 a32, v4
    v_accvgpr_read_b32 v5, a33
    v_mul_f32 v5, v5, v3
    v_accvgpr_write_b32 a33, v5
    v_accvgpr_read_b32 v6, a34
    v_mul_f32 v6, v6, v3
    v_accvgpr_write_b32 a34, v6
    v_accvgpr_read_b32 v7, a35
    v_mul_f32 v7, v7, v3
    v_accvgpr_write_b32 a35, v7
    v_accvgpr_read_b32 v4, a36
    v_mul_f32 v4, v4, v3
    v_accvgpr_write_b32 a36, v4
    v_accvgpr_read_b32 v5, a37
    v_mul_f32 v5, v5, v3
    v_accvgpr_write_b32 a37, v5
    v_accvgpr_read_b32 v6, a38
    v_mul_f32 v6, v6, v3
    v_accvgpr_write_b32 a38, v6
    v_accvgpr_read_b32 v7, a39
    v_mul_f32 v7, v7, v3
    v_accvgpr_write_b32 a39, v7
    v_accvgpr_read_b32 v4, a40
    v_mul_f32 v4, v4, v3
    v_accvgpr_write_b32 a40, v4
    v_accvgpr_read_b32 v5, a41
    v_mul_f32 v5, v5, v3
    v_accvgpr_write_b32 a41, v5
    v_accvgpr_read_b32 v6, a42
    v_mul_f32 v6, v6, v3
    v_accvgpr_write_b32 a42, v6
    v_accvgpr_read_b32 v7, a43
    v_mul_f32 v7, v7, v3
    v_accvgpr_write_b32 a43, v7
    v_accvgpr_read_b32 v4, a44
    v_mul_f32 v4, v4, v3
    v_accvgpr_write_b32 a44, v4
    v_accvgpr_read_b32 v5, a45
    v_mul_f32 v5, v5, v3
    v_accvgpr_write_b32 a45, v5
    v_accvgpr_read_b32 v6, a46
    v_mul_f32 v6, v6, v3
    v_accvgpr_write_b32 a46, v6
    v_accvgpr_read_b32 v7, a47
    v_mul_f32 v7, v7, v3
    v_accvgpr_write_b32 a47, v7
    v_accvgpr_read_b32 v4, a64
    v_mul_f32 v4, v4, v3
    v_accvgpr_write_b32 a64, v4
    v_accvgpr_read_b32 v5, a65
    v_mul_f32 v5, v5, v3
    v_accvgpr_write_b32 a65, v5
    v_accvgpr_read_b32 v6, a66
    v_mul_f32 v6, v6, v3
    v_accvgpr_write_b32 a66, v6
    v_accvgpr_read_b32 v7, a67
    v_mul_f32 v7, v7, v3
    v_accvgpr_write_b32 a67, v7
    v_accvgpr_read_b32 v4, a68
    v_mul_f32 v4, v4, v3
    v_accvgpr_write_b32 a68, v4
    v_accvgpr_read_b32 v5, a69
    v_mul_f32 v5, v5, v3
    v_accvgpr_write_b32 a69, v5
    v_accvgpr_read_b32 v6, a70
    v_mul_f32 v6, v6, v3
    v_accvgpr_write_b32 a70, v6
    v_accvgpr_read_b32 v7, a71
    v_mul_f32 v7, v7, v3
    v_accvgpr_write_b32 a71, v7
    v_accvgpr_read_b32 v4, a72
    v_mul_f32 v4, v4, v3
    v_accvgpr_write_b32 a72, v4
    v_accvgpr_read_b32 v5, a73
    v_mul_f32 v5, v5, v3
    v_accvgpr_write_b32 a73, v5
    v_accvgpr_read_b32 v6, a74
    v_mul_f32 v6, v6, v3
    v_accvgpr_write_b32 a74, v6
    v_accvgpr_read_b32 v7, a75
    v_mul_f32 v7, v7, v3
    v_accvgpr_write_b32 a75, v7
    v_accvgpr_read_b32 v4, a76
    v_mul_f32 v4, v4, v3
    v_accvgpr_write_b32 a76, v4
    v_accvgpr_read_b32 v5, a77
    v_mul_f32 v5, v5, v3
    v_accvgpr_write_b32 a77, v5
    v_accvgpr_read_b32 v6, a78
    v_mul_f32 v6, v6, v3
    v_accvgpr_write_b32 a78, v6
    v_accvgpr_read_b32 v7, a79
    v_mul_f32 v7, v7, v3
    v_accvgpr_write_b32 a79, v7
    v_accvgpr_read_b32 v4, a96
    v_mul_f32 v4, v4, v3
    v_accvgpr_write_b32 a96, v4
    v_accvgpr_read_b32 v5, a97
    v_mul_f32 v5, v5, v3
    v_accvgpr_write_b32 a97, v5
    v_accvgpr_read_b32 v6, a98
    v_mul_f32 v6, v6, v3
    v_accvgpr_write_b32 a98, v6
    v_accvgpr_read_b32 v7, a99
    v_mul_f32 v7, v7, v3
    v_accvgpr_write_b32 a99, v7
    v_accvgpr_read_b32 v4, a100
    v_mul_f32 v4, v4, v3
    v_accvgpr_write_b32 a100, v4
    v_accvgpr_read_b32 v5, a101
    v_mul_f32 v5, v5, v3
    v_accvgpr_write_b32 a101, v5
    v_accvgpr_read_b32 v6, a102
    v_mul_f32 v6, v6, v3
    v_accvgpr_write_b32 a102, v6
    v_accvgpr_read_b32 v7, a103
    v_mul_f32 v7, v7, v3
    v_accvgpr_write_b32 a103, v7
    v_accvgpr_read_b32 v4, a104
    v_mul_f32 v4, v4, v3
    v_accvgpr_write_b32 a104, v4
    v_accvgpr_read_b32 v5, a105
    v_mul_f32 v5, v5, v3
    v_accvgpr_write_b32 a105, v5
    v_accvgpr_read_b32 v6, a106
    v_mul_f32 v6, v6, v3
    v_accvgpr_write_b32 a106, v6
    v_accvgpr_read_b32 v7, a107
    v_mul_f32 v7, v7, v3
    v_accvgpr_write_b32 a107, v7
    v_accvgpr_read_b32 v4, a108
    v_mul_f32 v4, v4, v3
    v_accvgpr_write_b32 a108, v4
    v_accvgpr_read_b32 v5, a109
    v_mul_f32 v5, v5, v3
    v_accvgpr_write_b32 a109, v5
    v_accvgpr_read_b32 v6, a110
    v_mul_f32 v6, v6, v3
    v_accvgpr_write_b32 a110, v6
    v_accvgpr_read_b32 v7, a111
    v_mul_f32 v7, v7, v3
    v_accvgpr_write_b32 a111, v7
    v_sub_f32 v80, v80, v1
    v_sub_f32 v16, v16, v1
    v_sub_f32 v48, v48, v1
    v_sub_f32 v81, v81, v1
    v_sub_f32 v17, v17, v1
    v_sub_f32 v49, v49, v1
    v_sub_f32 v82, v82, v1
    v_sub_f32 v18, v18, v1
    v_sub_f32 v50, v50, v1
    v_sub_f32 v83, v83, v1
    v_sub_f32 v19, v19, v1
    v_sub_f32 v51, v51, v1
    v_sub_f32 v84, v84, v1
    v_sub_f32 v20, v20, v1
    v_sub_f32 v52, v52, v1
    v_sub_f32 v85, v85, v1
    v_sub_f32 v21, v21, v1
    v_sub_f32 v53, v53, v1
    v_sub_f32 v86, v86, v1
    v_sub_f32 v22, v22, v1
    v_sub_f32 v54, v54, v1
    v_sub_f32 v87, v87, v1
    v_sub_f32 v23, v23, v1
    v_sub_f32 v55, v55, v1
    v_sub_f32 v88, v88, v1
    v_sub_f32 v24, v24, v1
    v_sub_f32 v56, v56, v1
    v_sub_f32 v89, v89, v1
    v_sub_f32 v25, v25, v1
    v_sub_f32 v57, v57, v1
    v_sub_f32 v90, v90, v1
    v_sub_f32 v26, v26, v1
    v_sub_f32 v58, v58, v1
    v_sub_f32 v91, v91, v1
    v_sub_f32 v27, v27, v1
    v_sub_f32 v59, v59, v1
    v_sub_f32 v92, v92, v1
    v_sub_f32 v28, v28, v1
    v_sub_f32 v60, v60, v1
    v_sub_f32 v93, v93, v1
    v_sub_f32 v29, v29, v1
    v_sub_f32 v61, v61, v1
    v_sub_f32 v94, v94, v1
    v_sub_f32 v30, v30, v1
    v_sub_f32 v62, v62, v1
    v_sub_f32 v95, v95, v1
    v_sub_f32 v31, v31, v1
    v_sub_f32 v63, v63, v1
    v_exp_f32 v208, v48
    v_exp_f32 v209, v49
    s_nop 0
    v_add_f32 v218, v208, v209
    v_cvt_pk_bf16_f32 v128, v208, v209
    v_exp_f32 v208, v50
    v_exp_f32 v209, v51
    s_nop 0
    v_add_f32 v218, v218, v208
    v_add_f32 v218, v218, v209
    v_cvt_pk_bf16_f32 v129, v208, v209
    v_exp_f32 v208, v52
    v_exp_f32 v209, v53
    s_nop 0
    v_add_f32 v218, v218, v208
    v_add_f32 v218, v218, v209
    v_cvt_pk_bf16_f32 v130, v208, v209
    v_exp_f32 v208, v54
    v_exp_f32 v209, v55
    s_nop 0
    v_add_f32 v218, v218, v208
    v_add_f32 v218, v218, v209
    v_cvt_pk_bf16_f32 v131, v208, v209
    v_exp_f32 v208, v56
    v_exp_f32 v209, v57
    s_nop 0
    v_add_f32 v218, v218, v208
    v_add_f32 v218, v218, v209
    v_cvt_pk_bf16_f32 v132, v208, v209
    v_exp_f32 v208, v58
    v_exp_f32 v209, v59
    s_nop 0
    v_add_f32 v218, v218, v208
    v_add_f32 v218, v218, v209
    v_cvt_pk_bf16_f32 v133, v208, v209
    v_exp_f32 v208, v60
    v_exp_f32 v209, v61
    s_nop 0
    v_add_f32 v218, v218, v208
    v_add_f32 v218, v218, v209
    v_cvt_pk_bf16_f32 v134, v208, v209
    v_exp_f32 v208, v62
    v_exp_f32 v209, v63
    s_nop 0
    v_add_f32 v218, v218, v208
    v_add_f32 v218, v218, v209
    v_cvt_pk_bf16_f32 v135, v208, v209
    v_max3_f32 v1, v64, v65, v66
    v_max3_f32 v1, v1, v67, v68
    v_max3_f32 v1, v1, v69, v70
    v_max3_f32 v1, v1, v71, v72
    v_max3_f32 v1, v1, v73, v74
    v_max3_f32 v1, v1, v75, v76
    v_max3_f32 v1, v1, v77, v78
    v_max_f32 v1, v1, v79
    v_mov_b32 v2, v1
    s_nop 1
    v_permlane32_swap_b32 v2, v1
    v_max_f32 v1, v1, v2
    v_add_f32 v1, 0x42d00000, v1
    v_max_f32 v1, 0, v1
    v_exp_f32 v3, -v1
    s_nop 0
    v_mul_f32 v221, v221, v3
    v_accvgpr_read_b32 v4, a16
    v_mul_f32 v4, v4, v3
    v_accvgpr_write_b32 a16, v4
    v_accvgpr_read_b32 v5, a17
    v_mul_f32 v5, v5, v3
    v_accvgpr_write_b32 a17, v5
    v_accvgpr_read_b32 v6, a18
    v_mul_f32 v6, v6, v3
    v_accvgpr_write_b32 a18, v6
    v_accvgpr_read_b32 v7, a19
    v_mul_f32 v7, v7, v3
    v_accvgpr_write_b32 a19, v7
    v_accvgpr_read_b32 v4, a20
    v_mul_f32 v4, v4, v3
    v_accvgpr_write_b32 a20, v4
    v_accvgpr_read_b32 v5, a21
    v_mul_f32 v5, v5, v3
    v_accvgpr_write_b32 a21, v5
    v_accvgpr_read_b32 v6, a22
    v_mul_f32 v6, v6, v3
    v_accvgpr_write_b32 a22, v6
    v_accvgpr_read_b32 v7, a23
    v_mul_f32 v7, v7, v3
    v_accvgpr_write_b32 a23, v7
    v_accvgpr_read_b32 v4, a24
    v_mul_f32 v4, v4, v3
    v_accvgpr_write_b32 a24, v4
    v_accvgpr_read_b32 v5, a25
    v_mul_f32 v5, v5, v3
    v_accvgpr_write_b32 a25, v5
    v_accvgpr_read_b32 v6, a26
    v_mul_f32 v6, v6, v3
    v_accvgpr_write_b32 a26, v6
    v_accvgpr_read_b32 v7, a27
    v_mul_f32 v7, v7, v3
    v_accvgpr_write_b32 a27, v7
    v_accvgpr_read_b32 v4, a28
    v_mul_f32 v4, v4, v3
    v_accvgpr_write_b32 a28, v4
    v_accvgpr_read_b32 v5, a29
    v_mul_f32 v5, v5, v3
    v_accvgpr_write_b32 a29, v5
    v_accvgpr_read_b32 v6, a30
    v_mul_f32 v6, v6, v3
    v_accvgpr_write_b32 a30, v6
    v_accvgpr_read_b32 v7, a31
    v_mul_f32 v7, v7, v3
    v_accvgpr_write_b32 a31, v7
    v_accvgpr_read_b32 v4, a48
    v_mul_f32 v4, v4, v3
    v_accvgpr_write_b32 a48, v4
    v_accvgpr_read_b32 v5, a49
    v_mul_f32 v5, v5, v3
    v_accvgpr_write_b32 a49, v5
    v_accvgpr_read_b32 v6, a50
    v_mul_f32 v6, v6, v3
    v_accvgpr_write_b32 a50, v6
    v_accvgpr_read_b32 v7, a51
    v_mul_f32 v7, v7, v3
    v_accvgpr_write_b32 a51, v7
    v_accvgpr_read_b32 v4, a52
    v_mul_f32 v4, v4, v3
    v_accvgpr_write_b32 a52, v4
    v_accvgpr_read_b32 v5, a53
    v_mul_f32 v5, v5, v3
    v_accvgpr_write_b32 a53, v5
    v_accvgpr_read_b32 v6, a54
    v_mul_f32 v6, v6, v3
    v_accvgpr_write_b32 a54, v6
    v_accvgpr_read_b32 v7, a55
    v_mul_f32 v7, v7, v3
    v_accvgpr_write_b32 a55, v7
    v_accvgpr_read_b32 v4, a56
    v_mul_f32 v4, v4, v3
    v_accvgpr_write_b32 a56, v4
    v_accvgpr_read_b32 v5, a57
    v_mul_f32 v5, v5, v3
    v_accvgpr_write_b32 a57, v5
    v_accvgpr_read_b32 v6, a58
    v_mul_f32 v6, v6, v3
    v_accvgpr_write_b32 a58, v6
    v_accvgpr_read_b32 v7, a59
    v_mul_f32 v7, v7, v3
    v_accvgpr_write_b32 a59, v7
    v_accvgpr_read_b32 v4, a60
    v_mul_f32 v4, v4, v3
    v_accvgpr_write_b32 a60, v4
    v_accvgpr_read_b32 v5, a61
    v_mul_f32 v5, v5, v3
    v_accvgpr_write_b32 a61, v5
    v_accvgpr_read_b32 v6, a62
    v_mul_f32 v6, v6, v3
    v_accvgpr_write_b32 a62, v6
    v_accvgpr_read_b32 v7, a63
    v_mul_f32 v7, v7, v3
    v_accvgpr_write_b32 a63, v7
    v_accvgpr_read_b32 v4, a80
    v_mul_f32 v4, v4, v3
    v_accvgpr_write_b32 a80, v4
    v_accvgpr_read_b32 v5, a81
    v_mul_f32 v5, v5, v3
    v_accvgpr_write_b32 a81, v5
    v_accvgpr_read_b32 v6, a82
    v_mul_f32 v6, v6, v3
    v_accvgpr_write_b32 a82, v6
    v_accvgpr_read_b32 v7, a83
    v_mul_f32 v7, v7, v3
    v_accvgpr_write_b32 a83, v7
    v_accvgpr_read_b32 v4, a84
    v_mul_f32 v4, v4, v3
    v_accvgpr_write_b32 a84, v4
    v_accvgpr_read_b32 v5, a85
    v_mul_f32 v5, v5, v3
    v_accvgpr_write_b32 a85, v5
    v_accvgpr_read_b32 v6, a86
    v_mul_f32 v6, v6, v3
    v_accvgpr_write_b32 a86, v6
    v_accvgpr_read_b32 v7, a87
    v_mul_f32 v7, v7, v3
    v_accvgpr_write_b32 a87, v7
    v_accvgpr_read_b32 v4, a88
    v_mul_f32 v4, v4, v3
    v_accvgpr_write_b32 a88, v4
    v_accvgpr_read_b32 v5, a89
    v_mul_f32 v5, v5, v3
    v_accvgpr_write_b32 a89, v5
    v_accvgpr_read_b32 v6, a90
    v_mul_f32 v6, v6, v3
    v_accvgpr_write_b32 a90, v6
    v_accvgpr_read_b32 v7, a91
    v_mul_f32 v7, v7, v3
    v_accvgpr_write_b32 a91, v7
    v_accvgpr_read_b32 v4, a92
    v_mul_f32 v4, v4, v3
    v_accvgpr_write_b32 a92, v4
    v_accvgpr_read_b32 v5, a93
    v_mul_f32 v5, v5, v3
    v_accvgpr_write_b32 a93, v5
    v_accvgpr_read_b32 v6, a94
    v_mul_f32 v6, v6, v3
    v_accvgpr_write_b32 a94, v6
    v_accvgpr_read_b32 v7, a95
    v_mul_f32 v7, v7, v3
    v_accvgpr_write_b32 a95, v7
    v_accvgpr_read_b32 v4, a112
    v_mul_f32 v4, v4, v3
    v_accvgpr_write_b32 a112, v4
    v_accvgpr_read_b32 v5, a113
    v_mul_f32 v5, v5, v3
    v_accvgpr_write_b32 a113, v5
    v_accvgpr_read_b32 v6, a114
    v_mul_f32 v6, v6, v3
    v_accvgpr_write_b32 a114, v6
    v_accvgpr_read_b32 v7, a115
    v_mul_f32 v7, v7, v3
    v_accvgpr_write_b32 a115, v7
    v_accvgpr_read_b32 v4, a116
    v_mul_f32 v4, v4, v3
    v_accvgpr_write_b32 a116, v4
    v_accvgpr_read_b32 v5, a117
    v_mul_f32 v5, v5, v3
    v_accvgpr_write_b32 a117, v5
    v_accvgpr_read_b32 v6, a118
    v_mul_f32 v6, v6, v3
    v_accvgpr_write_b32 a118, v6
    v_accvgpr_read_b32 v7, a119
    v_mul_f32 v7, v7, v3
    v_accvgpr_write_b32 a119, v7
    v_accvgpr_read_b32 v4, a120
    v_mul_f32 v4, v4, v3
    v_accvgpr_write_b32 a120, v4
    v_accvgpr_read_b32 v5, a121
    v_mul_f32 v5, v5, v3
    v_accvgpr_write_b32 a121, v5
    v_accvgpr_read_b32 v6, a122
    v_mul_f32 v6, v6, v3
    v_accvgpr_write_b32 a122, v6
    v_accvgpr_read_b32 v7, a123
    v_mul_f32 v7, v7, v3
    v_accvgpr_write_b32 a123, v7
    v_accvgpr_read_b32 v4, a124
    v_mul_f32 v4, v4, v3
    v_accvgpr_write_b32 a124, v4
    v_accvgpr_read_b32 v5, a125
    v_mul_f32 v5, v5, v3
    v_accvgpr_write_b32 a125, v5
    v_accvgpr_read_b32 v6, a126
    v_mul_f32 v6, v6, v3
    v_accvgpr_write_b32 a126, v6
    v_accvgpr_read_b32 v7, a127
    v_mul_f32 v7, v7, v3
    v_accvgpr_write_b32 a127, v7
    v_sub_f32 v96, v96, v1
    v_sub_f32 v32, v32, v1
    v_sub_f32 v64, v64, v1
    v_sub_f32 v97, v97, v1
    v_sub_f32 v33, v33, v1
    v_sub_f32 v65, v65, v1
    v_sub_f32 v98, v98, v1
    v_sub_f32 v34, v34, v1
    v_sub_f32 v66, v66, v1
    v_sub_f32 v99, v99, v1
    v_sub_f32 v35, v35, v1
    v_sub_f32 v67, v67, v1
    v_sub_f32 v100, v100, v1
    v_sub_f32 v36, v36, v1
    v_sub_f32 v68, v68, v1
    v_sub_f32 v101, v101, v1
    v_sub_f32 v37, v37, v1
    v_sub_f32 v69, v69, v1
    v_sub_f32 v102, v102, v1
    v_sub_f32 v38, v38, v1
    v_sub_f32 v70, v70, v1
    v_sub_f32 v103, v103, v1
    v_sub_f32 v39, v39, v1
    v_sub_f32 v71, v71, v1
    v_sub_f32 v104, v104, v1
    v_sub_f32 v40, v40, v1
    v_sub_f32 v72, v72, v1
    v_sub_f32 v105, v105, v1
    v_sub_f32 v41, v41, v1
    v_sub_f32 v73, v73, v1
    v_sub_f32 v106, v106, v1
    v_sub_f32 v42, v42, v1
    v_sub_f32 v74, v74, v1
    v_sub_f32 v107, v107, v1
    v_sub_f32 v43, v43, v1
    v_sub_f32 v75, v75, v1
    v_sub_f32 v108, v108, v1
    v_sub_f32 v44, v44, v1
    v_sub_f32 v76, v76, v1
    v_sub_f32 v109, v109, v1
    v_sub_f32 v45, v45, v1
    v_sub_f32 v77, v77, v1
    v_sub_f32 v110, v110, v1
    v_sub_f32 v46, v46, v1
    v_sub_f32 v78, v78, v1
    v_sub_f32 v111, v111, v1
    v_sub_f32 v47, v47, v1
    v_sub_f32 v79, v79, v1
    v_exp_f32 v208, v64
    v_exp_f32 v209, v65
    s_nop 0
    v_add_f32 v219, v208, v209
    v_cvt_pk_bf16_f32 v136, v208, v209
    v_exp_f32 v208, v66
    v_exp_f32 v209, v67
    s_nop 0
    v_add_f32 v219, v219, v208
    v_add_f32 v219, v219, v209
    v_cvt_pk_bf16_f32 v137, v208, v209
    v_exp_f32 v208, v68
    v_exp_f32 v209, v69
    s_nop 0
    v_add_f32 v219, v219, v208
    v_add_f32 v219, v219, v209
    v_cvt_pk_bf16_f32 v138, v208, v209
    v_exp_f32 v208, v70
    v_exp_f32 v209, v71
    s_nop 0
    v_add_f32 v219, v219, v208
    v_add_f32 v219, v219, v209
    v_cvt_pk_bf16_f32 v139, v208, v209
    v_exp_f32 v208, v72
    v_exp_f32 v209, v73
    s_nop 0
    v_add_f32 v219, v219, v208
    v_add_f32 v219, v219, v209
    v_cvt_pk_bf16_f32 v140, v208, v209
    v_exp_f32 v208, v74
    v_exp_f32 v209, v75
    s_nop 0
    v_add_f32 v219, v219, v208
    v_add_f32 v219, v219, v209
    v_cvt_pk_bf16_f32 v141, v208, v209
    v_exp_f32 v208, v76
    v_exp_f32 v209, v77
    s_nop 0
    v_add_f32 v219, v219, v208
    v_add_f32 v219, v219, v209
    v_cvt_pk_bf16_f32 v142, v208, v209
    v_exp_f32 v208, v78
    v_exp_f32 v209, v79
    s_nop 0
    v_add_f32 v219, v219, v208
    v_add_f32 v219, v219, v209
    v_cvt_pk_bf16_f32 v143, v208, v209
    v_exp_f32 v208, v16
    v_exp_f32 v209, v17
    s_nop 1
    s_setpc_b64 s[52:53]

.section .rodata,"a"
.p2align 6
.amdhsa_kernel recurrent_scan__gqa_block_cached__mixer_token_mlp__prompt_kernel
  .amdhsa_next_free_vgpr 512
  .amdhsa_next_free_sgpr 102
  .amdhsa_accum_offset 256
  .amdhsa_group_segment_fixed_size 0
  .amdhsa_kernarg_size 104
  .amdhsa_user_sgpr_count 2
  .amdhsa_user_sgpr_kernarg_segment_ptr 1
  .amdhsa_system_sgpr_workgroup_id_x 1
.end_amdhsa_kernel
```
